```python
import torch

def _softmax(x, axis=-1):
    return torch.softmax(x, dim=axis)
def _gelu(x):
    return torch.nn.functional.gelu(x, approximate="tanh")
def _silu(x):
    return torch.nn.functional.silu(x)
def _sigmoid(x):
    return torch.sigmoid(x)
def _layernorm(x, axis=-1, eps=1e-5):
    m = x.mean(dim=axis, keepdim=True)
    v = x.var(dim=axis, keepdim=True, unbiased=False)
    return (x - m) / torch.sqrt(v + eps)
def _scatter_add(tgt, idx, src, axis=0):
    return tgt.clone().index_add_(axis, idx, src)
def _segment_sum(src, seg, n):
    out = torch.zeros((n,) + src.shape[1:], dtype=src.dtype)
    return out.index_add_(0, seg, src)
def _pad(x, pw):
    flat = tuple(v for pair in reversed(pw) for v in pair)
    return torch.nn.functional.pad(x, flat)

kernel_name = 'interleave_layers__grouped_kv_mqa__glu_gated_geglu__prompt'

def setup_inputs():

    _w = (lambda a: (lambda t: t.to(torch.bfloat16) if t.is_floating_point() else t)(torch.as_tensor(a)))
    def _A_setup():
        B, S, D, H = 1, 2048, 640, 32
        Dh = D // H
        return {
            "x": _w((lambda *s: torch.randn(*s, dtype=torch.bfloat16) * 0.05)(B, S, D)),
            "wq": _w((lambda *s: torch.randn(*s, dtype=torch.bfloat16) * 0.05)(D, H * Dh)),
            "wk": _w((lambda *s: torch.randn(*s, dtype=torch.bfloat16) * 0.05)(D, Dh)),
            "wv": _w((lambda *s: torch.randn(*s, dtype=torch.bfloat16) * 0.05)(D, Dh)),
            "wo": _w((lambda *s: torch.randn(*s, dtype=torch.bfloat16) * 0.05)(H * Dh, D)),
        }
    _A_in = _A_setup()

    def _B_setup():
        B, S, Dm, Df = 1, 2048, 640, 1728
        return {
            "x": _w((lambda *s: torch.randn(*s, dtype=torch.bfloat16) * 0.05)(B, S, Dm)),
            "w_gate": _w((lambda *s: torch.randn(*s, dtype=torch.bfloat16) * 0.8)(Dm, Df) * (Dm ** -0.5)),
            "w_up": _w((lambda *s: torch.randn(*s, dtype=torch.bfloat16) * 0.8)(Dm, Df) * (Dm ** -0.5)),
            "w_down": _w((lambda *s: torch.randn(*s, dtype=torch.bfloat16) * 0.8)(Df, Dm) * (Df ** -0.5)),
        }
    _B_in = _B_setup()

    return {
        "A_x": _A_in["x"],
        "A_wq": _A_in["wq"],
        "A_wk": _A_in["wk"],
        "A_wv": _A_in["wv"],
        "A_wo": _A_in["wo"],
        "B_x": _B_in["x"],
        "B_w_gate": _B_in["w_gate"],
        "B_w_up": _B_in["w_up"],
        "B_w_down": _B_in["w_down"],
    }

def reference(A_x, A_wq, A_wk, A_wv, A_wo, B_x, B_w_gate, B_w_up, B_w_down):
    def _A_ref(x, wq, wk, wv, wo):
        B, S, D = x.shape
        H = 32
        Dh = D // H
        q = (lambda x, *d: x.permute(*d))((x @ wq).reshape(B, S, H, Dh), 0, 2, 1, 3)
        k = x @ wk
        v = x @ wv
        scores = torch.einsum("bhqd,bkd->bhqk", q, k) * (Dh ** -0.5)
        p = _softmax(scores, axis=-1)
        o = torch.einsum("bhqk,bkd->bhqd", p, v)
        return (lambda x, *d: x.permute(*d))(o, 0, 2, 1, 3).reshape(B, S, H * Dh) @ wo

    def _B_ref(x, w_gate, w_up, w_down):
        g = torch.einsum("bsd,df->bsf", x, w_gate)
        u = torch.einsum("bsd,df->bsf", x, w_up)
        h = _gelu(g) * u
        return torch.einsum("bsf,fd->bsd", h, w_down)

    x = A_x
    x = x + _A_ref(_layernorm(x, axis=-1), A_wq, A_wk, A_wv, A_wo)
    x = x + _B_ref(_layernorm(x, axis=-1), B_w_gate, B_w_up, B_w_down)
    x = x + _A_ref(_layernorm(x, axis=-1), A_wq, A_wk, A_wv, A_wo)
    x = x + _B_ref(_layernorm(x, axis=-1), B_w_gate, B_w_up, B_w_down)
    return x
```

```asm
; @launch kernel=g1a_kernel grid=(288,1,1) block=(256,1,1) lds=81920
; @launch kernel=att_kernel grid=(256,1,1) block=(512,1,1) lds=132096
; @launch kernel=g2a_kernel grid=(256,1,1) block=(256,1,1) lds=147456
; @launch kernel=g3_kernel grid=(216,1,1) block=(512,1,1) lds=147456
; @launch kernel=g4a_kernel grid=(256,1,1) block=(256,1,1) lds=147456
; @launch kernel=g1b_kernel grid=(288,1,1) block=(256,1,1) lds=81920
; @launch kernel=att_kernel grid=(256,1,1) block=(512,1,1) lds=132096
; @launch kernel=g2b_kernel grid=(256,1,1) block=(256,1,1) lds=147456
; @launch kernel=g3_kernel grid=(216,1,1) block=(512,1,1) lds=147456
; @launch kernel=g4b_kernel grid=(256,1,1) block=(256,1,1) lds=147456
.amdgcn_target "amdgcn-amd-amdhsa--gfx950"
.text
.globl g1a_kernel
.p2align 8
.type g1a_kernel,@function
g1a_kernel:
  s_cmp_ge_u32 s2, 288
  s_cbranch_scc1 L_end_g1a_kernel
  s_load_dwordx2 s[32:33], s[0:1], 88
  s_load_dwordx2 s[34:35], s[0:1], 0
  s_load_dwordx2 s[36:37], s[0:1], 8
  s_load_dwordx2 s[38:39], s[0:1], 16
  s_load_dwordx2 s[40:41], s[0:1], 24
  v_lshrrev_b32 v15, 6, v0
  v_and_b32 v1, 63, v0
  v_readfirstlane_b32 s20, v15
  s_and_b32 s28, s2, 7
  s_lshr_b32 s30, s2, 3
  s_and_b32 s27, s30, 3
  s_lshr_b32 s30, s30, 2
  s_lshl_b32 s28, s28, 2
  s_add_u32 s28, s28, s27
  s_lshl_b32 s28, s28, 6
  s_mul_i32 s29, s30, 80
  s_waitcnt lgkmcnt(0)
  s_mov_b32 s4, s34
  s_mov_b32 s5, s35
  s_mov_b32 s6, 2621440
  s_mov_b32 s7, 0x00020000
  s_mov_b32 s8, s36
  s_mov_b32 s9, s37
  s_mov_b32 s10, 819200
  s_mov_b32 s11, 0x00020000
  s_add_u32 s42, s32, 0
  s_addc_u32 s43, s33, 0
  s_mov_b32 s12, s42
  s_mov_b32 s13, s43
  s_mov_b32 s14, 2621440
  s_mov_b32 s15, 0x00020000
  s_sub_u32 s22, 23, s20
  s_lshr_b32 s22, s22, 2
  s_mul_i32 s27, s20, 5
  s_min_u32 s23, s20, 0
  s_add_u32 s27, s27, s23
  s_lshl_b32 s23, s27, 6
  s_mul_i32 s24, s27, 40960
  s_mul_i32 s21, s20, 20480
  v_lshrrev_b32 v15, 2, v1
  v_lshrrev_b32 v16, 3, v1
  v_xor_b32 v16, v16, v1
  v_and_b32 v16, 3, v16
  v_add_u32 v15, s28, v15
  s_mov_b32 s27, 1280
  v_mul_lo_u32 v15, v15, s27
  v_lshl_add_u32 v2, v16, 4, v15
  v_add_u32 v3, 20480, v2
  v_add_u32 v4, 40960, v2
  v_add_u32 v5, 61440, v2
  v_add_u32 v15, 0, v1
  v_mul_u32_u24 v16, 6554, v15
  v_lshrrev_b32 v16, 16, v16
  v_mul_u32_u24 v17, 10, v16
  v_sub_u32 v17, v15, v17
  v_mul_u32_u24 v16, 1280, v16
  v_lshl_add_u32 v6, v17, 4, v16
  v_add_u32 v15, 64, v1
  v_mul_u32_u24 v16, 6554, v15
  v_lshrrev_b32 v16, 16, v16
  v_mul_u32_u24 v17, 10, v16
  v_sub_u32 v17, v15, v17
  v_mul_u32_u24 v16, 1280, v16
  v_lshl_add_u32 v7, v17, 4, v16
  v_add_u32 v15, 128, v1
  v_mul_u32_u24 v16, 6554, v15
  v_lshrrev_b32 v16, 16, v16
  v_mul_u32_u24 v17, 10, v16
  v_sub_u32 v17, v15, v17
  v_mul_u32_u24 v16, 1280, v16
  v_lshl_add_u32 v8, v17, 4, v16
  v_add_u32 v15, 192, v1
  v_mul_u32_u24 v16, 6554, v15
  v_lshrrev_b32 v16, 16, v16
  v_mul_u32_u24 v17, 10, v16
  v_sub_u32 v17, v15, v17
  v_mul_u32_u24 v16, 1280, v16
  v_lshl_add_u32 v9, v17, 4, v16
  v_add_u32 v15, 256, v1
  v_mul_u32_u24 v16, 6554, v15
  v_lshrrev_b32 v16, 16, v16
  v_mul_u32_u24 v17, 10, v16
  v_sub_u32 v17, v15, v17
  v_mul_u32_u24 v16, 1280, v16
  v_lshl_add_u32 v10, v17, 4, v16
  s_lshl_b32 s27, s29, 1
  v_add_u32 v6, s27, v6
  v_add_u32 v7, s27, v7
  v_add_u32 v8, s27, v8
  v_add_u32 v9, s27, v9
  v_add_u32 v10, s27, v10
  v_and_b32 v15, 15, v1
  v_lshrrev_b32 v16, 4, v1
  v_lshrrev_b32 v17, 1, v15
  v_xor_b32 v17, v17, v16
  v_and_b32 v17, 3, v17
  v_lshlrev_b32 v17, 4, v17
  v_lshl_add_u32 v11, v15, 6, v17
  v_add_u32 v11, s21, v11
  v_lshrrev_b32 v17, 2, v15
  v_lshl_add_u32 v17, v16, 3, v17
  v_mov_b32 v19, v17
  v_mul_u32_u24 v17, 160, v17
  v_and_b32 v18, 3, v1
  v_lshl_add_u32 v12, v18, 3, v17
  v_add_u32 v12, 4096, v12
  v_add_u32 v12, s21, v12
  v_mov_b32 v60, 0
  v_mov_b32 v61, 0
  v_mov_b32 v62, 0
  v_mov_b32 v63, 0
  v_mov_b32 v64, 0
  v_mov_b32 v65, 0
  v_mov_b32 v66, 0
  v_mov_b32 v67, 0
  v_mov_b32 v68, 0
  v_mov_b32 v69, 0
  v_mov_b32 v70, 0
  v_mov_b32 v71, 0
  v_mov_b32 v72, 0
  v_mov_b32 v73, 0
  v_mov_b32 v74, 0
  v_mov_b32 v75, 0
  v_mov_b32 v76, 0
  v_mov_b32 v77, 0
  v_mov_b32 v78, 0
  v_mov_b32 v79, 0
  v_mov_b32 v80, 0
  v_mov_b32 v81, 0
  v_mov_b32 v82, 0
  v_mov_b32 v83, 0
  v_mov_b32 v84, 0
  v_mov_b32 v85, 0
  v_mov_b32 v86, 0
  v_mov_b32 v87, 0
  v_mov_b32 v88, 0
  v_mov_b32 v89, 0
  v_mov_b32 v90, 0
  v_mov_b32 v91, 0
  v_mov_b32 v92, 0
  v_mov_b32 v93, 0
  v_mov_b32 v94, 0
  v_mov_b32 v95, 0
  v_mov_b32 v96, 0
  v_mov_b32 v97, 0
  v_mov_b32 v98, 0
  v_mov_b32 v99, 0
  v_mov_b32 v100, 0
  v_mov_b32 v101, 0
  v_mov_b32 v102, 0
  v_mov_b32 v103, 0
  v_mov_b32 v104, 0
  v_mov_b32 v105, 0
  v_mov_b32 v106, 0
  v_mov_b32 v107, 0
  v_mov_b32 v108, 0
  v_mov_b32 v109, 0
  v_mov_b32 v110, 0
  v_mov_b32 v111, 0
  v_mov_b32 v112, 0
  v_mov_b32 v113, 0
  v_mov_b32 v114, 0
  v_mov_b32 v115, 0
  v_mov_b32 v116, 0
  v_mov_b32 v117, 0
  v_mov_b32 v118, 0
  v_mov_b32 v119, 0
  v_mov_b32 v120, 0
  v_mov_b32 v121, 0
  v_mov_b32 v122, 0
  v_mov_b32 v123, 0
  v_mov_b32 v124, 0
  v_mov_b32 v125, 0
  v_mov_b32 v126, 0
  v_mov_b32 v127, 0
  v_mov_b32 v128, 0
  v_mov_b32 v129, 0
  v_mov_b32 v130, 0
  v_mov_b32 v131, 0
  v_mov_b32 v132, 0
  v_mov_b32 v133, 0
  v_mov_b32 v134, 0
  v_mov_b32 v135, 0
  v_mov_b32 v136, 0
  v_mov_b32 v137, 0
  v_mov_b32 v138, 0
  v_mov_b32 v139, 0
  v_mov_b32 v140, 0
  v_mov_b32 v141, 0
  v_mov_b32 v142, 0
  v_mov_b32 v143, 0
  v_mov_b32 v144, 0
  v_mov_b32 v145, 0
  v_mov_b32 v146, 0
  v_mov_b32 v147, 0
  v_mov_b32 v148, 0
  v_mov_b32 v149, 0
  v_mov_b32 v150, 0
  v_mov_b32 v151, 0
  v_mov_b32 v152, 0
  v_mov_b32 v153, 0x3f803f80
  s_mov_b32 s25, s21
  s_mov_b32 s26, 0
  s_cmp_eq_u32 s30, 8
  s_cbranch_scc1 L_kv_g1a_kernel
  s_add_u32 m0, s25, 0
  s_nop 0
  buffer_load_dwordx4 v2, s[4:7], s23 offen lds
  s_add_u32 m0, s25, 1024
  s_nop 0
  buffer_load_dwordx4 v3, s[4:7], s23 offen lds
  s_add_u32 m0, s25, 2048
  s_nop 0
  buffer_load_dwordx4 v4, s[4:7], s23 offen lds
  s_add_u32 m0, s25, 3072
  s_nop 0
  buffer_load_dwordx4 v5, s[4:7], s23 offen lds
  s_add_u32 m0, s25, 4096
  s_nop 0
  buffer_load_dwordx4 v6, s[8:11], s24 offen lds
  s_add_u32 m0, s25, 5120
  s_nop 0
  buffer_load_dwordx4 v7, s[8:11], s24 offen lds
  s_add_u32 m0, s25, 6144
  s_nop 0
  buffer_load_dwordx4 v8, s[8:11], s24 offen lds
  s_add_u32 m0, s25, 7168
  s_nop 0
  buffer_load_dwordx4 v9, s[8:11], s24 offen lds
  s_add_u32 m0, s25, 8192
  s_nop 0
  buffer_load_dwordx4 v10, s[8:11], s24 offen lds
  s_add_u32 s24, s24, 40960
  s_add_u32 s23, s23, 64
  s_add_u32 s25, s25, 9216
  s_add_u32 s27, s21, 18432
  s_cmp_ge_u32 s25, s27
  s_cselect_b32 s25, s21, s25
L_loop_g1a_kernel:
  s_add_u32 m0, s25, 0
  s_nop 0
  buffer_load_dwordx4 v2, s[4:7], s23 offen lds
  s_add_u32 m0, s25, 1024
  s_nop 0
  buffer_load_dwordx4 v3, s[4:7], s23 offen lds
  s_add_u32 m0, s25, 2048
  s_nop 0
  buffer_load_dwordx4 v4, s[4:7], s23 offen lds
  s_add_u32 m0, s25, 3072
  s_nop 0
  buffer_load_dwordx4 v5, s[4:7], s23 offen lds
  s_add_u32 m0, s25, 4096
  s_nop 0
  buffer_load_dwordx4 v6, s[8:11], s24 offen lds
  s_add_u32 m0, s25, 5120
  s_nop 0
  buffer_load_dwordx4 v7, s[8:11], s24 offen lds
  s_add_u32 m0, s25, 6144
  s_nop 0
  buffer_load_dwordx4 v8, s[8:11], s24 offen lds
  s_add_u32 m0, s25, 7168
  s_nop 0
  buffer_load_dwordx4 v9, s[8:11], s24 offen lds
  s_add_u32 m0, s25, 8192
  s_nop 0
  buffer_load_dwordx4 v10, s[8:11], s24 offen lds
  s_add_u32 s24, s24, 40960
  s_add_u32 s23, s23, 64
  s_add_u32 s25, s25, 9216
  s_add_u32 s27, s21, 18432
  s_cmp_ge_u32 s25, s27
  s_cselect_b32 s25, s21, s25
  s_waitcnt vmcnt(9)
  v_add_u32 v13, s26, v11
  v_add_u32 v14, s26, v12
  ds_read_b128 v[24:27], v13 offset:0
  ds_read_b128 v[28:31], v13 offset:1024
  ds_read_b128 v[32:35], v13 offset:2048
  ds_read_b128 v[36:39], v13 offset:3072
  ds_read_b64_tr_b16 v[40:41], v14 offset:0
  ds_read_b64_tr_b16 v[42:43], v14 offset:640
  ds_read_b64_tr_b16 v[44:45], v14 offset:32
  ds_read_b64_tr_b16 v[46:47], v14 offset:672
  ds_read_b64_tr_b16 v[48:49], v14 offset:64
  ds_read_b64_tr_b16 v[50:51], v14 offset:704
  ds_read_b64_tr_b16 v[52:53], v14 offset:96
  ds_read_b64_tr_b16 v[54:55], v14 offset:736
  ds_read_b64_tr_b16 v[56:57], v14 offset:128
  ds_read_b64_tr_b16 v[58:59], v14 offset:768
  s_add_u32 s26, s26, 9216
  s_cmp_ge_u32 s26, 18432
  s_cselect_b32 s26, 0, s26
  s_waitcnt lgkmcnt(0)
  v_mfma_f32_16x16x32_bf16 v[60:63], v[40:43], v[24:27], v[60:63]
  v_mfma_f32_16x16x32_bf16 v[64:67], v[44:47], v[24:27], v[64:67]
  v_mfma_f32_16x16x32_bf16 v[68:71], v[48:51], v[24:27], v[68:71]
  v_mfma_f32_16x16x32_bf16 v[72:75], v[52:55], v[24:27], v[72:75]
  v_mfma_f32_16x16x32_bf16 v[76:79], v[56:59], v[24:27], v[76:79]
  v_mfma_f32_16x16x32_bf16 v[80:83], v[40:43], v[28:31], v[80:83]
  v_mfma_f32_16x16x32_bf16 v[84:87], v[44:47], v[28:31], v[84:87]
  v_mfma_f32_16x16x32_bf16 v[88:91], v[48:51], v[28:31], v[88:91]
  v_mfma_f32_16x16x32_bf16 v[92:95], v[52:55], v[28:31], v[92:95]
  v_mfma_f32_16x16x32_bf16 v[96:99], v[56:59], v[28:31], v[96:99]
  v_mfma_f32_16x16x32_bf16 v[100:103], v[40:43], v[32:35], v[100:103]
  v_mfma_f32_16x16x32_bf16 v[104:107], v[44:47], v[32:35], v[104:107]
  v_mfma_f32_16x16x32_bf16 v[108:111], v[48:51], v[32:35], v[108:111]
  v_mfma_f32_16x16x32_bf16 v[112:115], v[52:55], v[32:35], v[112:115]
  v_mfma_f32_16x16x32_bf16 v[116:119], v[56:59], v[32:35], v[116:119]
  v_mfma_f32_16x16x32_bf16 v[120:123], v[40:43], v[36:39], v[120:123]
  v_mfma_f32_16x16x32_bf16 v[124:127], v[44:47], v[36:39], v[124:127]
  v_mfma_f32_16x16x32_bf16 v[128:131], v[48:51], v[36:39], v[128:131]
  v_mfma_f32_16x16x32_bf16 v[132:135], v[52:55], v[36:39], v[132:135]
  v_mfma_f32_16x16x32_bf16 v[136:139], v[56:59], v[36:39], v[136:139]
  v_dot2_f32_bf16 v140, v24, v153, v140
  v_dot2_f32_bf16 v144, v24, v24, v144
  v_dot2_f32_bf16 v140, v25, v153, v140
  v_dot2_f32_bf16 v144, v25, v25, v144
  v_dot2_f32_bf16 v140, v26, v153, v140
  v_dot2_f32_bf16 v144, v26, v26, v144
  v_dot2_f32_bf16 v140, v27, v153, v140
  v_dot2_f32_bf16 v144, v27, v27, v144
  v_dot2_f32_bf16 v141, v28, v153, v141
  v_dot2_f32_bf16 v145, v28, v28, v145
  v_dot2_f32_bf16 v141, v29, v153, v141
  v_dot2_f32_bf16 v145, v29, v29, v145
  v_dot2_f32_bf16 v141, v30, v153, v141
  v_dot2_f32_bf16 v145, v30, v30, v145
  v_dot2_f32_bf16 v141, v31, v153, v141
  v_dot2_f32_bf16 v145, v31, v31, v145
  v_dot2_f32_bf16 v142, v32, v153, v142
  v_dot2_f32_bf16 v146, v32, v32, v146
  v_dot2_f32_bf16 v142, v33, v153, v142
  v_dot2_f32_bf16 v146, v33, v33, v146
  v_dot2_f32_bf16 v142, v34, v153, v142
  v_dot2_f32_bf16 v146, v34, v34, v146
  v_dot2_f32_bf16 v142, v35, v153, v142
  v_dot2_f32_bf16 v146, v35, v35, v146
  v_dot2_f32_bf16 v143, v36, v153, v143
  v_dot2_f32_bf16 v147, v36, v36, v147
  v_dot2_f32_bf16 v143, v37, v153, v143
  v_dot2_f32_bf16 v147, v37, v37, v147
  v_dot2_f32_bf16 v143, v38, v153, v143
  v_dot2_f32_bf16 v147, v38, v38, v147
  v_dot2_f32_bf16 v143, v39, v153, v143
  v_dot2_f32_bf16 v147, v39, v39, v147
  v_dot2_f32_bf16 v148, v40, v153, v148
  v_dot2_f32_bf16 v148, v41, v153, v148
  v_dot2_f32_bf16 v148, v42, v153, v148
  v_dot2_f32_bf16 v148, v43, v153, v148
  v_dot2_f32_bf16 v149, v44, v153, v149
  v_dot2_f32_bf16 v149, v45, v153, v149
  v_dot2_f32_bf16 v149, v46, v153, v149
  v_dot2_f32_bf16 v149, v47, v153, v149
  v_dot2_f32_bf16 v150, v48, v153, v150
  v_dot2_f32_bf16 v150, v49, v153, v150
  v_dot2_f32_bf16 v150, v50, v153, v150
  v_dot2_f32_bf16 v150, v51, v153, v150
  v_dot2_f32_bf16 v151, v52, v153, v151
  v_dot2_f32_bf16 v151, v53, v153, v151
  v_dot2_f32_bf16 v151, v54, v153, v151
  v_dot2_f32_bf16 v151, v55, v153, v151
  v_dot2_f32_bf16 v152, v56, v153, v152
  v_dot2_f32_bf16 v152, v57, v153, v152
  v_dot2_f32_bf16 v152, v58, v153, v152
  v_dot2_f32_bf16 v152, v59, v153, v152
  s_sub_u32 s22, s22, 1
  s_cmp_lg_u32 s22, 0
  s_cbranch_scc1 L_loop_g1a_kernel
  s_branch L_red_g1a_kernel
L_kv_g1a_kernel:
  s_mov_b32 s8, s38
  s_mov_b32 s9, s39
  s_mov_b32 s10, 25600
  s_mov_b32 s11, 0x00020000
  s_mov_b32 s48, s40
  s_mov_b32 s49, s41
  s_mov_b32 s50, 25600
  s_mov_b32 s51, 0x00020000
  v_lshlrev_b32 v6, 4, v1
  v_add_u32 v7, 1024, v6
  s_mul_i32 s27, s20, 5
  s_mul_i32 s24, s27, 1280
  v_mul_u32_u24 v17, 40, v19
  v_lshl_add_u32 v12, v18, 3, v17
  v_add_u32 v12, 4096, v12
  v_add_u32 v12, s21, v12
  s_add_u32 m0, s25, 0
  s_nop 0
  buffer_load_dwordx4 v2, s[4:7], s23 offen lds
  s_add_u32 m0, s25, 1024
  s_nop 0
  buffer_load_dwordx4 v3, s[4:7], s23 offen lds
  s_add_u32 m0, s25, 2048
  s_nop 0
  buffer_load_dwordx4 v4, s[4:7], s23 offen lds
  s_add_u32 m0, s25, 3072
  s_nop 0
  buffer_load_dwordx4 v5, s[4:7], s23 offen lds
  s_add_u32 m0, s25, 4096
  s_nop 0
  buffer_load_dwordx4 v6, s[8:11], s24 offen lds
  s_add_u32 m0, s25, 5120
  s_nop 0
  buffer_load_dwordx4 v7, s[8:11], s24 offen lds
  s_add_u32 m0, s25, 6144
  s_nop 0
  buffer_load_dwordx4 v6, s[48:51], s24 offen lds
  s_add_u32 m0, s25, 7168
  s_nop 0
  buffer_load_dwordx4 v7, s[48:51], s24 offen lds
  s_add_u32 s24, s24, 1280
  s_add_u32 s23, s23, 64
  s_add_u32 s25, s25, 9216
  s_add_u32 s27, s21, 18432
  s_cmp_ge_u32 s25, s27
  s_cselect_b32 s25, s21, s25
L_loopkv_g1a_kernel:
  s_add_u32 m0, s25, 0
  s_nop 0
  buffer_load_dwordx4 v2, s[4:7], s23 offen lds
  s_add_u32 m0, s25, 1024
  s_nop 0
  buffer_load_dwordx4 v3, s[4:7], s23 offen lds
  s_add_u32 m0, s25, 2048
  s_nop 0
  buffer_load_dwordx4 v4, s[4:7], s23 offen lds
  s_add_u32 m0, s25, 3072
  s_nop 0
  buffer_load_dwordx4 v5, s[4:7], s23 offen lds
  s_add_u32 m0, s25, 4096
  s_nop 0
  buffer_load_dwordx4 v6, s[8:11], s24 offen lds
  s_add_u32 m0, s25, 5120
  s_nop 0
  buffer_load_dwordx4 v7, s[8:11], s24 offen lds
  s_add_u32 m0, s25, 6144
  s_nop 0
  buffer_load_dwordx4 v6, s[48:51], s24 offen lds
  s_add_u32 m0, s25, 7168
  s_nop 0
  buffer_load_dwordx4 v7, s[48:51], s24 offen lds
  s_add_u32 s24, s24, 1280
  s_add_u32 s23, s23, 64
  s_add_u32 s25, s25, 9216
  s_add_u32 s27, s21, 18432
  s_cmp_ge_u32 s25, s27
  s_cselect_b32 s25, s21, s25
  s_waitcnt vmcnt(8)
  v_add_u32 v13, s26, v11
  v_add_u32 v14, s26, v12
  ds_read_b128 v[24:27], v13 offset:0
  ds_read_b128 v[28:31], v13 offset:1024
  ds_read_b128 v[32:35], v13 offset:2048
  ds_read_b128 v[36:39], v13 offset:3072
  ds_read_b64_tr_b16 v[40:41], v14 offset:0
  ds_read_b64_tr_b16 v[42:43], v14 offset:160
  ds_read_b64_tr_b16 v[44:45], v14 offset:32
  ds_read_b64_tr_b16 v[46:47], v14 offset:192
  ds_read_b64_tr_b16 v[48:49], v14 offset:2048
  ds_read_b64_tr_b16 v[50:51], v14 offset:2208
  ds_read_b64_tr_b16 v[52:53], v14 offset:2080
  ds_read_b64_tr_b16 v[54:55], v14 offset:2240
  s_add_u32 s26, s26, 9216
  s_cmp_ge_u32 s26, 18432
  s_cselect_b32 s26, 0, s26
  s_waitcnt lgkmcnt(0)
  v_mfma_f32_16x16x32_bf16 v[60:63], v[40:43], v[24:27], v[60:63]
  v_mfma_f32_16x16x32_bf16 v[64:67], v[44:47], v[24:27], v[64:67]
  v_mfma_f32_16x16x32_bf16 v[68:71], v[48:51], v[24:27], v[68:71]
  v_mfma_f32_16x16x32_bf16 v[72:75], v[52:55], v[24:27], v[72:75]
  v_mfma_f32_16x16x32_bf16 v[80:83], v[40:43], v[28:31], v[80:83]
  v_mfma_f32_16x16x32_bf16 v[84:87], v[44:47], v[28:31], v[84:87]
  v_mfma_f32_16x16x32_bf16 v[88:91], v[48:51], v[28:31], v[88:91]
  v_mfma_f32_16x16x32_bf16 v[92:95], v[52:55], v[28:31], v[92:95]
  v_mfma_f32_16x16x32_bf16 v[100:103], v[40:43], v[32:35], v[100:103]
  v_mfma_f32_16x16x32_bf16 v[104:107], v[44:47], v[32:35], v[104:107]
  v_mfma_f32_16x16x32_bf16 v[108:111], v[48:51], v[32:35], v[108:111]
  v_mfma_f32_16x16x32_bf16 v[112:115], v[52:55], v[32:35], v[112:115]
  v_mfma_f32_16x16x32_bf16 v[120:123], v[40:43], v[36:39], v[120:123]
  v_mfma_f32_16x16x32_bf16 v[124:127], v[44:47], v[36:39], v[124:127]
  v_mfma_f32_16x16x32_bf16 v[128:131], v[48:51], v[36:39], v[128:131]
  v_mfma_f32_16x16x32_bf16 v[132:135], v[52:55], v[36:39], v[132:135]
  v_dot2_f32_bf16 v140, v24, v153, v140
  v_dot2_f32_bf16 v144, v24, v24, v144
  v_dot2_f32_bf16 v140, v25, v153, v140
  v_dot2_f32_bf16 v144, v25, v25, v144
  v_dot2_f32_bf16 v140, v26, v153, v140
  v_dot2_f32_bf16 v144, v26, v26, v144
  v_dot2_f32_bf16 v140, v27, v153, v140
  v_dot2_f32_bf16 v144, v27, v27, v144
  v_dot2_f32_bf16 v141, v28, v153, v141
  v_dot2_f32_bf16 v145, v28, v28, v145
  v_dot2_f32_bf16 v141, v29, v153, v141
  v_dot2_f32_bf16 v145, v29, v29, v145
  v_dot2_f32_bf16 v141, v30, v153, v141
  v_dot2_f32_bf16 v145, v30, v30, v145
  v_dot2_f32_bf16 v141, v31, v153, v141
  v_dot2_f32_bf16 v145, v31, v31, v145
  v_dot2_f32_bf16 v142, v32, v153, v142
  v_dot2_f32_bf16 v146, v32, v32, v146
  v_dot2_f32_bf16 v142, v33, v153, v142
  v_dot2_f32_bf16 v146, v33, v33, v146
  v_dot2_f32_bf16 v142, v34, v153, v142
  v_dot2_f32_bf16 v146, v34, v34, v146
  v_dot2_f32_bf16 v142, v35, v153, v142
  v_dot2_f32_bf16 v146, v35, v35, v146
  v_dot2_f32_bf16 v143, v36, v153, v143
  v_dot2_f32_bf16 v147, v36, v36, v147
  v_dot2_f32_bf16 v143, v37, v153, v143
  v_dot2_f32_bf16 v147, v37, v37, v147
  v_dot2_f32_bf16 v143, v38, v153, v143
  v_dot2_f32_bf16 v147, v38, v38, v147
  v_dot2_f32_bf16 v143, v39, v153, v143
  v_dot2_f32_bf16 v147, v39, v39, v147
  v_dot2_f32_bf16 v148, v40, v153, v148
  v_dot2_f32_bf16 v148, v41, v153, v148
  v_dot2_f32_bf16 v148, v42, v153, v148
  v_dot2_f32_bf16 v148, v43, v153, v148
  v_dot2_f32_bf16 v149, v44, v153, v149
  v_dot2_f32_bf16 v149, v45, v153, v149
  v_dot2_f32_bf16 v149, v46, v153, v149
  v_dot2_f32_bf16 v149, v47, v153, v149
  v_dot2_f32_bf16 v150, v48, v153, v150
  v_dot2_f32_bf16 v150, v49, v153, v150
  v_dot2_f32_bf16 v150, v50, v153, v150
  v_dot2_f32_bf16 v150, v51, v153, v150
  v_dot2_f32_bf16 v151, v52, v153, v151
  v_dot2_f32_bf16 v151, v53, v153, v151
  v_dot2_f32_bf16 v151, v54, v153, v151
  v_dot2_f32_bf16 v151, v55, v153, v151
  s_sub_u32 s22, s22, 1
  s_cmp_lg_u32 s22, 0
  s_cbranch_scc1 L_loopkv_g1a_kernel
L_red_g1a_kernel:
  s_waitcnt vmcnt(0)
  v_lshlrev_b32 v15, 4, v1
  v_add_u32 v15, s21, v15
  ds_write_b128 v15, v[60:63] offset:0
  ds_write_b128 v15, v[64:67] offset:1024
  ds_write_b128 v15, v[68:71] offset:2048
  ds_write_b128 v15, v[72:75] offset:3072
  ds_write_b128 v15, v[76:79] offset:4096
  ds_write_b128 v15, v[80:83] offset:5120
  ds_write_b128 v15, v[84:87] offset:6144
  ds_write_b128 v15, v[88:91] offset:7168
  ds_write_b128 v15, v[92:95] offset:8192
  ds_write_b128 v15, v[96:99] offset:9216
  ds_write_b128 v15, v[100:103] offset:10240
  ds_write_b128 v15, v[104:107] offset:11264
  ds_write_b128 v15, v[108:111] offset:12288
  ds_write_b128 v15, v[112:115] offset:13312
  ds_write_b128 v15, v[116:119] offset:14336
  ds_write_b128 v15, v[120:123] offset:15360
  ds_write_b128 v15, v[124:127] offset:16384
  ds_write_b128 v15, v[128:131] offset:17408
  ds_write_b128 v15, v[132:135] offset:18432
  ds_write_b128 v15, v[136:139] offset:19456
  s_mul_i32 s27, s20, 5120
  s_add_u32 s27, s27, s21
  v_lshlrev_b32 v16, 2, v1
  v_add_u32 v16, s27, v16
  ds_write_b32 v16, v140 offset:0
  ds_write_b32 v16, v141 offset:256
  ds_write_b32 v16, v142 offset:512
  ds_write_b32 v16, v143 offset:768
  ds_write_b32 v16, v144 offset:1024
  ds_write_b32 v16, v145 offset:1280
  ds_write_b32 v16, v146 offset:1536
  ds_write_b32 v16, v147 offset:1792
  ds_write_b32 v16, v148 offset:2048
  ds_write_b32 v16, v149 offset:2304
  ds_write_b32 v16, v150 offset:2560
  ds_write_b32 v16, v151 offset:2816
  ds_write_b32 v16, v152 offset:3072
  s_cmp_lg_u32 s20, 1
  s_cbranch_scc1 L_own1_g1a_kernel
  v_mov_b32 v60, v80
  v_mov_b32 v61, v81
  v_mov_b32 v62, v82
  v_mov_b32 v63, v83
  v_mov_b32 v64, v84
  v_mov_b32 v65, v85
  v_mov_b32 v66, v86
  v_mov_b32 v67, v87
  v_mov_b32 v68, v88
  v_mov_b32 v69, v89
  v_mov_b32 v70, v90
  v_mov_b32 v71, v91
  v_mov_b32 v72, v92
  v_mov_b32 v73, v93
  v_mov_b32 v74, v94
  v_mov_b32 v75, v95
  v_mov_b32 v76, v96
  v_mov_b32 v77, v97
  v_mov_b32 v78, v98
  v_mov_b32 v79, v99
L_own1_g1a_kernel:
  s_cmp_lg_u32 s20, 2
  s_cbranch_scc1 L_own2_g1a_kernel
  v_mov_b32 v60, v100
  v_mov_b32 v61, v101
  v_mov_b32 v62, v102
  v_mov_b32 v63, v103
  v_mov_b32 v64, v104
  v_mov_b32 v65, v105
  v_mov_b32 v66, v106
  v_mov_b32 v67, v107
  v_mov_b32 v68, v108
  v_mov_b32 v69, v109
  v_mov_b32 v70, v110
  v_mov_b32 v71, v111
  v_mov_b32 v72, v112
  v_mov_b32 v73, v113
  v_mov_b32 v74, v114
  v_mov_b32 v75, v115
  v_mov_b32 v76, v116
  v_mov_b32 v77, v117
  v_mov_b32 v78, v118
  v_mov_b32 v79, v119
L_own2_g1a_kernel:
  s_cmp_lg_u32 s20, 3
  s_cbranch_scc1 L_own3_g1a_kernel
  v_mov_b32 v60, v120
  v_mov_b32 v61, v121
  v_mov_b32 v62, v122
  v_mov_b32 v63, v123
  v_mov_b32 v64, v124
  v_mov_b32 v65, v125
  v_mov_b32 v66, v126
  v_mov_b32 v67, v127
  v_mov_b32 v68, v128
  v_mov_b32 v69, v129
  v_mov_b32 v70, v130
  v_mov_b32 v71, v131
  v_mov_b32 v72, v132
  v_mov_b32 v73, v133
  v_mov_b32 v74, v134
  v_mov_b32 v75, v135
  v_mov_b32 v76, v136
  v_mov_b32 v77, v137
  v_mov_b32 v78, v138
  v_mov_b32 v79, v139
L_own3_g1a_kernel:
  s_waitcnt lgkmcnt(0)
  s_barrier
  v_lshlrev_b32 v15, 4, v1
  s_mul_i32 s27, s20, 5120
  v_add_u32 v15, s27, v15
  v_add_u32 v16, 20480, v15
  v_add_u32 v17, 40960, v15
  v_add_u32 v18, 61440, v15
  s_add_u32 s27, s20, 1
  s_and_b32 s27, s27, 3
  s_mul_i32 s27, s27, 20480
  v_add_u32 v16, s27, v15
  s_add_u32 s27, s20, 2
  s_and_b32 s27, s27, 3
  s_mul_i32 s27, s27, 20480
  v_add_u32 v17, s27, v15
  s_add_u32 s27, s20, 3
  s_and_b32 s27, s27, 3
  s_mul_i32 s27, s27, 20480
  v_add_u32 v18, s27, v15
  ds_read_b128 v[80:83], v16 offset:0
  ds_read_b128 v[84:87], v16 offset:1024
  ds_read_b128 v[88:91], v16 offset:2048
  ds_read_b128 v[92:95], v16 offset:3072
  ds_read_b128 v[96:99], v16 offset:4096
  ds_read_b128 v[100:103], v17 offset:0
  ds_read_b128 v[104:107], v17 offset:1024
  ds_read_b128 v[108:111], v17 offset:2048
  ds_read_b128 v[112:115], v17 offset:3072
  ds_read_b128 v[116:119], v17 offset:4096
  ds_read_b128 v[120:123], v18 offset:0
  ds_read_b128 v[124:127], v18 offset:1024
  ds_read_b128 v[128:131], v18 offset:2048
  ds_read_b128 v[132:135], v18 offset:3072
  ds_read_b128 v[136:139], v18 offset:4096
  v_lshlrev_b32 v19, 2, v1
  s_lshl_b32 s27, s20, 8
  v_add_u32 v19, s27, v19
  v_add_u32 v20, 0, v19
  ds_read_b32 v140, v20
  ds_read_b32 v144, v20 offset:1024
  v_add_u32 v20, 25600, v19
  ds_read_b32 v141, v20
  ds_read_b32 v145, v20 offset:1024
  v_add_u32 v20, 51200, v19
  ds_read_b32 v142, v20
  ds_read_b32 v146, v20 offset:1024
  v_add_u32 v20, 76800, v19
  ds_read_b32 v143, v20
  ds_read_b32 v147, v20 offset:1024
  v_lshlrev_b32 v19, 2, v1
  v_add_u32 v20, 2048, v19
  ds_read_b32 v40, v20 offset:0
  ds_read_b32 v41, v20 offset:256
  ds_read_b32 v42, v20 offset:512
  ds_read_b32 v43, v20 offset:768
  ds_read_b32 v44, v20 offset:1024
  v_add_u32 v20, 27648, v19
  ds_read_b32 v45, v20 offset:0
  ds_read_b32 v46, v20 offset:256
  ds_read_b32 v47, v20 offset:512
  ds_read_b32 v48, v20 offset:768
  ds_read_b32 v49, v20 offset:1024
  v_add_u32 v20, 53248, v19
  ds_read_b32 v50, v20 offset:0
  ds_read_b32 v51, v20 offset:256
  ds_read_b32 v52, v20 offset:512
  ds_read_b32 v53, v20 offset:768
  ds_read_b32 v54, v20 offset:1024
  v_add_u32 v20, 78848, v19
  ds_read_b32 v55, v20 offset:0
  ds_read_b32 v56, v20 offset:256
  ds_read_b32 v57, v20 offset:512
  ds_read_b32 v58, v20 offset:768
  ds_read_b32 v59, v20 offset:1024
  s_waitcnt lgkmcnt(0)
  v_add_f32 v60, v60, v80
  v_add_f32 v61, v61, v81
  v_add_f32 v62, v62, v82
  v_add_f32 v63, v63, v83
  v_add_f32 v64, v64, v84
  v_add_f32 v65, v65, v85
  v_add_f32 v66, v66, v86
  v_add_f32 v67, v67, v87
  v_add_f32 v68, v68, v88
  v_add_f32 v69, v69, v89
  v_add_f32 v70, v70, v90
  v_add_f32 v71, v71, v91
  v_add_f32 v72, v72, v92
  v_add_f32 v73, v73, v93
  v_add_f32 v74, v74, v94
  v_add_f32 v75, v75, v95
  v_add_f32 v76, v76, v96
  v_add_f32 v77, v77, v97
  v_add_f32 v78, v78, v98
  v_add_f32 v79, v79, v99
  v_add_f32 v60, v60, v100
  v_add_f32 v61, v61, v101
  v_add_f32 v62, v62, v102
  v_add_f32 v63, v63, v103
  v_add_f32 v64, v64, v104
  v_add_f32 v65, v65, v105
  v_add_f32 v66, v66, v106
  v_add_f32 v67, v67, v107
  v_add_f32 v68, v68, v108
  v_add_f32 v69, v69, v109
  v_add_f32 v70, v70, v110
  v_add_f32 v71, v71, v111
  v_add_f32 v72, v72, v112
  v_add_f32 v73, v73, v113
  v_add_f32 v74, v74, v114
  v_add_f32 v75, v75, v115
  v_add_f32 v76, v76, v116
  v_add_f32 v77, v77, v117
  v_add_f32 v78, v78, v118
  v_add_f32 v79, v79, v119
  v_add_f32 v60, v60, v120
  v_add_f32 v61, v61, v121
  v_add_f32 v62, v62, v122
  v_add_f32 v63, v63, v123
  v_add_f32 v64, v64, v124
  v_add_f32 v65, v65, v125
  v_add_f32 v66, v66, v126
  v_add_f32 v67, v67, v127
  v_add_f32 v68, v68, v128
  v_add_f32 v69, v69, v129
  v_add_f32 v70, v70, v130
  v_add_f32 v71, v71, v131
  v_add_f32 v72, v72, v132
  v_add_f32 v73, v73, v133
  v_add_f32 v74, v74, v134
  v_add_f32 v75, v75, v135
  v_add_f32 v76, v76, v136
  v_add_f32 v77, v77, v137
  v_add_f32 v78, v78, v138
  v_add_f32 v79, v79, v139
  v_add_f32 v140, v140, v141
  v_add_f32 v142, v142, v143
  v_add_f32 v140, v140, v142
  v_add_f32 v144, v144, v145
  v_add_f32 v146, v146, v147
  v_add_f32 v144, v144, v146
  v_mov_b32 v104, v140
  s_nop 1
  v_permlane16_swap_b32 v140, v104
  v_add_f32 v140, v140, v104
  v_mov_b32 v104, v140
  s_nop 1
  v_permlane32_swap_b32 v140, v104
  v_add_f32 v140, v140, v104
  v_mov_b32 v104, v144
  s_nop 1
  v_permlane16_swap_b32 v144, v104
  v_add_f32 v144, v144, v104
  v_mov_b32 v104, v144
  s_nop 1
  v_permlane32_swap_b32 v144, v104
  v_add_f32 v144, v144, v104
  v_add_f32 v40, v40, v45
  v_add_f32 v50, v50, v55
  v_add_f32 v40, v40, v50
  v_mov_b32 v104, v40
  s_nop 1
  v_permlane16_swap_b32 v40, v104
  v_add_f32 v40, v40, v104
  v_mov_b32 v104, v40
  s_nop 1
  v_permlane32_swap_b32 v40, v104
  v_add_f32 v40, v40, v104
  v_add_f32 v41, v41, v46
  v_add_f32 v51, v51, v56
  v_add_f32 v41, v41, v51
  v_mov_b32 v104, v41
  s_nop 1
  v_permlane16_swap_b32 v41, v104
  v_add_f32 v41, v41, v104
  v_mov_b32 v104, v41
  s_nop 1
  v_permlane32_swap_b32 v41, v104
  v_add_f32 v41, v41, v104
  v_add_f32 v42, v42, v47
  v_add_f32 v52, v52, v57
  v_add_f32 v42, v42, v52
  v_mov_b32 v104, v42
  s_nop 1
  v_permlane16_swap_b32 v42, v104
  v_add_f32 v42, v42, v104
  v_mov_b32 v104, v42
  s_nop 1
  v_permlane32_swap_b32 v42, v104
  v_add_f32 v42, v42, v104
  v_add_f32 v43, v43, v48
  v_add_f32 v53, v53, v58
  v_add_f32 v43, v43, v53
  v_mov_b32 v104, v43
  s_nop 1
  v_permlane16_swap_b32 v43, v104
  v_add_f32 v43, v43, v104
  v_mov_b32 v104, v43
  s_nop 1
  v_permlane32_swap_b32 v43, v104
  v_add_f32 v43, v43, v104
  v_add_f32 v44, v44, v49
  v_add_f32 v54, v54, v59
  v_add_f32 v44, v44, v54
  v_mov_b32 v104, v44
  s_nop 1
  v_permlane16_swap_b32 v44, v104
  v_add_f32 v44, v44, v104
  v_mov_b32 v104, v44
  s_nop 1
  v_permlane32_swap_b32 v44, v104
  v_add_f32 v44, v44, v104
  v_lshrrev_b32 v104, 4, v1
  v_lshlrev_b32 v104, 4, v104
  v_add_u32 v105, 0, v104
  ds_bpermute_b32 v84, v105, v40
  v_add_u32 v105, 4, v104
  ds_bpermute_b32 v85, v105, v40
  v_add_u32 v105, 8, v104
  ds_bpermute_b32 v86, v105, v40
  v_add_u32 v105, 12, v104
  ds_bpermute_b32 v87, v105, v40
  v_add_u32 v105, 0, v104
  ds_bpermute_b32 v88, v105, v41
  v_add_u32 v105, 4, v104
  ds_bpermute_b32 v89, v105, v41
  v_add_u32 v105, 8, v104
  ds_bpermute_b32 v90, v105, v41
  v_add_u32 v105, 12, v104
  ds_bpermute_b32 v91, v105, v41
  v_add_u32 v105, 0, v104
  ds_bpermute_b32 v92, v105, v42
  v_add_u32 v105, 4, v104
  ds_bpermute_b32 v93, v105, v42
  v_add_u32 v105, 8, v104
  ds_bpermute_b32 v94, v105, v42
  v_add_u32 v105, 12, v104
  ds_bpermute_b32 v95, v105, v42
  v_add_u32 v105, 0, v104
  ds_bpermute_b32 v96, v105, v43
  v_add_u32 v105, 4, v104
  ds_bpermute_b32 v97, v105, v43
  v_add_u32 v105, 8, v104
  ds_bpermute_b32 v98, v105, v43
  v_add_u32 v105, 12, v104
  ds_bpermute_b32 v99, v105, v43
  v_add_u32 v105, 0, v104
  ds_bpermute_b32 v100, v105, v44
  v_add_u32 v105, 4, v104
  ds_bpermute_b32 v101, v105, v44
  v_add_u32 v105, 8, v104
  ds_bpermute_b32 v102, v105, v44
  v_add_u32 v105, 12, v104
  ds_bpermute_b32 v103, v105, v44
  v_mul_f32 v80, 0x3acccccd, v140
  v_mul_f32 v106, 0x3acccccd, v144
  v_fma_f32 v106, -v80, v80, v106
  v_max_f32 v106, 0, v106
  v_cvt_pk_bf16_f32 v107, v106, v106
  v_lshlrev_b32 v106, 16, v107
  v_add_f32 v106, 0x3727c5ac, v106
  v_cvt_pk_bf16_f32 v107, v106, v106
  v_lshlrev_b32 v106, 16, v107
  v_sqrt_f32 v106, v106
  s_nop 0
  v_cvt_pk_bf16_f32 v107, v106, v106
  v_lshlrev_b32 v106, 16, v107
  v_rcp_f32 v81, v106
  v_cvt_pk_bf16_f32 v107, v80, v80
  v_lshlrev_b32 v80, 16, v107
  s_waitcnt lgkmcnt(0)
  v_fma_f32 v60, -v80, v84, v60
  v_mul_f32 v60, v60, v81
  v_fma_f32 v61, -v80, v85, v61
  v_mul_f32 v61, v61, v81
  v_fma_f32 v62, -v80, v86, v62
  v_mul_f32 v62, v62, v81
  v_fma_f32 v63, -v80, v87, v63
  v_mul_f32 v63, v63, v81
  v_fma_f32 v64, -v80, v88, v64
  v_mul_f32 v64, v64, v81
  v_fma_f32 v65, -v80, v89, v65
  v_mul_f32 v65, v65, v81
  v_fma_f32 v66, -v80, v90, v66
  v_mul_f32 v66, v66, v81
  v_fma_f32 v67, -v80, v91, v67
  v_mul_f32 v67, v67, v81
  v_fma_f32 v68, -v80, v92, v68
  v_mul_f32 v68, v68, v81
  v_fma_f32 v69, -v80, v93, v69
  v_mul_f32 v69, v69, v81
  v_fma_f32 v70, -v80, v94, v70
  v_mul_f32 v70, v70, v81
  v_fma_f32 v71, -v80, v95, v71
  v_mul_f32 v71, v71, v81
  v_fma_f32 v72, -v80, v96, v72
  v_mul_f32 v72, v72, v81
  v_fma_f32 v73, -v80, v97, v73
  v_mul_f32 v73, v73, v81
  v_fma_f32 v74, -v80, v98, v74
  v_mul_f32 v74, v74, v81
  v_fma_f32 v75, -v80, v99, v75
  v_mul_f32 v75, v75, v81
  v_fma_f32 v76, -v80, v100, v76
  v_mul_f32 v76, v76, v81
  v_fma_f32 v77, -v80, v101, v77
  v_mul_f32 v77, v77, v81
  v_fma_f32 v78, -v80, v102, v78
  v_mul_f32 v78, v78, v81
  v_fma_f32 v79, -v80, v103, v79
  v_mul_f32 v79, v79, v81
  v_and_b32 v15, 15, v1
  s_lshl_b32 s27, s20, 4
  s_add_u32 s27, s27, s28
  v_add_u32 v15, s27, v15
  v_lshrrev_b32 v16, 4, v1
  s_cmp_eq_u32 s30, 8
  s_cbranch_scc1 L_epikv_g1a_kernel
  v_mov_b32 v104, 0x3ea52b5c
  v_mul_f32 v60, v60, v104
  v_mul_f32 v61, v61, v104
  v_mul_f32 v62, v62, v104
  v_mul_f32 v63, v63, v104
  v_mul_f32 v64, v64, v104
  v_mul_f32 v65, v65, v104
  v_mul_f32 v66, v66, v104
  v_mul_f32 v67, v67, v104
  v_mul_f32 v68, v68, v104
  v_mul_f32 v69, v69, v104
  v_mul_f32 v70, v70, v104
  v_mul_f32 v71, v71, v104
  v_mul_f32 v72, v72, v104
  v_mul_f32 v73, v73, v104
  v_mul_f32 v74, v74, v104
  v_mul_f32 v75, v75, v104
  v_mul_f32 v76, v76, v104
  v_mul_f32 v77, v77, v104
  v_mul_f32 v78, v78, v104
  v_mul_f32 v79, v79, v104
  v_mul_u32_u24 v17, 1280, v15
  v_lshl_add_u32 v17, v16, 3, v17
  s_lshl_b32 s27, s29, 1
  v_add_u32 v17, s27, v17
  v_cvt_pk_bf16_f32 v124, v60, v61
  v_cvt_pk_bf16_f32 v125, v62, v63
  buffer_store_dwordx2 v[124:125], v17, s[12:15], 0 offen offset:0
  v_cvt_pk_bf16_f32 v126, v64, v65
  v_cvt_pk_bf16_f32 v127, v66, v67
  buffer_store_dwordx2 v[126:127], v17, s[12:15], 0 offen offset:32
  v_cvt_pk_bf16_f32 v128, v68, v69
  v_cvt_pk_bf16_f32 v129, v70, v71
  buffer_store_dwordx2 v[128:129], v17, s[12:15], 0 offen offset:64
  v_cvt_pk_bf16_f32 v130, v72, v73
  v_cvt_pk_bf16_f32 v131, v74, v75
  buffer_store_dwordx2 v[130:131], v17, s[12:15], 0 offen offset:96
  v_cvt_pk_bf16_f32 v132, v76, v77
  v_cvt_pk_bf16_f32 v133, v78, v79
  buffer_store_dwordx2 v[132:133], v17, s[12:15], 0 offen offset:128
  s_branch L_end_g1a_kernel
L_epikv_g1a_kernel:
  s_add_u32 s42, s32, 12582912
  s_addc_u32 s43, s33, 0
  s_mov_b32 s12, s42
  s_mov_b32 s13, s43
  s_mov_b32 s14, 262144
  s_mov_b32 s15, 0x00020000
  v_cmp_eq_u32 vcc, 1, v16
  s_nop 1
  v_cndmask_b32 v104, 0, 1.0, vcc
  v_cmp_eq_u32 vcc, 0, v16
  s_nop 1
  v_cndmask_b32 v64, v104, v64, vcc
  v_cndmask_b32 v65, 0, v65, vcc
  v_cndmask_b32 v66, 0, v66, vcc
  v_cndmask_b32 v67, 0, v67, vcc
  v_cndmask_b32 v72, v104, v72, vcc
  v_cndmask_b32 v73, 0, v73, vcc
  v_cndmask_b32 v74, 0, v74, vcc
  v_cndmask_b32 v75, 0, v75, vcc
  v_lshrrev_b32 v17, 5, v15
  v_lshlrev_b32 v17, 12, v17
  v_and_b32 v18, 31, v15
  v_lshrrev_b32 v19, 1, v16
  v_lshl_add_u32 v19, v19, 5, v18
  v_lshl_add_u32 v19, v19, 4, v17
  v_and_b32 v20, 1, v16
  v_lshl_add_u32 v19, v20, 3, v19
  v_cvt_pk_bf16_f32 v124, v60, v61
  v_cvt_pk_bf16_f32 v125, v62, v63
  buffer_store_dwordx2 v[124:125], v19, s[12:15], 0 offen offset:0
  v_cvt_pk_bf16_f32 v126, v64, v65
  v_cvt_pk_bf16_f32 v127, v66, v67
  buffer_store_dwordx2 v[126:127], v19, s[12:15], 0 offen offset:1024
  v_lshrrev_b32 v19, 4, v18
  v_lshl_add_u32 v19, v19, 10, v17
  v_add_u32 v19, 2048, v19
  v_lshrrev_b32 v20, 2, v18
  v_and_b32 v20, 1, v20
  v_lshl_add_u32 v19, v20, 9, v19
  v_lshrrev_b32 v20, 3, v18
  v_and_b32 v20, 1, v20
  v_and_b32 v21, 3, v18
  v_lshl_add_u32 v20, v20, 2, v21
  v_lshl_add_u32 v19, v20, 1, v19
  v_lshl_add_u32 v19, v16, 6, v19
  v_cvt_pk_bf16_f32 v106, v68, v68
  buffer_store_short v106, v19, s[12:15], 0 offen offset:0
  v_cvt_pk_bf16_f32 v106, v69, v69
  buffer_store_short v106, v19, s[12:15], 0 offen offset:16
  v_cvt_pk_bf16_f32 v106, v70, v70
  buffer_store_short v106, v19, s[12:15], 0 offen offset:32
  v_cvt_pk_bf16_f32 v106, v71, v71
  buffer_store_short v106, v19, s[12:15], 0 offen offset:48
  v_cvt_pk_bf16_f32 v106, v72, v72
  buffer_store_short v106, v19, s[12:15], 0 offen offset:256
  v_cvt_pk_bf16_f32 v106, v73, v73
  buffer_store_short v106, v19, s[12:15], 0 offen offset:272
  v_cvt_pk_bf16_f32 v106, v74, v74
  buffer_store_short v106, v19, s[12:15], 0 offen offset:288
  v_cvt_pk_bf16_f32 v106, v75, v75
  buffer_store_short v106, v19, s[12:15], 0 offen offset:304
L_end_g1a_kernel:
  s_endpgm
.globl att_kernel
.p2align 8
.type att_kernel,@function
att_kernel:
  s_cmp_ge_u32 s2, 256
  s_cbranch_scc1 L_end_att_kernel
  s_load_dwordx2 s[32:33], s[0:1], 88
  v_lshrrev_b32 v2, 6, v0
  v_and_b32 v1, 63, v0
  v_readfirstlane_b32 s20, v2
  s_and_b32 s23, s2, 7
  s_lshr_b32 s24, s2, 3
  s_and_b32 s22, s24, 3
  s_lshr_b32 s24, s24, 2
  s_lshl_b32 s23, s23, 2
  s_add_u32 s23, s23, s22
  s_lshl_b32 s24, s24, 2
  s_and_b32 s22, s20, 3
  s_add_u32 s24, s24, s22
  s_lshr_b32 s21, s20, 2
  s_and_b32 s22, s20, 3
  s_lshl_b32 s28, s22, 12
  s_mul_i32 s29, s21, 131072
  s_add_u32 s28, s28, s29
  s_mul_i32 s26, s21, 65536
  s_lshl_b32 s22, s22, 12
  s_add_u32 s26, s26, s22
  v_lshlrev_b32 v12, 4, v1
  s_mul_i32 s22, s21, 65536
  v_lshlrev_b32 v13, 4, v1
  v_add_u32 v13, s22, v13
  s_waitcnt lgkmcnt(0)
  s_add_u32 s34, s32, 12582912
  s_addc_u32 s35, s33, 0
  s_mov_b32 s8, s34
  s_mov_b32 s9, s35
  s_mov_b32 s10, 262144
  s_mov_b32 s11, 0x00020000
  s_add_u32 m0, s26, 0
  s_nop 0
  buffer_load_dwordx4 v12, s[8:11], s28 offen offset:0 lds
  buffer_load_dwordx4 v12, s[8:11], s28 offen offset:1024 lds
  buffer_load_dwordx4 v12, s[8:11], s28 offen offset:2048 lds
  buffer_load_dwordx4 v12, s[8:11], s28 offen offset:3072 lds
  s_add_u32 s28, s28, 16384
  s_add_u32 m0, s26, 16384
  s_nop 0
  buffer_load_dwordx4 v12, s[8:11], s28 offen offset:0 lds
  buffer_load_dwordx4 v12, s[8:11], s28 offen offset:1024 lds
  buffer_load_dwordx4 v12, s[8:11], s28 offen offset:2048 lds
  buffer_load_dwordx4 v12, s[8:11], s28 offen offset:3072 lds
  s_add_u32 s28, s28, 16384
  s_add_u32 s34, s32, 0
  s_addc_u32 s35, s33, 0
  s_mov_b32 s4, s34
  s_mov_b32 s5, s35
  s_mov_b32 s6, 2621440
  s_mov_b32 s7, 0x00020000
  s_add_u32 s34, s32, 3145728
  s_addc_u32 s35, s33, 0
  s_mov_b32 s12, s34
  s_mov_b32 s13, s35
  s_mov_b32 s14, 2621440
  s_mov_b32 s15, 0x00020000
  v_and_b32 v2, 31, v1
  s_lshl_b32 s22, s23, 6
  v_add_u32 v2, s22, v2
  v_mul_u32_u24 v2, 1280, v2
  v_lshrrev_b32 v3, 5, v1
  v_lshl_add_u32 v2, v3, 4, v2
  s_mul_i32 s22, s24, 40
  v_add_u32 v2, s22, v2
  v_add_u32 v4, 40960, v2
  buffer_load_dwordx4 v[16:19], v2, s[4:7], 0 offen
  buffer_load_dwordx4 v[24:27], v4, s[4:7], 0 offen
  buffer_load_dwordx2 v[20:21], v2, s[4:7], 0 offen offset:32
  buffer_load_dwordx2 v[28:29], v4, s[4:7], 0 offen offset:32
  buffer_load_dwordx4 v[32:35], v12, s[8:11], 0 offen offset:0
  buffer_load_dwordx4 v[36:39], v12, s[8:11], 0 offen offset:1024
  s_add_u32 m0, s26, 32768
  s_nop 0
  buffer_load_dwordx4 v12, s[8:11], s28 offen offset:0 lds
  buffer_load_dwordx4 v12, s[8:11], s28 offen offset:1024 lds
  buffer_load_dwordx4 v12, s[8:11], s28 offen offset:2048 lds
  buffer_load_dwordx4 v12, s[8:11], s28 offen offset:3072 lds
  s_add_u32 s28, s28, 16384
  s_add_u32 m0, s26, 49152
  s_nop 0
  buffer_load_dwordx4 v12, s[8:11], s28 offen offset:0 lds
  buffer_load_dwordx4 v12, s[8:11], s28 offen offset:1024 lds
  buffer_load_dwordx4 v12, s[8:11], s28 offen offset:2048 lds
  buffer_load_dwordx4 v12, s[8:11], s28 offen offset:3072 lds
  s_add_u32 s28, s28, 16384
  v_mov_b32 v22, 0
  v_mov_b32 v23, 0
  v_mov_b32 v30, 0
  v_mov_b32 v31, 0
  v_mov_b32 v160, 0
  v_mov_b32 v161, 0
  v_mov_b32 v162, 0
  v_mov_b32 v163, 0
  v_mov_b32 v164, 0
  v_mov_b32 v165, 0
  v_mov_b32 v166, 0
  v_mov_b32 v167, 0
  v_mov_b32 v168, 0
  v_mov_b32 v169, 0
  v_mov_b32 v170, 0
  v_mov_b32 v171, 0
  v_mov_b32 v172, 0
  v_mov_b32 v173, 0
  v_mov_b32 v174, 0
  v_mov_b32 v175, 0
  v_mov_b32 v176, 0
  v_mov_b32 v177, 0
  v_mov_b32 v178, 0
  v_mov_b32 v179, 0
  v_mov_b32 v180, 0
  v_mov_b32 v181, 0
  v_mov_b32 v182, 0
  v_mov_b32 v183, 0
  v_mov_b32 v184, 0
  v_mov_b32 v185, 0
  v_mov_b32 v186, 0
  v_mov_b32 v187, 0
  v_mov_b32 v188, 0
  v_mov_b32 v189, 0
  v_mov_b32 v190, 0
  v_mov_b32 v191, 0
  v_cmp_gt_u32 vcc, 32, v1
  s_waitcnt vmcnt(8)
  s_nop 0
  v_cndmask_b32 v20, 0, v20, vcc
  v_cndmask_b32 v21, 0, v21, vcc
  v_cndmask_b32 v28, 0, v28, vcc
  v_cndmask_b32 v29, 0, v29, vcc
  v_mfma_f32_32x32x16_bf16 v[64:79], v[32:35], v[16:19], 0
  v_mfma_f32_32x32x16_bf16 v[64:79], v[36:39], v[20:23], v[64:79]
  v_mfma_f32_32x32x16_bf16 v[80:95], v[32:35], v[24:27], 0
  v_mfma_f32_32x32x16_bf16 v[80:95], v[36:39], v[28:31], v[80:95]
  s_nop 9
  v_max3_f32 v6, v64, v65, v66
  v_max3_f32 v6, v6, v67, v68
  v_max3_f32 v6, v6, v69, v70
  v_max3_f32 v6, v6, v71, v72
  v_max3_f32 v6, v6, v73, v74
  v_max3_f32 v6, v6, v75, v76
  v_max3_f32 v6, v6, v77, v78
  v_max_f32 v6, v6, v79
  v_mov_b32 v8, v6
  s_nop 1
  v_permlane32_swap_b32 v6, v8
  v_max_f32 v6, v6, v8
  v_sub_f32 v6, 0, v6
  v_cvt_pk_bf16_f32 v6, v6, v6
  v_and_b32 v6, 0xffff, v6
  v_cndmask_b32 v22, 0, v6, vcc
  v_max3_f32 v7, v80, v81, v82
  v_max3_f32 v7, v7, v83, v84
  v_max3_f32 v7, v7, v85, v86
  v_max3_f32 v7, v7, v87, v88
  v_max3_f32 v7, v7, v89, v90
  v_max3_f32 v7, v7, v91, v92
  v_max3_f32 v7, v7, v93, v94
  v_max_f32 v7, v7, v95
  v_mov_b32 v8, v7
  s_nop 1
  v_permlane32_swap_b32 v7, v8
  v_max_f32 v7, v7, v8
  v_sub_f32 v7, 0, v7
  v_cvt_pk_bf16_f32 v7, v7, v7
  v_and_b32 v7, 0xffff, v7
  v_cndmask_b32 v30, 0, v7, vcc
  s_mov_b32 s30, 0
L_retry_att_kernel:
  s_waitcnt vmcnt(12)
  s_barrier
  ds_read_b128 v[32:35], v13 offset:0
  ds_read_b128 v[36:39], v13 offset:1024
  ds_read_b128 v[40:43], v13 offset:4096
  ds_read_b128 v[44:47], v13 offset:5120
  s_waitcnt lgkmcnt(2)
  v_mfma_f32_32x32x16_bf16 v[64:79], v[32:35], v[16:19], 0
  v_mfma_f32_32x32x16_bf16 v[64:79], v[36:39], v[20:23], v[64:79]
  v_mfma_f32_32x32x16_bf16 v[80:95], v[32:35], v[24:27], 0
  v_mfma_f32_32x32x16_bf16 v[80:95], v[36:39], v[28:31], v[80:95]
  ds_read_b128 v[32:35], v13 offset:8192
  ds_read_b128 v[36:39], v13 offset:9216
  ds_read_b128 v[48:51], v13 offset:2048
  ds_read_b128 v[52:55], v13 offset:3072
  s_waitcnt lgkmcnt(4)
  v_mfma_f32_32x32x16_bf16 v[96:111], v[40:43], v[16:19], 0
  s_nop 3
  v_exp_f32 v64, v64
  v_exp_f32 v65, v65
  v_exp_f32 v66, v66
  v_exp_f32 v67, v67
  v_exp_f32 v68, v68
  v_exp_f32 v69, v69
  v_exp_f32 v70, v70
  v_exp_f32 v71, v71
  v_exp_f32 v72, v72
  v_exp_f32 v73, v73
  v_exp_f32 v74, v74
  v_exp_f32 v75, v75
  v_mfma_f32_32x32x16_bf16 v[96:111], v[44:47], v[20:23], v[96:111]
  v_exp_f32 v76, v76
  v_exp_f32 v77, v77
  v_exp_f32 v78, v78
  v_exp_f32 v79, v79
  v_cvt_pk_bf16_f32 v128, v64, v65
  v_cvt_pk_bf16_f32 v129, v66, v67
  v_cvt_pk_bf16_f32 v130, v68, v69
  v_cvt_pk_bf16_f32 v131, v70, v71
  v_cvt_pk_bf16_f32 v132, v72, v73
  v_cvt_pk_bf16_f32 v133, v74, v75
  v_cvt_pk_bf16_f32 v134, v76, v77
  v_cvt_pk_bf16_f32 v135, v78, v79
  v_mfma_f32_32x32x16_bf16 v[112:127], v[40:43], v[24:27], 0
  v_exp_f32 v80, v80
  v_exp_f32 v81, v81
  v_exp_f32 v82, v82
  v_exp_f32 v83, v83
  v_exp_f32 v84, v84
  v_exp_f32 v85, v85
  v_exp_f32 v86, v86
  v_exp_f32 v87, v87
  v_exp_f32 v88, v88
  v_exp_f32 v89, v89
  v_exp_f32 v90, v90
  v_exp_f32 v91, v91
  v_mfma_f32_32x32x16_bf16 v[112:127], v[44:47], v[28:31], v[112:127]
  v_exp_f32 v92, v92
  v_exp_f32 v93, v93
  v_exp_f32 v94, v94
  v_exp_f32 v95, v95
  v_cvt_pk_bf16_f32 v136, v80, v81
  v_cvt_pk_bf16_f32 v137, v82, v83
  v_cvt_pk_bf16_f32 v138, v84, v85
  v_cvt_pk_bf16_f32 v139, v86, v87
  v_cvt_pk_bf16_f32 v140, v88, v89
  v_cvt_pk_bf16_f32 v141, v90, v91
  v_cvt_pk_bf16_f32 v142, v92, v93
  v_cvt_pk_bf16_f32 v143, v94, v95
  ds_read_b128 v[40:43], v13 offset:12288
  ds_read_b128 v[44:47], v13 offset:13312
  ds_read_b128 v[56:59], v13 offset:6144
  ds_read_b128 v[60:63], v13 offset:7168
  s_waitcnt lgkmcnt(4)
  v_mfma_f32_32x32x16_bf16 v[64:79], v[32:35], v[16:19], 0
  v_exp_f32 v96, v96
  v_exp_f32 v97, v97
  v_exp_f32 v98, v98
  v_exp_f32 v99, v99
  v_exp_f32 v100, v100
  v_exp_f32 v101, v101
  v_mfma_f32_32x32x16_bf16 v[64:79], v[36:39], v[20:23], v[64:79]
  v_exp_f32 v102, v102
  v_exp_f32 v103, v103
  v_exp_f32 v104, v104
  v_exp_f32 v105, v105
  v_exp_f32 v106, v106
  v_exp_f32 v107, v107
  v_mfma_f32_32x32x16_bf16 v[80:95], v[32:35], v[24:27], 0
  v_exp_f32 v108, v108
  v_exp_f32 v109, v109
  v_exp_f32 v110, v110
  v_exp_f32 v111, v111
  v_cvt_pk_bf16_f32 v144, v96, v97
  v_cvt_pk_bf16_f32 v145, v98, v99
  v_mfma_f32_32x32x16_bf16 v[80:95], v[36:39], v[28:31], v[80:95]
  v_cvt_pk_bf16_f32 v146, v100, v101
  v_cvt_pk_bf16_f32 v147, v102, v103
  v_cvt_pk_bf16_f32 v148, v104, v105
  v_cvt_pk_bf16_f32 v149, v106, v107
  v_cvt_pk_bf16_f32 v150, v108, v109
  v_cvt_pk_bf16_f32 v151, v110, v111
  v_mfma_f32_32x32x16_bf16 v[160:175], v[48:51], v[128:131], v[160:175]
  v_exp_f32 v112, v112
  v_exp_f32 v113, v113
  v_exp_f32 v114, v114
  v_exp_f32 v115, v115
  v_exp_f32 v116, v116
  v_exp_f32 v117, v117
  v_mfma_f32_32x32x16_bf16 v[160:175], v[52:55], v[132:135], v[160:175]
  v_exp_f32 v118, v118
  v_exp_f32 v119, v119
  v_exp_f32 v120, v120
  v_exp_f32 v121, v121
  v_exp_f32 v122, v122
  v_exp_f32 v123, v123
  v_mfma_f32_32x32x16_bf16 v[176:191], v[48:51], v[136:139], v[176:191]
  v_exp_f32 v124, v124
  v_exp_f32 v125, v125
  v_exp_f32 v126, v126
  v_exp_f32 v127, v127
  v_cvt_pk_bf16_f32 v152, v112, v113
  v_cvt_pk_bf16_f32 v153, v114, v115
  v_mfma_f32_32x32x16_bf16 v[176:191], v[52:55], v[140:143], v[176:191]
  v_cvt_pk_bf16_f32 v154, v116, v117
  v_cvt_pk_bf16_f32 v155, v118, v119
  v_cvt_pk_bf16_f32 v156, v120, v121
  v_cvt_pk_bf16_f32 v157, v122, v123
  v_cvt_pk_bf16_f32 v158, v124, v125
  v_cvt_pk_bf16_f32 v159, v126, v127
  s_waitcnt vmcnt(8)
  s_barrier
  ds_read_b128 v[32:35], v13 offset:16384
  ds_read_b128 v[36:39], v13 offset:17408
  ds_read_b128 v[48:51], v13 offset:10240
  ds_read_b128 v[52:55], v13 offset:11264
  s_waitcnt lgkmcnt(4)
  v_mfma_f32_32x32x16_bf16 v[96:111], v[40:43], v[16:19], 0
  v_exp_f32 v64, v64
  v_exp_f32 v65, v65
  v_exp_f32 v66, v66
  v_exp_f32 v67, v67
  v_exp_f32 v68, v68
  v_exp_f32 v69, v69
  v_mfma_f32_32x32x16_bf16 v[96:111], v[44:47], v[20:23], v[96:111]
  v_exp_f32 v70, v70
  v_exp_f32 v71, v71
  v_exp_f32 v72, v72
  v_exp_f32 v73, v73
  v_exp_f32 v74, v74
  v_exp_f32 v75, v75
  v_mfma_f32_32x32x16_bf16 v[112:127], v[40:43], v[24:27], 0
  v_exp_f32 v76, v76
  v_exp_f32 v77, v77
  v_exp_f32 v78, v78
  v_exp_f32 v79, v79
  v_cvt_pk_bf16_f32 v128, v64, v65
  v_cvt_pk_bf16_f32 v129, v66, v67
  v_mfma_f32_32x32x16_bf16 v[112:127], v[44:47], v[28:31], v[112:127]
  v_cvt_pk_bf16_f32 v130, v68, v69
  v_cvt_pk_bf16_f32 v131, v70, v71
  v_cvt_pk_bf16_f32 v132, v72, v73
  v_cvt_pk_bf16_f32 v133, v74, v75
  v_cvt_pk_bf16_f32 v134, v76, v77
  v_cvt_pk_bf16_f32 v135, v78, v79
  v_mfma_f32_32x32x16_bf16 v[160:175], v[56:59], v[144:147], v[160:175]
  v_exp_f32 v80, v80
  v_exp_f32 v81, v81
  v_exp_f32 v82, v82
  v_exp_f32 v83, v83
  v_exp_f32 v84, v84
  v_exp_f32 v85, v85
  v_mfma_f32_32x32x16_bf16 v[160:175], v[60:63], v[148:151], v[160:175]
  v_exp_f32 v86, v86
  v_exp_f32 v87, v87
  v_exp_f32 v88, v88
  v_exp_f32 v89, v89
  v_exp_f32 v90, v90
  v_exp_f32 v91, v91
  v_mfma_f32_32x32x16_bf16 v[176:191], v[56:59], v[152:155], v[176:191]
  v_exp_f32 v92, v92
  v_exp_f32 v93, v93
  v_exp_f32 v94, v94
  v_exp_f32 v95, v95
  v_cvt_pk_bf16_f32 v136, v80, v81
  v_cvt_pk_bf16_f32 v137, v82, v83
  v_mfma_f32_32x32x16_bf16 v[176:191], v[60:63], v[156:159], v[176:191]
  v_cvt_pk_bf16_f32 v138, v84, v85
  v_cvt_pk_bf16_f32 v139, v86, v87
  v_cvt_pk_bf16_f32 v140, v88, v89
  v_cvt_pk_bf16_f32 v141, v90, v91
  v_cvt_pk_bf16_f32 v142, v92, v93
  v_cvt_pk_bf16_f32 v143, v94, v95
  ds_read_b128 v[40:43], v13 offset:20480
  ds_read_b128 v[44:47], v13 offset:21504
  ds_read_b128 v[56:59], v13 offset:14336
  ds_read_b128 v[60:63], v13 offset:15360
  s_waitcnt lgkmcnt(4)
  v_mfma_f32_32x32x16_bf16 v[64:79], v[32:35], v[16:19], 0
  v_exp_f32 v96, v96
  v_exp_f32 v97, v97
  v_exp_f32 v98, v98
  v_exp_f32 v99, v99
  v_exp_f32 v100, v100
  v_exp_f32 v101, v101
  v_mfma_f32_32x32x16_bf16 v[64:79], v[36:39], v[20:23], v[64:79]
  v_exp_f32 v102, v102
  v_exp_f32 v103, v103
  v_exp_f32 v104, v104
  v_exp_f32 v105, v105
  v_exp_f32 v106, v106
  v_exp_f32 v107, v107
  v_mfma_f32_32x32x16_bf16 v[80:95], v[32:35], v[24:27], 0
  v_exp_f32 v108, v108
  v_exp_f32 v109, v109
  v_exp_f32 v110, v110
  v_exp_f32 v111, v111
  v_cvt_pk_bf16_f32 v144, v96, v97
  v_cvt_pk_bf16_f32 v145, v98, v99
  v_mfma_f32_32x32x16_bf16 v[80:95], v[36:39], v[28:31], v[80:95]
  v_cvt_pk_bf16_f32 v146, v100, v101
  v_cvt_pk_bf16_f32 v147, v102, v103
  v_cvt_pk_bf16_f32 v148, v104, v105
  v_cvt_pk_bf16_f32 v149, v106, v107
  v_cvt_pk_bf16_f32 v150, v108, v109
  v_cvt_pk_bf16_f32 v151, v110, v111
  v_mfma_f32_32x32x16_bf16 v[160:175], v[48:51], v[128:131], v[160:175]
  v_exp_f32 v112, v112
  v_exp_f32 v113, v113
  v_exp_f32 v114, v114
  v_exp_f32 v115, v115
  v_exp_f32 v116, v116
  v_exp_f32 v117, v117
  v_mfma_f32_32x32x16_bf16 v[160:175], v[52:55], v[132:135], v[160:175]
  v_exp_f32 v118, v118
  v_exp_f32 v119, v119
  v_exp_f32 v120, v120
  v_exp_f32 v121, v121
  v_exp_f32 v122, v122
  v_exp_f32 v123, v123
  v_mfma_f32_32x32x16_bf16 v[176:191], v[48:51], v[136:139], v[176:191]
  v_exp_f32 v124, v124
  v_exp_f32 v125, v125
  v_exp_f32 v126, v126
  v_exp_f32 v127, v127
  v_cvt_pk_bf16_f32 v152, v112, v113
  v_cvt_pk_bf16_f32 v153, v114, v115
  v_mfma_f32_32x32x16_bf16 v[176:191], v[52:55], v[140:143], v[176:191]
  v_cvt_pk_bf16_f32 v154, v116, v117
  v_cvt_pk_bf16_f32 v155, v118, v119
  v_cvt_pk_bf16_f32 v156, v120, v121
  v_cvt_pk_bf16_f32 v157, v122, v123
  v_cvt_pk_bf16_f32 v158, v124, v125
  v_cvt_pk_bf16_f32 v159, v126, v127
  ds_read_b128 v[32:35], v13 offset:24576
  ds_read_b128 v[36:39], v13 offset:25600
  ds_read_b128 v[48:51], v13 offset:18432
  ds_read_b128 v[52:55], v13 offset:19456
  s_waitcnt lgkmcnt(4)
  v_mfma_f32_32x32x16_bf16 v[96:111], v[40:43], v[16:19], 0
  v_exp_f32 v64, v64
  v_exp_f32 v65, v65
  v_exp_f32 v66, v66
  v_exp_f32 v67, v67
  v_exp_f32 v68, v68
  v_exp_f32 v69, v69
  v_mfma_f32_32x32x16_bf16 v[96:111], v[44:47], v[20:23], v[96:111]
  v_exp_f32 v70, v70
  v_exp_f32 v71, v71
  v_exp_f32 v72, v72
  v_exp_f32 v73, v73
  v_exp_f32 v74, v74
  v_exp_f32 v75, v75
  v_mfma_f32_32x32x16_bf16 v[112:127], v[40:43], v[24:27], 0
  v_exp_f32 v76, v76
  v_exp_f32 v77, v77
  v_exp_f32 v78, v78
  v_exp_f32 v79, v79
  v_cvt_pk_bf16_f32 v128, v64, v65
  v_cvt_pk_bf16_f32 v129, v66, v67
  v_mfma_f32_32x32x16_bf16 v[112:127], v[44:47], v[28:31], v[112:127]
  v_cvt_pk_bf16_f32 v130, v68, v69
  v_cvt_pk_bf16_f32 v131, v70, v71
  v_cvt_pk_bf16_f32 v132, v72, v73
  v_cvt_pk_bf16_f32 v133, v74, v75
  v_cvt_pk_bf16_f32 v134, v76, v77
  v_cvt_pk_bf16_f32 v135, v78, v79
  v_mfma_f32_32x32x16_bf16 v[160:175], v[56:59], v[144:147], v[160:175]
  v_exp_f32 v80, v80
  v_exp_f32 v81, v81
  v_exp_f32 v82, v82
  v_exp_f32 v83, v83
  v_exp_f32 v84, v84
  v_exp_f32 v85, v85
  v_mfma_f32_32x32x16_bf16 v[160:175], v[60:63], v[148:151], v[160:175]
  v_exp_f32 v86, v86
  v_exp_f32 v87, v87
  v_exp_f32 v88, v88
  v_exp_f32 v89, v89
  v_exp_f32 v90, v90
  v_exp_f32 v91, v91
  v_mfma_f32_32x32x16_bf16 v[176:191], v[56:59], v[152:155], v[176:191]
  v_exp_f32 v92, v92
  v_exp_f32 v93, v93
  v_exp_f32 v94, v94
  v_exp_f32 v95, v95
  v_cvt_pk_bf16_f32 v136, v80, v81
  v_cvt_pk_bf16_f32 v137, v82, v83
  v_mfma_f32_32x32x16_bf16 v[176:191], v[60:63], v[156:159], v[176:191]
  v_cvt_pk_bf16_f32 v138, v84, v85
  v_cvt_pk_bf16_f32 v139, v86, v87
  v_cvt_pk_bf16_f32 v140, v88, v89
  v_cvt_pk_bf16_f32 v141, v90, v91
  v_cvt_pk_bf16_f32 v142, v92, v93
  v_cvt_pk_bf16_f32 v143, v94, v95
  ds_read_b128 v[40:43], v13 offset:28672
  ds_read_b128 v[44:47], v13 offset:29696
  ds_read_b128 v[56:59], v13 offset:22528
  ds_read_b128 v[60:63], v13 offset:23552
  s_waitcnt lgkmcnt(4)
  v_mfma_f32_32x32x16_bf16 v[64:79], v[32:35], v[16:19], 0
  v_exp_f32 v96, v96
  v_exp_f32 v97, v97
  v_exp_f32 v98, v98
  v_exp_f32 v99, v99
  v_exp_f32 v100, v100
  v_exp_f32 v101, v101
  v_mfma_f32_32x32x16_bf16 v[64:79], v[36:39], v[20:23], v[64:79]
  v_exp_f32 v102, v102
  v_exp_f32 v103, v103
  v_exp_f32 v104, v104
  v_exp_f32 v105, v105
  v_exp_f32 v106, v106
  v_exp_f32 v107, v107
  v_mfma_f32_32x32x16_bf16 v[80:95], v[32:35], v[24:27], 0
  v_exp_f32 v108, v108
  v_exp_f32 v109, v109
  v_exp_f32 v110, v110
  v_exp_f32 v111, v111
  v_cvt_pk_bf16_f32 v144, v96, v97
  v_cvt_pk_bf16_f32 v145, v98, v99
  v_mfma_f32_32x32x16_bf16 v[80:95], v[36:39], v[28:31], v[80:95]
  v_cvt_pk_bf16_f32 v146, v100, v101
  v_cvt_pk_bf16_f32 v147, v102, v103
  v_cvt_pk_bf16_f32 v148, v104, v105
  v_cvt_pk_bf16_f32 v149, v106, v107
  v_cvt_pk_bf16_f32 v150, v108, v109
  v_cvt_pk_bf16_f32 v151, v110, v111
  v_mfma_f32_32x32x16_bf16 v[160:175], v[48:51], v[128:131], v[160:175]
  v_exp_f32 v112, v112
  v_exp_f32 v113, v113
  v_exp_f32 v114, v114
  v_exp_f32 v115, v115
  v_exp_f32 v116, v116
  v_exp_f32 v117, v117
  v_mfma_f32_32x32x16_bf16 v[160:175], v[52:55], v[132:135], v[160:175]
  v_exp_f32 v118, v118
  v_exp_f32 v119, v119
  v_exp_f32 v120, v120
  v_exp_f32 v121, v121
  v_exp_f32 v122, v122
  v_exp_f32 v123, v123
  v_mfma_f32_32x32x16_bf16 v[176:191], v[48:51], v[136:139], v[176:191]
  v_exp_f32 v124, v124
  v_exp_f32 v125, v125
  v_exp_f32 v126, v126
  v_exp_f32 v127, v127
  v_cvt_pk_bf16_f32 v152, v112, v113
  v_cvt_pk_bf16_f32 v153, v114, v115
  v_mfma_f32_32x32x16_bf16 v[176:191], v[52:55], v[140:143], v[176:191]
  v_cvt_pk_bf16_f32 v154, v116, v117
  v_cvt_pk_bf16_f32 v155, v118, v119
  v_cvt_pk_bf16_f32 v156, v120, v121
  v_cvt_pk_bf16_f32 v157, v122, v123
  v_cvt_pk_bf16_f32 v158, v124, v125
  v_cvt_pk_bf16_f32 v159, v126, v127
  s_waitcnt vmcnt(4)
  s_barrier
  s_add_u32 m0, s26, 0
  s_nop 0
  buffer_load_dwordx4 v12, s[8:11], s28 offen offset:0 lds
  buffer_load_dwordx4 v12, s[8:11], s28 offen offset:1024 lds
  buffer_load_dwordx4 v12, s[8:11], s28 offen offset:2048 lds
  buffer_load_dwordx4 v12, s[8:11], s28 offen offset:3072 lds
  s_add_u32 s28, s28, 16384
  ds_read_b128 v[32:35], v13 offset:32768
  ds_read_b128 v[36:39], v13 offset:33792
  ds_read_b128 v[48:51], v13 offset:26624
  ds_read_b128 v[52:55], v13 offset:27648
  s_waitcnt lgkmcnt(4)
  v_mfma_f32_32x32x16_bf16 v[96:111], v[40:43], v[16:19], 0
  v_exp_f32 v64, v64
  v_exp_f32 v65, v65
  v_exp_f32 v66, v66
  v_exp_f32 v67, v67
  v_exp_f32 v68, v68
  v_exp_f32 v69, v69
  v_mfma_f32_32x32x16_bf16 v[96:111], v[44:47], v[20:23], v[96:111]
  v_exp_f32 v70, v70
  v_exp_f32 v71, v71
  v_exp_f32 v72, v72
  v_exp_f32 v73, v73
  v_exp_f32 v74, v74
  v_exp_f32 v75, v75
  v_mfma_f32_32x32x16_bf16 v[112:127], v[40:43], v[24:27], 0
  v_exp_f32 v76, v76
  v_exp_f32 v77, v77
  v_exp_f32 v78, v78
  v_exp_f32 v79, v79
  v_cvt_pk_bf16_f32 v128, v64, v65
  v_cvt_pk_bf16_f32 v129, v66, v67
  v_mfma_f32_32x32x16_bf16 v[112:127], v[44:47], v[28:31], v[112:127]
  v_cvt_pk_bf16_f32 v130, v68, v69
  v_cvt_pk_bf16_f32 v131, v70, v71
  v_cvt_pk_bf16_f32 v132, v72, v73
  v_cvt_pk_bf16_f32 v133, v74, v75
  v_cvt_pk_bf16_f32 v134, v76, v77
  v_cvt_pk_bf16_f32 v135, v78, v79
  v_mfma_f32_32x32x16_bf16 v[160:175], v[56:59], v[144:147], v[160:175]
  v_exp_f32 v80, v80
  v_exp_f32 v81, v81
  v_exp_f32 v82, v82
  v_exp_f32 v83, v83
  v_exp_f32 v84, v84
  v_exp_f32 v85, v85
  v_mfma_f32_32x32x16_bf16 v[160:175], v[60:63], v[148:151], v[160:175]
  v_exp_f32 v86, v86
  v_exp_f32 v87, v87
  v_exp_f32 v88, v88
  v_exp_f32 v89, v89
  v_exp_f32 v90, v90
  v_exp_f32 v91, v91
  v_mfma_f32_32x32x16_bf16 v[176:191], v[56:59], v[152:155], v[176:191]
  v_exp_f32 v92, v92
  v_exp_f32 v93, v93
  v_exp_f32 v94, v94
  v_exp_f32 v95, v95
  v_cvt_pk_bf16_f32 v136, v80, v81
  v_cvt_pk_bf16_f32 v137, v82, v83
  v_mfma_f32_32x32x16_bf16 v[176:191], v[60:63], v[156:159], v[176:191]
  v_cvt_pk_bf16_f32 v138, v84, v85
  v_cvt_pk_bf16_f32 v139, v86, v87
  v_cvt_pk_bf16_f32 v140, v88, v89
  v_cvt_pk_bf16_f32 v141, v90, v91
  v_cvt_pk_bf16_f32 v142, v92, v93
  v_cvt_pk_bf16_f32 v143, v94, v95
  ds_read_b128 v[40:43], v13 offset:36864
  ds_read_b128 v[44:47], v13 offset:37888
  ds_read_b128 v[56:59], v13 offset:30720
  ds_read_b128 v[60:63], v13 offset:31744
  s_waitcnt lgkmcnt(4)
  v_mfma_f32_32x32x16_bf16 v[64:79], v[32:35], v[16:19], 0
  v_exp_f32 v96, v96
  v_exp_f32 v97, v97
  v_exp_f32 v98, v98
  v_exp_f32 v99, v99
  v_exp_f32 v100, v100
  v_exp_f32 v101, v101
  v_mfma_f32_32x32x16_bf16 v[64:79], v[36:39], v[20:23], v[64:79]
  v_exp_f32 v102, v102
  v_exp_f32 v103, v103
  v_exp_f32 v104, v104
  v_exp_f32 v105, v105
  v_exp_f32 v106, v106
  v_exp_f32 v107, v107
  v_mfma_f32_32x32x16_bf16 v[80:95], v[32:35], v[24:27], 0
  v_exp_f32 v108, v108
  v_exp_f32 v109, v109
  v_exp_f32 v110, v110
  v_exp_f32 v111, v111
  v_cvt_pk_bf16_f32 v144, v96, v97
  v_cvt_pk_bf16_f32 v145, v98, v99
  v_mfma_f32_32x32x16_bf16 v[80:95], v[36:39], v[28:31], v[80:95]
  v_cvt_pk_bf16_f32 v146, v100, v101
  v_cvt_pk_bf16_f32 v147, v102, v103
  v_cvt_pk_bf16_f32 v148, v104, v105
  v_cvt_pk_bf16_f32 v149, v106, v107
  v_cvt_pk_bf16_f32 v150, v108, v109
  v_cvt_pk_bf16_f32 v151, v110, v111
  v_mfma_f32_32x32x16_bf16 v[160:175], v[48:51], v[128:131], v[160:175]
  v_exp_f32 v112, v112
  v_exp_f32 v113, v113
  v_exp_f32 v114, v114
  v_exp_f32 v115, v115
  v_exp_f32 v116, v116
  v_exp_f32 v117, v117
  v_mfma_f32_32x32x16_bf16 v[160:175], v[52:55], v[132:135], v[160:175]
  v_exp_f32 v118, v118
  v_exp_f32 v119, v119
  v_exp_f32 v120, v120
  v_exp_f32 v121, v121
  v_exp_f32 v122, v122
  v_exp_f32 v123, v123
  v_mfma_f32_32x32x16_bf16 v[176:191], v[48:51], v[136:139], v[176:191]
  v_exp_f32 v124, v124
  v_exp_f32 v125, v125
  v_exp_f32 v126, v126
  v_exp_f32 v127, v127
  v_cvt_pk_bf16_f32 v152, v112, v113
  v_cvt_pk_bf16_f32 v153, v114, v115
  v_mfma_f32_32x32x16_bf16 v[176:191], v[52:55], v[140:143], v[176:191]
  v_cvt_pk_bf16_f32 v154, v116, v117
  v_cvt_pk_bf16_f32 v155, v118, v119
  v_cvt_pk_bf16_f32 v156, v120, v121
  v_cvt_pk_bf16_f32 v157, v122, v123
  v_cvt_pk_bf16_f32 v158, v124, v125
  v_cvt_pk_bf16_f32 v159, v126, v127
  ds_read_b128 v[32:35], v13 offset:40960
  ds_read_b128 v[36:39], v13 offset:41984
  ds_read_b128 v[48:51], v13 offset:34816
  ds_read_b128 v[52:55], v13 offset:35840
  s_waitcnt lgkmcnt(4)
  v_mfma_f32_32x32x16_bf16 v[96:111], v[40:43], v[16:19], 0
  v_exp_f32 v64, v64
  v_exp_f32 v65, v65
  v_exp_f32 v66, v66
  v_exp_f32 v67, v67
  v_exp_f32 v68, v68
  v_exp_f32 v69, v69
  v_mfma_f32_32x32x16_bf16 v[96:111], v[44:47], v[20:23], v[96:111]
  v_exp_f32 v70, v70
  v_exp_f32 v71, v71
  v_exp_f32 v72, v72
  v_exp_f32 v73, v73
  v_exp_f32 v74, v74
  v_exp_f32 v75, v75
  v_mfma_f32_32x32x16_bf16 v[112:127], v[40:43], v[24:27], 0
  v_exp_f32 v76, v76
  v_exp_f32 v77, v77
  v_exp_f32 v78, v78
  v_exp_f32 v79, v79
  v_cvt_pk_bf16_f32 v128, v64, v65
  v_cvt_pk_bf16_f32 v129, v66, v67
  v_mfma_f32_32x32x16_bf16 v[112:127], v[44:47], v[28:31], v[112:127]
  v_cvt_pk_bf16_f32 v130, v68, v69
  v_cvt_pk_bf16_f32 v131, v70, v71
  v_cvt_pk_bf16_f32 v132, v72, v73
  v_cvt_pk_bf16_f32 v133, v74, v75
  v_cvt_pk_bf16_f32 v134, v76, v77
  v_cvt_pk_bf16_f32 v135, v78, v79
  v_mfma_f32_32x32x16_bf16 v[160:175], v[56:59], v[144:147], v[160:175]
  v_exp_f32 v80, v80
  v_exp_f32 v81, v81
  v_exp_f32 v82, v82
  v_exp_f32 v83, v83
  v_exp_f32 v84, v84
  v_exp_f32 v85, v85
  v_mfma_f32_32x32x16_bf16 v[160:175], v[60:63], v[148:151], v[160:175]
  v_exp_f32 v86, v86
  v_exp_f32 v87, v87
  v_exp_f32 v88, v88
  v_exp_f32 v89, v89
  v_exp_f32 v90, v90
  v_exp_f32 v91, v91
  v_mfma_f32_32x32x16_bf16 v[176:191], v[56:59], v[152:155], v[176:191]
  v_exp_f32 v92, v92
  v_exp_f32 v93, v93
  v_exp_f32 v94, v94
  v_exp_f32 v95, v95
  v_cvt_pk_bf16_f32 v136, v80, v81
  v_cvt_pk_bf16_f32 v137, v82, v83
  v_mfma_f32_32x32x16_bf16 v[176:191], v[60:63], v[156:159], v[176:191]
  v_cvt_pk_bf16_f32 v138, v84, v85
  v_cvt_pk_bf16_f32 v139, v86, v87
  v_cvt_pk_bf16_f32 v140, v88, v89
  v_cvt_pk_bf16_f32 v141, v90, v91
  v_cvt_pk_bf16_f32 v142, v92, v93
  v_cvt_pk_bf16_f32 v143, v94, v95
  ds_read_b128 v[40:43], v13 offset:45056
  ds_read_b128 v[44:47], v13 offset:46080
  ds_read_b128 v[56:59], v13 offset:38912
  ds_read_b128 v[60:63], v13 offset:39936
  s_waitcnt lgkmcnt(4)
  v_mfma_f32_32x32x16_bf16 v[64:79], v[32:35], v[16:19], 0
  v_exp_f32 v96, v96
  v_exp_f32 v97, v97
  v_exp_f32 v98, v98
  v_exp_f32 v99, v99
  v_exp_f32 v100, v100
  v_exp_f32 v101, v101
  v_mfma_f32_32x32x16_bf16 v[64:79], v[36:39], v[20:23], v[64:79]
  v_exp_f32 v102, v102
  v_exp_f32 v103, v103
  v_exp_f32 v104, v104
  v_exp_f32 v105, v105
  v_exp_f32 v106, v106
  v_exp_f32 v107, v107
  v_mfma_f32_32x32x16_bf16 v[80:95], v[32:35], v[24:27], 0
  v_exp_f32 v108, v108
  v_exp_f32 v109, v109
  v_exp_f32 v110, v110
  v_exp_f32 v111, v111
  v_cvt_pk_bf16_f32 v144, v96, v97
  v_cvt_pk_bf16_f32 v145, v98, v99
  v_mfma_f32_32x32x16_bf16 v[80:95], v[36:39], v[28:31], v[80:95]
  v_cvt_pk_bf16_f32 v146, v100, v101
  v_cvt_pk_bf16_f32 v147, v102, v103
  v_cvt_pk_bf16_f32 v148, v104, v105
  v_cvt_pk_bf16_f32 v149, v106, v107
  v_cvt_pk_bf16_f32 v150, v108, v109
  v_cvt_pk_bf16_f32 v151, v110, v111
  v_mfma_f32_32x32x16_bf16 v[160:175], v[48:51], v[128:131], v[160:175]
  v_exp_f32 v112, v112
  v_exp_f32 v113, v113
  v_exp_f32 v114, v114
  v_exp_f32 v115, v115
  v_exp_f32 v116, v116
  v_exp_f32 v117, v117
  v_mfma_f32_32x32x16_bf16 v[160:175], v[52:55], v[132:135], v[160:175]
  v_exp_f32 v118, v118
  v_exp_f32 v119, v119
  v_exp_f32 v120, v120
  v_exp_f32 v121, v121
  v_exp_f32 v122, v122
  v_exp_f32 v123, v123
  v_mfma_f32_32x32x16_bf16 v[176:191], v[48:51], v[136:139], v[176:191]
  v_exp_f32 v124, v124
  v_exp_f32 v125, v125
  v_exp_f32 v126, v126
  v_exp_f32 v127, v127
  v_cvt_pk_bf16_f32 v152, v112, v113
  v_cvt_pk_bf16_f32 v153, v114, v115
  v_mfma_f32_32x32x16_bf16 v[176:191], v[52:55], v[140:143], v[176:191]
  v_cvt_pk_bf16_f32 v154, v116, v117
  v_cvt_pk_bf16_f32 v155, v118, v119
  v_cvt_pk_bf16_f32 v156, v120, v121
  v_cvt_pk_bf16_f32 v157, v122, v123
  v_cvt_pk_bf16_f32 v158, v124, v125
  v_cvt_pk_bf16_f32 v159, v126, v127
  s_waitcnt vmcnt(4)
  s_barrier
  s_add_u32 m0, s26, 16384
  s_nop 0
  buffer_load_dwordx4 v12, s[8:11], s28 offen offset:0 lds
  buffer_load_dwordx4 v12, s[8:11], s28 offen offset:1024 lds
  buffer_load_dwordx4 v12, s[8:11], s28 offen offset:2048 lds
  buffer_load_dwordx4 v12, s[8:11], s28 offen offset:3072 lds
  s_add_u32 s28, s28, 16384
  ds_read_b128 v[32:35], v13 offset:49152
  ds_read_b128 v[36:39], v13 offset:50176
  ds_read_b128 v[48:51], v13 offset:43008
  ds_read_b128 v[52:55], v13 offset:44032
  s_waitcnt lgkmcnt(4)
  v_mfma_f32_32x32x16_bf16 v[96:111], v[40:43], v[16:19], 0
  v_exp_f32 v64, v64
  v_exp_f32 v65, v65
  v_exp_f32 v66, v66
  v_exp_f32 v67, v67
  v_exp_f32 v68, v68
  v_exp_f32 v69, v69
  v_mfma_f32_32x32x16_bf16 v[96:111], v[44:47], v[20:23], v[96:111]
  v_exp_f32 v70, v70
  v_exp_f32 v71, v71
  v_exp_f32 v72, v72
  v_exp_f32 v73, v73
  v_exp_f32 v74, v74
  v_exp_f32 v75, v75
  v_mfma_f32_32x32x16_bf16 v[112:127], v[40:43], v[24:27], 0
  v_exp_f32 v76, v76
  v_exp_f32 v77, v77
  v_exp_f32 v78, v78
  v_exp_f32 v79, v79
  v_cvt_pk_bf16_f32 v128, v64, v65
  v_cvt_pk_bf16_f32 v129, v66, v67
  v_mfma_f32_32x32x16_bf16 v[112:127], v[44:47], v[28:31], v[112:127]
  v_cvt_pk_bf16_f32 v130, v68, v69
  v_cvt_pk_bf16_f32 v131, v70, v71
  v_cvt_pk_bf16_f32 v132, v72, v73
  v_cvt_pk_bf16_f32 v133, v74, v75
  v_cvt_pk_bf16_f32 v134, v76, v77
  v_cvt_pk_bf16_f32 v135, v78, v79
  v_mfma_f32_32x32x16_bf16 v[160:175], v[56:59], v[144:147], v[160:175]
  v_exp_f32 v80, v80
  v_exp_f32 v81, v81
  v_exp_f32 v82, v82
  v_exp_f32 v83, v83
  v_exp_f32 v84, v84
  v_exp_f32 v85, v85
  v_mfma_f32_32x32x16_bf16 v[160:175], v[60:63], v[148:151], v[160:175]
  v_exp_f32 v86, v86
  v_exp_f32 v87, v87
  v_exp_f32 v88, v88
  v_exp_f32 v89, v89
  v_exp_f32 v90, v90
  v_exp_f32 v91, v91
  v_mfma_f32_32x32x16_bf16 v[176:191], v[56:59], v[152:155], v[176:191]
  v_exp_f32 v92, v92
  v_exp_f32 v93, v93
  v_exp_f32 v94, v94
  v_exp_f32 v95, v95
  v_cvt_pk_bf16_f32 v136, v80, v81
  v_cvt_pk_bf16_f32 v137, v82, v83
  v_mfma_f32_32x32x16_bf16 v[176:191], v[60:63], v[156:159], v[176:191]
  v_cvt_pk_bf16_f32 v138, v84, v85
  v_cvt_pk_bf16_f32 v139, v86, v87
  v_cvt_pk_bf16_f32 v140, v88, v89
  v_cvt_pk_bf16_f32 v141, v90, v91
  v_cvt_pk_bf16_f32 v142, v92, v93
  v_cvt_pk_bf16_f32 v143, v94, v95
  ds_read_b128 v[40:43], v13 offset:53248
  ds_read_b128 v[44:47], v13 offset:54272
  ds_read_b128 v[56:59], v13 offset:47104
  ds_read_b128 v[60:63], v13 offset:48128
  s_waitcnt lgkmcnt(4)
  v_mfma_f32_32x32x16_bf16 v[64:79], v[32:35], v[16:19], 0
  v_exp_f32 v96, v96
  v_exp_f32 v97, v97
  v_exp_f32 v98, v98
  v_exp_f32 v99, v99
  v_exp_f32 v100, v100
  v_exp_f32 v101, v101
  v_mfma_f32_32x32x16_bf16 v[64:79], v[36:39], v[20:23], v[64:79]
  v_exp_f32 v102, v102
  v_exp_f32 v103, v103
  v_exp_f32 v104, v104
  v_exp_f32 v105, v105
  v_exp_f32 v106, v106
  v_exp_f32 v107, v107
  v_mfma_f32_32x32x16_bf16 v[80:95], v[32:35], v[24:27], 0
  v_exp_f32 v108, v108
  v_exp_f32 v109, v109
  v_exp_f32 v110, v110
  v_exp_f32 v111, v111
  v_cvt_pk_bf16_f32 v144, v96, v97
  v_cvt_pk_bf16_f32 v145, v98, v99
  v_mfma_f32_32x32x16_bf16 v[80:95], v[36:39], v[28:31], v[80:95]
  v_cvt_pk_bf16_f32 v146, v100, v101
  v_cvt_pk_bf16_f32 v147, v102, v103
  v_cvt_pk_bf16_f32 v148, v104, v105
  v_cvt_pk_bf16_f32 v149, v106, v107
  v_cvt_pk_bf16_f32 v150, v108, v109
  v_cvt_pk_bf16_f32 v151, v110, v111
  v_mfma_f32_32x32x16_bf16 v[160:175], v[48:51], v[128:131], v[160:175]
  v_exp_f32 v112, v112
  v_exp_f32 v113, v113
  v_exp_f32 v114, v114
  v_exp_f32 v115, v115
  v_exp_f32 v116, v116
  v_exp_f32 v117, v117
  v_mfma_f32_32x32x16_bf16 v[160:175], v[52:55], v[132:135], v[160:175]
  v_exp_f32 v118, v118
  v_exp_f32 v119, v119
  v_exp_f32 v120, v120
  v_exp_f32 v121, v121
  v_exp_f32 v122, v122
  v_exp_f32 v123, v123
  v_mfma_f32_32x32x16_bf16 v[176:191], v[48:51], v[136:139], v[176:191]
  v_exp_f32 v124, v124
  v_exp_f32 v125, v125
  v_exp_f32 v126, v126
  v_exp_f32 v127, v127
  v_cvt_pk_bf16_f32 v152, v112, v113
  v_cvt_pk_bf16_f32 v153, v114, v115
  v_mfma_f32_32x32x16_bf16 v[176:191], v[52:55], v[140:143], v[176:191]
  v_cvt_pk_bf16_f32 v154, v116, v117
  v_cvt_pk_bf16_f32 v155, v118, v119
  v_cvt_pk_bf16_f32 v156, v120, v121
  v_cvt_pk_bf16_f32 v157, v122, v123
  v_cvt_pk_bf16_f32 v158, v124, v125
  v_cvt_pk_bf16_f32 v159, v126, v127
  ds_read_b128 v[32:35], v13 offset:57344
  ds_read_b128 v[36:39], v13 offset:58368
  ds_read_b128 v[48:51], v13 offset:51200
  ds_read_b128 v[52:55], v13 offset:52224
  s_waitcnt lgkmcnt(4)
  v_mfma_f32_32x32x16_bf16 v[96:111], v[40:43], v[16:19], 0
  v_exp_f32 v64, v64
  v_exp_f32 v65, v65
  v_exp_f32 v66, v66
  v_exp_f32 v67, v67
  v_exp_f32 v68, v68
  v_exp_f32 v69, v69
  v_mfma_f32_32x32x16_bf16 v[96:111], v[44:47], v[20:23], v[96:111]
  v_exp_f32 v70, v70
  v_exp_f32 v71, v71
  v_exp_f32 v72, v72
  v_exp_f32 v73, v73
  v_exp_f32 v74, v74
  v_exp_f32 v75, v75
  v_mfma_f32_32x32x16_bf16 v[112:127], v[40:43], v[24:27], 0
  v_exp_f32 v76, v76
  v_exp_f32 v77, v77
  v_exp_f32 v78, v78
  v_exp_f32 v79, v79
  v_cvt_pk_bf16_f32 v128, v64, v65
  v_cvt_pk_bf16_f32 v129, v66, v67
  v_mfma_f32_32x32x16_bf16 v[112:127], v[44:47], v[28:31], v[112:127]
  v_cvt_pk_bf16_f32 v130, v68, v69
  v_cvt_pk_bf16_f32 v131, v70, v71
  v_cvt_pk_bf16_f32 v132, v72, v73
  v_cvt_pk_bf16_f32 v133, v74, v75
  v_cvt_pk_bf16_f32 v134, v76, v77
  v_cvt_pk_bf16_f32 v135, v78, v79
  v_mfma_f32_32x32x16_bf16 v[160:175], v[56:59], v[144:147], v[160:175]
  v_exp_f32 v80, v80
  v_exp_f32 v81, v81
  v_exp_f32 v82, v82
  v_exp_f32 v83, v83
  v_exp_f32 v84, v84
  v_exp_f32 v85, v85
  v_mfma_f32_32x32x16_bf16 v[160:175], v[60:63], v[148:151], v[160:175]
  v_exp_f32 v86, v86
  v_exp_f32 v87, v87
  v_exp_f32 v88, v88
  v_exp_f32 v89, v89
  v_exp_f32 v90, v90
  v_exp_f32 v91, v91
  v_mfma_f32_32x32x16_bf16 v[176:191], v[56:59], v[152:155], v[176:191]
  v_exp_f32 v92, v92
  v_exp_f32 v93, v93
  v_exp_f32 v94, v94
  v_exp_f32 v95, v95
  v_cvt_pk_bf16_f32 v136, v80, v81
  v_cvt_pk_bf16_f32 v137, v82, v83
  v_mfma_f32_32x32x16_bf16 v[176:191], v[60:63], v[156:159], v[176:191]
  v_cvt_pk_bf16_f32 v138, v84, v85
  v_cvt_pk_bf16_f32 v139, v86, v87
  v_cvt_pk_bf16_f32 v140, v88, v89
  v_cvt_pk_bf16_f32 v141, v90, v91
  v_cvt_pk_bf16_f32 v142, v92, v93
  v_cvt_pk_bf16_f32 v143, v94, v95
  ds_read_b128 v[40:43], v13 offset:61440
  ds_read_b128 v[44:47], v13 offset:62464
  ds_read_b128 v[56:59], v13 offset:55296
  ds_read_b128 v[60:63], v13 offset:56320
  s_waitcnt lgkmcnt(4)
  v_mfma_f32_32x32x16_bf16 v[64:79], v[32:35], v[16:19], 0
  v_exp_f32 v96, v96
  v_exp_f32 v97, v97
  v_exp_f32 v98, v98
  v_exp_f32 v99, v99
  v_exp_f32 v100, v100
  v_exp_f32 v101, v101
  v_mfma_f32_32x32x16_bf16 v[64:79], v[36:39], v[20:23], v[64:79]
  v_exp_f32 v102, v102
  v_exp_f32 v103, v103
  v_exp_f32 v104, v104
  v_exp_f32 v105, v105
  v_exp_f32 v106, v106
  v_exp_f32 v107, v107
  v_mfma_f32_32x32x16_bf16 v[80:95], v[32:35], v[24:27], 0
  v_exp_f32 v108, v108
  v_exp_f32 v109, v109
  v_exp_f32 v110, v110
  v_exp_f32 v111, v111
  v_cvt_pk_bf16_f32 v144, v96, v97
  v_cvt_pk_bf16_f32 v145, v98, v99
  v_mfma_f32_32x32x16_bf16 v[80:95], v[36:39], v[28:31], v[80:95]
  v_cvt_pk_bf16_f32 v146, v100, v101
  v_cvt_pk_bf16_f32 v147, v102, v103
  v_cvt_pk_bf16_f32 v148, v104, v105
  v_cvt_pk_bf16_f32 v149, v106, v107
  v_cvt_pk_bf16_f32 v150, v108, v109
  v_cvt_pk_bf16_f32 v151, v110, v111
  v_mfma_f32_32x32x16_bf16 v[160:175], v[48:51], v[128:131], v[160:175]
  v_exp_f32 v112, v112
  v_exp_f32 v113, v113
  v_exp_f32 v114, v114
  v_exp_f32 v115, v115
  v_exp_f32 v116, v116
  v_exp_f32 v117, v117
  v_mfma_f32_32x32x16_bf16 v[160:175], v[52:55], v[132:135], v[160:175]
  v_exp_f32 v118, v118
  v_exp_f32 v119, v119
  v_exp_f32 v120, v120
  v_exp_f32 v121, v121
  v_exp_f32 v122, v122
  v_exp_f32 v123, v123
  v_mfma_f32_32x32x16_bf16 v[176:191], v[48:51], v[136:139], v[176:191]
  v_exp_f32 v124, v124
  v_exp_f32 v125, v125
  v_exp_f32 v126, v126
  v_exp_f32 v127, v127
  v_cvt_pk_bf16_f32 v152, v112, v113
  v_cvt_pk_bf16_f32 v153, v114, v115
  v_mfma_f32_32x32x16_bf16 v[176:191], v[52:55], v[140:143], v[176:191]
  v_cvt_pk_bf16_f32 v154, v116, v117
  v_cvt_pk_bf16_f32 v155, v118, v119
  v_cvt_pk_bf16_f32 v156, v120, v121
  v_cvt_pk_bf16_f32 v157, v122, v123
  v_cvt_pk_bf16_f32 v158, v124, v125
  v_cvt_pk_bf16_f32 v159, v126, v127
  s_waitcnt vmcnt(4)
  s_barrier
  s_add_u32 m0, s26, 32768
  s_nop 0
  buffer_load_dwordx4 v12, s[8:11], s28 offen offset:0 lds
  buffer_load_dwordx4 v12, s[8:11], s28 offen offset:1024 lds
  buffer_load_dwordx4 v12, s[8:11], s28 offen offset:2048 lds
  buffer_load_dwordx4 v12, s[8:11], s28 offen offset:3072 lds
  s_add_u32 s28, s28, 16384
  ds_read_b128 v[32:35], v13 offset:0
  ds_read_b128 v[36:39], v13 offset:1024
  ds_read_b128 v[48:51], v13 offset:59392
  ds_read_b128 v[52:55], v13 offset:60416
  s_waitcnt lgkmcnt(4)
  v_mfma_f32_32x32x16_bf16 v[96:111], v[40:43], v[16:19], 0
  v_exp_f32 v64, v64
  v_exp_f32 v65, v65
  v_exp_f32 v66, v66
  v_exp_f32 v67, v67
  v_exp_f32 v68, v68
  v_exp_f32 v69, v69
  v_mfma_f32_32x32x16_bf16 v[96:111], v[44:47], v[20:23], v[96:111]
  v_exp_f32 v70, v70
  v_exp_f32 v71, v71
  v_exp_f32 v72, v72
  v_exp_f32 v73, v73
  v_exp_f32 v74, v74
  v_exp_f32 v75, v75
  v_mfma_f32_32x32x16_bf16 v[112:127], v[40:43], v[24:27], 0
  v_exp_f32 v76, v76
  v_exp_f32 v77, v77
  v_exp_f32 v78, v78
  v_exp_f32 v79, v79
  v_cvt_pk_bf16_f32 v128, v64, v65
  v_cvt_pk_bf16_f32 v129, v66, v67
  v_mfma_f32_32x32x16_bf16 v[112:127], v[44:47], v[28:31], v[112:127]
  v_cvt_pk_bf16_f32 v130, v68, v69
  v_cvt_pk_bf16_f32 v131, v70, v71
  v_cvt_pk_bf16_f32 v132, v72, v73
  v_cvt_pk_bf16_f32 v133, v74, v75
  v_cvt_pk_bf16_f32 v134, v76, v77
  v_cvt_pk_bf16_f32 v135, v78, v79
  v_mfma_f32_32x32x16_bf16 v[160:175], v[56:59], v[144:147], v[160:175]
  v_exp_f32 v80, v80
  v_exp_f32 v81, v81
  v_exp_f32 v82, v82
  v_exp_f32 v83, v83
  v_exp_f32 v84, v84
  v_exp_f32 v85, v85
  v_mfma_f32_32x32x16_bf16 v[160:175], v[60:63], v[148:151], v[160:175]
  v_exp_f32 v86, v86
  v_exp_f32 v87, v87
  v_exp_f32 v88, v88
  v_exp_f32 v89, v89
  v_exp_f32 v90, v90
  v_exp_f32 v91, v91
  v_mfma_f32_32x32x16_bf16 v[176:191], v[56:59], v[152:155], v[176:191]
  v_exp_f32 v92, v92
  v_exp_f32 v93, v93
  v_exp_f32 v94, v94
  v_exp_f32 v95, v95
  v_cvt_pk_bf16_f32 v136, v80, v81
  v_cvt_pk_bf16_f32 v137, v82, v83
  v_mfma_f32_32x32x16_bf16 v[176:191], v[60:63], v[156:159], v[176:191]
  v_cvt_pk_bf16_f32 v138, v84, v85
  v_cvt_pk_bf16_f32 v139, v86, v87
  v_cvt_pk_bf16_f32 v140, v88, v89
  v_cvt_pk_bf16_f32 v141, v90, v91
  v_cvt_pk_bf16_f32 v142, v92, v93
  v_cvt_pk_bf16_f32 v143, v94, v95
  ds_read_b128 v[40:43], v13 offset:4096
  ds_read_b128 v[44:47], v13 offset:5120
  ds_read_b128 v[56:59], v13 offset:63488
  ds_read_b128 v[60:63], v13 offset:64512
  s_waitcnt lgkmcnt(4)
  v_mfma_f32_32x32x16_bf16 v[64:79], v[32:35], v[16:19], 0
  v_exp_f32 v96, v96
  v_exp_f32 v97, v97
  v_exp_f32 v98, v98
  v_exp_f32 v99, v99
  v_exp_f32 v100, v100
  v_exp_f32 v101, v101
  v_mfma_f32_32x32x16_bf16 v[64:79], v[36:39], v[20:23], v[64:79]
  v_exp_f32 v102, v102
  v_exp_f32 v103, v103
  v_exp_f32 v104, v104
  v_exp_f32 v105, v105
  v_exp_f32 v106, v106
  v_exp_f32 v107, v107
  v_mfma_f32_32x32x16_bf16 v[80:95], v[32:35], v[24:27], 0
  v_exp_f32 v108, v108
  v_exp_f32 v109, v109
  v_exp_f32 v110, v110
  v_exp_f32 v111, v111
  v_cvt_pk_bf16_f32 v144, v96, v97
  v_cvt_pk_bf16_f32 v145, v98, v99
  v_mfma_f32_32x32x16_bf16 v[80:95], v[36:39], v[28:31], v[80:95]
  v_cvt_pk_bf16_f32 v146, v100, v101
  v_cvt_pk_bf16_f32 v147, v102, v103
  v_cvt_pk_bf16_f32 v148, v104, v105
  v_cvt_pk_bf16_f32 v149, v106, v107
  v_cvt_pk_bf16_f32 v150, v108, v109
  v_cvt_pk_bf16_f32 v151, v110, v111
  v_mfma_f32_32x32x16_bf16 v[160:175], v[48:51], v[128:131], v[160:175]
  v_exp_f32 v112, v112
  v_exp_f32 v113, v113
  v_exp_f32 v114, v114
  v_exp_f32 v115, v115
  v_exp_f32 v116, v116
  v_exp_f32 v117, v117
  v_mfma_f32_32x32x16_bf16 v[160:175], v[52:55], v[132:135], v[160:175]
  v_exp_f32 v118, v118
  v_exp_f32 v119, v119
  v_exp_f32 v120, v120
  v_exp_f32 v121, v121
  v_exp_f32 v122, v122
  v_exp_f32 v123, v123
  v_mfma_f32_32x32x16_bf16 v[176:191], v[48:51], v[136:139], v[176:191]
  v_exp_f32 v124, v124
  v_exp_f32 v125, v125
  v_exp_f32 v126, v126
  v_exp_f32 v127, v127
  v_cvt_pk_bf16_f32 v152, v112, v113
  v_cvt_pk_bf16_f32 v153, v114, v115
  v_mfma_f32_32x32x16_bf16 v[176:191], v[52:55], v[140:143], v[176:191]
  v_cvt_pk_bf16_f32 v154, v116, v117
  v_cvt_pk_bf16_f32 v155, v118, v119
  v_cvt_pk_bf16_f32 v156, v120, v121
  v_cvt_pk_bf16_f32 v157, v122, v123
  v_cvt_pk_bf16_f32 v158, v124, v125
  v_cvt_pk_bf16_f32 v159, v126, v127
  ds_read_b128 v[32:35], v13 offset:8192
  ds_read_b128 v[36:39], v13 offset:9216
  ds_read_b128 v[48:51], v13 offset:2048
  ds_read_b128 v[52:55], v13 offset:3072
  s_waitcnt lgkmcnt(4)
  v_mfma_f32_32x32x16_bf16 v[96:111], v[40:43], v[16:19], 0
  v_exp_f32 v64, v64
  v_exp_f32 v65, v65
  v_exp_f32 v66, v66
  v_exp_f32 v67, v67
  v_exp_f32 v68, v68
  v_exp_f32 v69, v69
  v_mfma_f32_32x32x16_bf16 v[96:111], v[44:47], v[20:23], v[96:111]
  v_exp_f32 v70, v70
  v_exp_f32 v71, v71
  v_exp_f32 v72, v72
  v_exp_f32 v73, v73
  v_exp_f32 v74, v74
  v_exp_f32 v75, v75
  v_mfma_f32_32x32x16_bf16 v[112:127], v[40:43], v[24:27], 0
  v_exp_f32 v76, v76
  v_exp_f32 v77, v77
  v_exp_f32 v78, v78
  v_exp_f32 v79, v79
  v_cvt_pk_bf16_f32 v128, v64, v65
  v_cvt_pk_bf16_f32 v129, v66, v67
  v_mfma_f32_32x32x16_bf16 v[112:127], v[44:47], v[28:31], v[112:127]
  v_cvt_pk_bf16_f32 v130, v68, v69
  v_cvt_pk_bf16_f32 v131, v70, v71
  v_cvt_pk_bf16_f32 v132, v72, v73
  v_cvt_pk_bf16_f32 v133, v74, v75
  v_cvt_pk_bf16_f32 v134, v76, v77
  v_cvt_pk_bf16_f32 v135, v78, v79
  v_mfma_f32_32x32x16_bf16 v[160:175], v[56:59], v[144:147], v[160:175]
  v_exp_f32 v80, v80
  v_exp_f32 v81, v81
  v_exp_f32 v82, v82
  v_exp_f32 v83, v83
  v_exp_f32 v84, v84
  v_exp_f32 v85, v85
  v_mfma_f32_32x32x16_bf16 v[160:175], v[60:63], v[148:151], v[160:175]
  v_exp_f32 v86, v86
  v_exp_f32 v87, v87
  v_exp_f32 v88, v88
  v_exp_f32 v89, v89
  v_exp_f32 v90, v90
  v_exp_f32 v91, v91
  v_mfma_f32_32x32x16_bf16 v[176:191], v[56:59], v[152:155], v[176:191]
  v_exp_f32 v92, v92
  v_exp_f32 v93, v93
  v_exp_f32 v94, v94
  v_exp_f32 v95, v95
  v_cvt_pk_bf16_f32 v136, v80, v81
  v_cvt_pk_bf16_f32 v137, v82, v83
  v_mfma_f32_32x32x16_bf16 v[176:191], v[60:63], v[156:159], v[176:191]
  v_cvt_pk_bf16_f32 v138, v84, v85
  v_cvt_pk_bf16_f32 v139, v86, v87
  v_cvt_pk_bf16_f32 v140, v88, v89
  v_cvt_pk_bf16_f32 v141, v90, v91
  v_cvt_pk_bf16_f32 v142, v92, v93
  v_cvt_pk_bf16_f32 v143, v94, v95
  ds_read_b128 v[40:43], v13 offset:12288
  ds_read_b128 v[44:47], v13 offset:13312
  ds_read_b128 v[56:59], v13 offset:6144
  ds_read_b128 v[60:63], v13 offset:7168
  s_waitcnt lgkmcnt(4)
  v_mfma_f32_32x32x16_bf16 v[64:79], v[32:35], v[16:19], 0
  v_exp_f32 v96, v96
  v_exp_f32 v97, v97
  v_exp_f32 v98, v98
  v_exp_f32 v99, v99
  v_exp_f32 v100, v100
  v_exp_f32 v101, v101
  v_mfma_f32_32x32x16_bf16 v[64:79], v[36:39], v[20:23], v[64:79]
  v_exp_f32 v102, v102
  v_exp_f32 v103, v103
  v_exp_f32 v104, v104
  v_exp_f32 v105, v105
  v_exp_f32 v106, v106
  v_exp_f32 v107, v107
  v_mfma_f32_32x32x16_bf16 v[80:95], v[32:35], v[24:27], 0
  v_exp_f32 v108, v108
  v_exp_f32 v109, v109
  v_exp_f32 v110, v110
  v_exp_f32 v111, v111
  v_cvt_pk_bf16_f32 v144, v96, v97
  v_cvt_pk_bf16_f32 v145, v98, v99
  v_mfma_f32_32x32x16_bf16 v[80:95], v[36:39], v[28:31], v[80:95]
  v_cvt_pk_bf16_f32 v146, v100, v101
  v_cvt_pk_bf16_f32 v147, v102, v103
  v_cvt_pk_bf16_f32 v148, v104, v105
  v_cvt_pk_bf16_f32 v149, v106, v107
  v_cvt_pk_bf16_f32 v150, v108, v109
  v_cvt_pk_bf16_f32 v151, v110, v111
  v_mfma_f32_32x32x16_bf16 v[160:175], v[48:51], v[128:131], v[160:175]
  v_exp_f32 v112, v112
  v_exp_f32 v113, v113
  v_exp_f32 v114, v114
  v_exp_f32 v115, v115
  v_exp_f32 v116, v116
  v_exp_f32 v117, v117
  v_mfma_f32_32x32x16_bf16 v[160:175], v[52:55], v[132:135], v[160:175]
  v_exp_f32 v118, v118
  v_exp_f32 v119, v119
  v_exp_f32 v120, v120
  v_exp_f32 v121, v121
  v_exp_f32 v122, v122
  v_exp_f32 v123, v123
  v_mfma_f32_32x32x16_bf16 v[176:191], v[48:51], v[136:139], v[176:191]
  v_exp_f32 v124, v124
  v_exp_f32 v125, v125
  v_exp_f32 v126, v126
  v_exp_f32 v127, v127
  v_cvt_pk_bf16_f32 v152, v112, v113
  v_cvt_pk_bf16_f32 v153, v114, v115
  v_mfma_f32_32x32x16_bf16 v[176:191], v[52:55], v[140:143], v[176:191]
  v_cvt_pk_bf16_f32 v154, v116, v117
  v_cvt_pk_bf16_f32 v155, v118, v119
  v_cvt_pk_bf16_f32 v156, v120, v121
  v_cvt_pk_bf16_f32 v157, v122, v123
  v_cvt_pk_bf16_f32 v158, v124, v125
  v_cvt_pk_bf16_f32 v159, v126, v127
  s_waitcnt vmcnt(4)
  s_barrier
  s_add_u32 m0, s26, 49152
  s_nop 0
  buffer_load_dwordx4 v12, s[8:11], s28 offen offset:0 lds
  buffer_load_dwordx4 v12, s[8:11], s28 offen offset:1024 lds
  buffer_load_dwordx4 v12, s[8:11], s28 offen offset:2048 lds
  buffer_load_dwordx4 v12, s[8:11], s28 offen offset:3072 lds
  s_add_u32 s28, s28, 16384
  ds_read_b128 v[32:35], v13 offset:16384
  ds_read_b128 v[36:39], v13 offset:17408
  ds_read_b128 v[48:51], v13 offset:10240
  ds_read_b128 v[52:55], v13 offset:11264
  s_waitcnt lgkmcnt(4)
  v_mfma_f32_32x32x16_bf16 v[96:111], v[40:43], v[16:19], 0
  v_exp_f32 v64, v64
  v_exp_f32 v65, v65
  v_exp_f32 v66, v66
  v_exp_f32 v67, v67
  v_exp_f32 v68, v68
  v_exp_f32 v69, v69
  v_mfma_f32_32x32x16_bf16 v[96:111], v[44:47], v[20:23], v[96:111]
  v_exp_f32 v70, v70
  v_exp_f32 v71, v71
  v_exp_f32 v72, v72
  v_exp_f32 v73, v73
  v_exp_f32 v74, v74
  v_exp_f32 v75, v75
  v_mfma_f32_32x32x16_bf16 v[112:127], v[40:43], v[24:27], 0
  v_exp_f32 v76, v76
  v_exp_f32 v77, v77
  v_exp_f32 v78, v78
  v_exp_f32 v79, v79
  v_cvt_pk_bf16_f32 v128, v64, v65
  v_cvt_pk_bf16_f32 v129, v66, v67
  v_mfma_f32_32x32x16_bf16 v[112:127], v[44:47], v[28:31], v[112:127]
  v_cvt_pk_bf16_f32 v130, v68, v69
  v_cvt_pk_bf16_f32 v131, v70, v71
  v_cvt_pk_bf16_f32 v132, v72, v73
  v_cvt_pk_bf16_f32 v133, v74, v75
  v_cvt_pk_bf16_f32 v134, v76, v77
  v_cvt_pk_bf16_f32 v135, v78, v79
  v_mfma_f32_32x32x16_bf16 v[160:175], v[56:59], v[144:147], v[160:175]
  v_exp_f32 v80, v80
  v_exp_f32 v81, v81
  v_exp_f32 v82, v82
  v_exp_f32 v83, v83
  v_exp_f32 v84, v84
  v_exp_f32 v85, v85
  v_mfma_f32_32x32x16_bf16 v[160:175], v[60:63], v[148:151], v[160:175]
  v_exp_f32 v86, v86
  v_exp_f32 v87, v87
  v_exp_f32 v88, v88
  v_exp_f32 v89, v89
  v_exp_f32 v90, v90
  v_exp_f32 v91, v91
  v_mfma_f32_32x32x16_bf16 v[176:191], v[56:59], v[152:155], v[176:191]
  v_exp_f32 v92, v92
  v_exp_f32 v93, v93
  v_exp_f32 v94, v94
  v_exp_f32 v95, v95
  v_cvt_pk_bf16_f32 v136, v80, v81
  v_cvt_pk_bf16_f32 v137, v82, v83
  v_mfma_f32_32x32x16_bf16 v[176:191], v[60:63], v[156:159], v[176:191]
  v_cvt_pk_bf16_f32 v138, v84, v85
  v_cvt_pk_bf16_f32 v139, v86, v87
  v_cvt_pk_bf16_f32 v140, v88, v89
  v_cvt_pk_bf16_f32 v141, v90, v91
  v_cvt_pk_bf16_f32 v142, v92, v93
  v_cvt_pk_bf16_f32 v143, v94, v95
  ds_read_b128 v[40:43], v13 offset:20480
  ds_read_b128 v[44:47], v13 offset:21504
  ds_read_b128 v[56:59], v13 offset:14336
  ds_read_b128 v[60:63], v13 offset:15360
  s_waitcnt lgkmcnt(4)
  v_mfma_f32_32x32x16_bf16 v[64:79], v[32:35], v[16:19], 0
  v_exp_f32 v96, v96
  v_exp_f32 v97, v97
  v_exp_f32 v98, v98
  v_exp_f32 v99, v99
  v_exp_f32 v100, v100
  v_exp_f32 v101, v101
  v_mfma_f32_32x32x16_bf16 v[64:79], v[36:39], v[20:23], v[64:79]
  v_exp_f32 v102, v102
  v_exp_f32 v103, v103
  v_exp_f32 v104, v104
  v_exp_f32 v105, v105
  v_exp_f32 v106, v106
  v_exp_f32 v107, v107
  v_mfma_f32_32x32x16_bf16 v[80:95], v[32:35], v[24:27], 0
  v_exp_f32 v108, v108
  v_exp_f32 v109, v109
  v_exp_f32 v110, v110
  v_exp_f32 v111, v111
  v_cvt_pk_bf16_f32 v144, v96, v97
  v_cvt_pk_bf16_f32 v145, v98, v99
  v_mfma_f32_32x32x16_bf16 v[80:95], v[36:39], v[28:31], v[80:95]
  v_cvt_pk_bf16_f32 v146, v100, v101
  v_cvt_pk_bf16_f32 v147, v102, v103
  v_cvt_pk_bf16_f32 v148, v104, v105
  v_cvt_pk_bf16_f32 v149, v106, v107
  v_cvt_pk_bf16_f32 v150, v108, v109
  v_cvt_pk_bf16_f32 v151, v110, v111
  v_mfma_f32_32x32x16_bf16 v[160:175], v[48:51], v[128:131], v[160:175]
  v_exp_f32 v112, v112
  v_exp_f32 v113, v113
  v_exp_f32 v114, v114
  v_exp_f32 v115, v115
  v_exp_f32 v116, v116
  v_exp_f32 v117, v117
  v_mfma_f32_32x32x16_bf16 v[160:175], v[52:55], v[132:135], v[160:175]
  v_exp_f32 v118, v118
  v_exp_f32 v119, v119
  v_exp_f32 v120, v120
  v_exp_f32 v121, v121
  v_exp_f32 v122, v122
  v_exp_f32 v123, v123
  v_mfma_f32_32x32x16_bf16 v[176:191], v[48:51], v[136:139], v[176:191]
  v_exp_f32 v124, v124
  v_exp_f32 v125, v125
  v_exp_f32 v126, v126
  v_exp_f32 v127, v127
  v_cvt_pk_bf16_f32 v152, v112, v113
  v_cvt_pk_bf16_f32 v153, v114, v115
  v_mfma_f32_32x32x16_bf16 v[176:191], v[52:55], v[140:143], v[176:191]
  v_cvt_pk_bf16_f32 v154, v116, v117
  v_cvt_pk_bf16_f32 v155, v118, v119
  v_cvt_pk_bf16_f32 v156, v120, v121
  v_cvt_pk_bf16_f32 v157, v122, v123
  v_cvt_pk_bf16_f32 v158, v124, v125
  v_cvt_pk_bf16_f32 v159, v126, v127
  ds_read_b128 v[32:35], v13 offset:24576
  ds_read_b128 v[36:39], v13 offset:25600
  ds_read_b128 v[48:51], v13 offset:18432
  ds_read_b128 v[52:55], v13 offset:19456
  s_waitcnt lgkmcnt(4)
  v_mfma_f32_32x32x16_bf16 v[96:111], v[40:43], v[16:19], 0
  v_exp_f32 v64, v64
  v_exp_f32 v65, v65
  v_exp_f32 v66, v66
  v_exp_f32 v67, v67
  v_exp_f32 v68, v68
  v_exp_f32 v69, v69
  v_mfma_f32_32x32x16_bf16 v[96:111], v[44:47], v[20:23], v[96:111]
  v_exp_f32 v70, v70
  v_exp_f32 v71, v71
  v_exp_f32 v72, v72
  v_exp_f32 v73, v73
  v_exp_f32 v74, v74
  v_exp_f32 v75, v75
  v_mfma_f32_32x32x16_bf16 v[112:127], v[40:43], v[24:27], 0
  v_exp_f32 v76, v76
  v_exp_f32 v77, v77
  v_exp_f32 v78, v78
  v_exp_f32 v79, v79
  v_cvt_pk_bf16_f32 v128, v64, v65
  v_cvt_pk_bf16_f32 v129, v66, v67
  v_mfma_f32_32x32x16_bf16 v[112:127], v[44:47], v[28:31], v[112:127]
  v_cvt_pk_bf16_f32 v130, v68, v69
  v_cvt_pk_bf16_f32 v131, v70, v71
  v_cvt_pk_bf16_f32 v132, v72, v73
  v_cvt_pk_bf16_f32 v133, v74, v75
  v_cvt_pk_bf16_f32 v134, v76, v77
  v_cvt_pk_bf16_f32 v135, v78, v79
  v_mfma_f32_32x32x16_bf16 v[160:175], v[56:59], v[144:147], v[160:175]
  v_exp_f32 v80, v80
  v_exp_f32 v81, v81
  v_exp_f32 v82, v82
  v_exp_f32 v83, v83
  v_exp_f32 v84, v84
  v_exp_f32 v85, v85
  v_mfma_f32_32x32x16_bf16 v[160:175], v[60:63], v[148:151], v[160:175]
  v_exp_f32 v86, v86
  v_exp_f32 v87, v87
  v_exp_f32 v88, v88
  v_exp_f32 v89, v89
  v_exp_f32 v90, v90
  v_exp_f32 v91, v91
  v_mfma_f32_32x32x16_bf16 v[176:191], v[56:59], v[152:155], v[176:191]
  v_exp_f32 v92, v92
  v_exp_f32 v93, v93
  v_exp_f32 v94, v94
  v_exp_f32 v95, v95
  v_cvt_pk_bf16_f32 v136, v80, v81
  v_cvt_pk_bf16_f32 v137, v82, v83
  v_mfma_f32_32x32x16_bf16 v[176:191], v[60:63], v[156:159], v[176:191]
  v_cvt_pk_bf16_f32 v138, v84, v85
  v_cvt_pk_bf16_f32 v139, v86, v87
  v_cvt_pk_bf16_f32 v140, v88, v89
  v_cvt_pk_bf16_f32 v141, v90, v91
  v_cvt_pk_bf16_f32 v142, v92, v93
  v_cvt_pk_bf16_f32 v143, v94, v95
  ds_read_b128 v[40:43], v13 offset:28672
  ds_read_b128 v[44:47], v13 offset:29696
  ds_read_b128 v[56:59], v13 offset:22528
  ds_read_b128 v[60:63], v13 offset:23552
  s_waitcnt lgkmcnt(4)
  v_mfma_f32_32x32x16_bf16 v[64:79], v[32:35], v[16:19], 0
  v_exp_f32 v96, v96
  v_exp_f32 v97, v97
  v_exp_f32 v98, v98
  v_exp_f32 v99, v99
  v_exp_f32 v100, v100
  v_exp_f32 v101, v101
  v_mfma_f32_32x32x16_bf16 v[64:79], v[36:39], v[20:23], v[64:79]
  v_exp_f32 v102, v102
  v_exp_f32 v103, v103
  v_exp_f32 v104, v104
  v_exp_f32 v105, v105
  v_exp_f32 v106, v106
  v_exp_f32 v107, v107
  v_mfma_f32_32x32x16_bf16 v[80:95], v[32:35], v[24:27], 0
  v_exp_f32 v108, v108
  v_exp_f32 v109, v109
  v_exp_f32 v110, v110
  v_exp_f32 v111, v111
  v_cvt_pk_bf16_f32 v144, v96, v97
  v_cvt_pk_bf16_f32 v145, v98, v99
  v_mfma_f32_32x32x16_bf16 v[80:95], v[36:39], v[28:31], v[80:95]
  v_cvt_pk_bf16_f32 v146, v100, v101
  v_cvt_pk_bf16_f32 v147, v102, v103
  v_cvt_pk_bf16_f32 v148, v104, v105
  v_cvt_pk_bf16_f32 v149, v106, v107
  v_cvt_pk_bf16_f32 v150, v108, v109
  v_cvt_pk_bf16_f32 v151, v110, v111
  v_mfma_f32_32x32x16_bf16 v[160:175], v[48:51], v[128:131], v[160:175]
  v_exp_f32 v112, v112
  v_exp_f32 v113, v113
  v_exp_f32 v114, v114
  v_exp_f32 v115, v115
  v_exp_f32 v116, v116
  v_exp_f32 v117, v117
  v_mfma_f32_32x32x16_bf16 v[160:175], v[52:55], v[132:135], v[160:175]
  v_exp_f32 v118, v118
  v_exp_f32 v119, v119
  v_exp_f32 v120, v120
  v_exp_f32 v121, v121
  v_exp_f32 v122, v122
  v_exp_f32 v123, v123
  v_mfma_f32_32x32x16_bf16 v[176:191], v[48:51], v[136:139], v[176:191]
  v_exp_f32 v124, v124
  v_exp_f32 v125, v125
  v_exp_f32 v126, v126
  v_exp_f32 v127, v127
  v_cvt_pk_bf16_f32 v152, v112, v113
  v_cvt_pk_bf16_f32 v153, v114, v115
  v_mfma_f32_32x32x16_bf16 v[176:191], v[52:55], v[140:143], v[176:191]
  v_cvt_pk_bf16_f32 v154, v116, v117
  v_cvt_pk_bf16_f32 v155, v118, v119
  v_cvt_pk_bf16_f32 v156, v120, v121
  v_cvt_pk_bf16_f32 v157, v122, v123
  v_cvt_pk_bf16_f32 v158, v124, v125
  v_cvt_pk_bf16_f32 v159, v126, v127
  s_waitcnt vmcnt(4)
  s_barrier
  ds_read_b128 v[32:35], v13 offset:32768
  ds_read_b128 v[36:39], v13 offset:33792
  ds_read_b128 v[48:51], v13 offset:26624
  ds_read_b128 v[52:55], v13 offset:27648
  s_waitcnt lgkmcnt(4)
  v_mfma_f32_32x32x16_bf16 v[96:111], v[40:43], v[16:19], 0
  v_exp_f32 v64, v64
  v_exp_f32 v65, v65
  v_exp_f32 v66, v66
  v_exp_f32 v67, v67
  v_exp_f32 v68, v68
  v_exp_f32 v69, v69
  v_mfma_f32_32x32x16_bf16 v[96:111], v[44:47], v[20:23], v[96:111]
  v_exp_f32 v70, v70
  v_exp_f32 v71, v71
  v_exp_f32 v72, v72
  v_exp_f32 v73, v73
  v_exp_f32 v74, v74
  v_exp_f32 v75, v75
  v_mfma_f32_32x32x16_bf16 v[112:127], v[40:43], v[24:27], 0
  v_exp_f32 v76, v76
  v_exp_f32 v77, v77
  v_exp_f32 v78, v78
  v_exp_f32 v79, v79
  v_cvt_pk_bf16_f32 v128, v64, v65
  v_cvt_pk_bf16_f32 v129, v66, v67
  v_mfma_f32_32x32x16_bf16 v[112:127], v[44:47], v[28:31], v[112:127]
  v_cvt_pk_bf16_f32 v130, v68, v69
  v_cvt_pk_bf16_f32 v131, v70, v71
  v_cvt_pk_bf16_f32 v132, v72, v73
  v_cvt_pk_bf16_f32 v133, v74, v75
  v_cvt_pk_bf16_f32 v134, v76, v77
  v_cvt_pk_bf16_f32 v135, v78, v79
  v_mfma_f32_32x32x16_bf16 v[160:175], v[56:59], v[144:147], v[160:175]
  v_exp_f32 v80, v80
  v_exp_f32 v81, v81
  v_exp_f32 v82, v82
  v_exp_f32 v83, v83
  v_exp_f32 v84, v84
  v_exp_f32 v85, v85
  v_mfma_f32_32x32x16_bf16 v[160:175], v[60:63], v[148:151], v[160:175]
  v_exp_f32 v86, v86
  v_exp_f32 v87, v87
  v_exp_f32 v88, v88
  v_exp_f32 v89, v89
  v_exp_f32 v90, v90
  v_exp_f32 v91, v91
  v_mfma_f32_32x32x16_bf16 v[176:191], v[56:59], v[152:155], v[176:191]
  v_exp_f32 v92, v92
  v_exp_f32 v93, v93
  v_exp_f32 v94, v94
  v_exp_f32 v95, v95
  v_cvt_pk_bf16_f32 v136, v80, v81
  v_cvt_pk_bf16_f32 v137, v82, v83
  v_mfma_f32_32x32x16_bf16 v[176:191], v[60:63], v[156:159], v[176:191]
  v_cvt_pk_bf16_f32 v138, v84, v85
  v_cvt_pk_bf16_f32 v139, v86, v87
  v_cvt_pk_bf16_f32 v140, v88, v89
  v_cvt_pk_bf16_f32 v141, v90, v91
  v_cvt_pk_bf16_f32 v142, v92, v93
  v_cvt_pk_bf16_f32 v143, v94, v95
  ds_read_b128 v[40:43], v13 offset:36864
  ds_read_b128 v[44:47], v13 offset:37888
  ds_read_b128 v[56:59], v13 offset:30720
  ds_read_b128 v[60:63], v13 offset:31744
  s_waitcnt lgkmcnt(4)
  v_mfma_f32_32x32x16_bf16 v[64:79], v[32:35], v[16:19], 0
  v_exp_f32 v96, v96
  v_exp_f32 v97, v97
  v_exp_f32 v98, v98
  v_exp_f32 v99, v99
  v_exp_f32 v100, v100
  v_exp_f32 v101, v101
  v_mfma_f32_32x32x16_bf16 v[64:79], v[36:39], v[20:23], v[64:79]
  v_exp_f32 v102, v102
  v_exp_f32 v103, v103
  v_exp_f32 v104, v104
  v_exp_f32 v105, v105
  v_exp_f32 v106, v106
  v_exp_f32 v107, v107
  v_mfma_f32_32x32x16_bf16 v[80:95], v[32:35], v[24:27], 0
  v_exp_f32 v108, v108
  v_exp_f32 v109, v109
  v_exp_f32 v110, v110
  v_exp_f32 v111, v111
  v_cvt_pk_bf16_f32 v144, v96, v97
  v_cvt_pk_bf16_f32 v145, v98, v99
  v_mfma_f32_32x32x16_bf16 v[80:95], v[36:39], v[28:31], v[80:95]
  v_cvt_pk_bf16_f32 v146, v100, v101
  v_cvt_pk_bf16_f32 v147, v102, v103
  v_cvt_pk_bf16_f32 v148, v104, v105
  v_cvt_pk_bf16_f32 v149, v106, v107
  v_cvt_pk_bf16_f32 v150, v108, v109
  v_cvt_pk_bf16_f32 v151, v110, v111
  v_mfma_f32_32x32x16_bf16 v[160:175], v[48:51], v[128:131], v[160:175]
  v_exp_f32 v112, v112
  v_exp_f32 v113, v113
  v_exp_f32 v114, v114
  v_exp_f32 v115, v115
  v_exp_f32 v116, v116
  v_exp_f32 v117, v117
  v_mfma_f32_32x32x16_bf16 v[160:175], v[52:55], v[132:135], v[160:175]
  v_exp_f32 v118, v118
  v_exp_f32 v119, v119
  v_exp_f32 v120, v120
  v_exp_f32 v121, v121
  v_exp_f32 v122, v122
  v_exp_f32 v123, v123
  v_mfma_f32_32x32x16_bf16 v[176:191], v[48:51], v[136:139], v[176:191]
  v_exp_f32 v124, v124
  v_exp_f32 v125, v125
  v_exp_f32 v126, v126
  v_exp_f32 v127, v127
  v_cvt_pk_bf16_f32 v152, v112, v113
  v_cvt_pk_bf16_f32 v153, v114, v115
  v_mfma_f32_32x32x16_bf16 v[176:191], v[52:55], v[140:143], v[176:191]
  v_cvt_pk_bf16_f32 v154, v116, v117
  v_cvt_pk_bf16_f32 v155, v118, v119
  v_cvt_pk_bf16_f32 v156, v120, v121
  v_cvt_pk_bf16_f32 v157, v122, v123
  v_cvt_pk_bf16_f32 v158, v124, v125
  v_cvt_pk_bf16_f32 v159, v126, v127
  ds_read_b128 v[32:35], v13 offset:40960
  ds_read_b128 v[36:39], v13 offset:41984
  ds_read_b128 v[48:51], v13 offset:34816
  ds_read_b128 v[52:55], v13 offset:35840
  s_waitcnt lgkmcnt(4)
  v_mfma_f32_32x32x16_bf16 v[96:111], v[40:43], v[16:19], 0
  v_exp_f32 v64, v64
  v_exp_f32 v65, v65
  v_exp_f32 v66, v66
  v_exp_f32 v67, v67
  v_exp_f32 v68, v68
  v_exp_f32 v69, v69
  v_mfma_f32_32x32x16_bf16 v[96:111], v[44:47], v[20:23], v[96:111]
  v_exp_f32 v70, v70
  v_exp_f32 v71, v71
  v_exp_f32 v72, v72
  v_exp_f32 v73, v73
  v_exp_f32 v74, v74
  v_exp_f32 v75, v75
  v_mfma_f32_32x32x16_bf16 v[112:127], v[40:43], v[24:27], 0
  v_exp_f32 v76, v76
  v_exp_f32 v77, v77
  v_exp_f32 v78, v78
  v_exp_f32 v79, v79
  v_cvt_pk_bf16_f32 v128, v64, v65
  v_cvt_pk_bf16_f32 v129, v66, v67
  v_mfma_f32_32x32x16_bf16 v[112:127], v[44:47], v[28:31], v[112:127]
  v_cvt_pk_bf16_f32 v130, v68, v69
  v_cvt_pk_bf16_f32 v131, v70, v71
  v_cvt_pk_bf16_f32 v132, v72, v73
  v_cvt_pk_bf16_f32 v133, v74, v75
  v_cvt_pk_bf16_f32 v134, v76, v77
  v_cvt_pk_bf16_f32 v135, v78, v79
  v_mfma_f32_32x32x16_bf16 v[160:175], v[56:59], v[144:147], v[160:175]
  v_exp_f32 v80, v80
  v_exp_f32 v81, v81
  v_exp_f32 v82, v82
  v_exp_f32 v83, v83
  v_exp_f32 v84, v84
  v_exp_f32 v85, v85
  v_mfma_f32_32x32x16_bf16 v[160:175], v[60:63], v[148:151], v[160:175]
  v_exp_f32 v86, v86
  v_exp_f32 v87, v87
  v_exp_f32 v88, v88
  v_exp_f32 v89, v89
  v_exp_f32 v90, v90
  v_exp_f32 v91, v91
  v_mfma_f32_32x32x16_bf16 v[176:191], v[56:59], v[152:155], v[176:191]
  v_exp_f32 v92, v92
  v_exp_f32 v93, v93
  v_exp_f32 v94, v94
  v_exp_f32 v95, v95
  v_cvt_pk_bf16_f32 v136, v80, v81
  v_cvt_pk_bf16_f32 v137, v82, v83
  v_mfma_f32_32x32x16_bf16 v[176:191], v[60:63], v[156:159], v[176:191]
  v_cvt_pk_bf16_f32 v138, v84, v85
  v_cvt_pk_bf16_f32 v139, v86, v87
  v_cvt_pk_bf16_f32 v140, v88, v89
  v_cvt_pk_bf16_f32 v141, v90, v91
  v_cvt_pk_bf16_f32 v142, v92, v93
  v_cvt_pk_bf16_f32 v143, v94, v95
  ds_read_b128 v[40:43], v13 offset:45056
  ds_read_b128 v[44:47], v13 offset:46080
  ds_read_b128 v[56:59], v13 offset:38912
  ds_read_b128 v[60:63], v13 offset:39936
  s_waitcnt lgkmcnt(4)
  v_mfma_f32_32x32x16_bf16 v[64:79], v[32:35], v[16:19], 0
  v_exp_f32 v96, v96
  v_exp_f32 v97, v97
  v_exp_f32 v98, v98
  v_exp_f32 v99, v99
  v_exp_f32 v100, v100
  v_exp_f32 v101, v101
  v_mfma_f32_32x32x16_bf16 v[64:79], v[36:39], v[20:23], v[64:79]
  v_exp_f32 v102, v102
  v_exp_f32 v103, v103
  v_exp_f32 v104, v104
  v_exp_f32 v105, v105
  v_exp_f32 v106, v106
  v_exp_f32 v107, v107
  v_mfma_f32_32x32x16_bf16 v[80:95], v[32:35], v[24:27], 0
  v_exp_f32 v108, v108
  v_exp_f32 v109, v109
  v_exp_f32 v110, v110
  v_exp_f32 v111, v111
  v_cvt_pk_bf16_f32 v144, v96, v97
  v_cvt_pk_bf16_f32 v145, v98, v99
  v_mfma_f32_32x32x16_bf16 v[80:95], v[36:39], v[28:31], v[80:95]
  v_cvt_pk_bf16_f32 v146, v100, v101
  v_cvt_pk_bf16_f32 v147, v102, v103
  v_cvt_pk_bf16_f32 v148, v104, v105
  v_cvt_pk_bf16_f32 v149, v106, v107
  v_cvt_pk_bf16_f32 v150, v108, v109
  v_cvt_pk_bf16_f32 v151, v110, v111
  v_mfma_f32_32x32x16_bf16 v[160:175], v[48:51], v[128:131], v[160:175]
  v_exp_f32 v112, v112
  v_exp_f32 v113, v113
  v_exp_f32 v114, v114
  v_exp_f32 v115, v115
  v_exp_f32 v116, v116
  v_exp_f32 v117, v117
  v_mfma_f32_32x32x16_bf16 v[160:175], v[52:55], v[132:135], v[160:175]
  v_exp_f32 v118, v118
  v_exp_f32 v119, v119
  v_exp_f32 v120, v120
  v_exp_f32 v121, v121
  v_exp_f32 v122, v122
  v_exp_f32 v123, v123
  v_mfma_f32_32x32x16_bf16 v[176:191], v[48:51], v[136:139], v[176:191]
  v_exp_f32 v124, v124
  v_exp_f32 v125, v125
  v_exp_f32 v126, v126
  v_exp_f32 v127, v127
  v_cvt_pk_bf16_f32 v152, v112, v113
  v_cvt_pk_bf16_f32 v153, v114, v115
  v_mfma_f32_32x32x16_bf16 v[176:191], v[52:55], v[140:143], v[176:191]
  v_cvt_pk_bf16_f32 v154, v116, v117
  v_cvt_pk_bf16_f32 v155, v118, v119
  v_cvt_pk_bf16_f32 v156, v120, v121
  v_cvt_pk_bf16_f32 v157, v122, v123
  v_cvt_pk_bf16_f32 v158, v124, v125
  v_cvt_pk_bf16_f32 v159, v126, v127
  s_waitcnt vmcnt(0)
  s_barrier
  ds_read_b128 v[32:35], v13 offset:49152
  ds_read_b128 v[36:39], v13 offset:50176
  ds_read_b128 v[48:51], v13 offset:43008
  ds_read_b128 v[52:55], v13 offset:44032
  s_waitcnt lgkmcnt(4)
  v_mfma_f32_32x32x16_bf16 v[96:111], v[40:43], v[16:19], 0
  v_exp_f32 v64, v64
  v_exp_f32 v65, v65
  v_exp_f32 v66, v66
  v_exp_f32 v67, v67
  v_exp_f32 v68, v68
  v_exp_f32 v69, v69
  v_mfma_f32_32x32x16_bf16 v[96:111], v[44:47], v[20:23], v[96:111]
  v_exp_f32 v70, v70
  v_exp_f32 v71, v71
  v_exp_f32 v72, v72
  v_exp_f32 v73, v73
  v_exp_f32 v74, v74
  v_exp_f32 v75, v75
  v_mfma_f32_32x32x16_bf16 v[112:127], v[40:43], v[24:27], 0
  v_exp_f32 v76, v76
  v_exp_f32 v77, v77
  v_exp_f32 v78, v78
  v_exp_f32 v79, v79
  v_cvt_pk_bf16_f32 v128, v64, v65
  v_cvt_pk_bf16_f32 v129, v66, v67
  v_mfma_f32_32x32x16_bf16 v[112:127], v[44:47], v[28:31], v[112:127]
  v_cvt_pk_bf16_f32 v130, v68, v69
  v_cvt_pk_bf16_f32 v131, v70, v71
  v_cvt_pk_bf16_f32 v132, v72, v73
  v_cvt_pk_bf16_f32 v133, v74, v75
  v_cvt_pk_bf16_f32 v134, v76, v77
  v_cvt_pk_bf16_f32 v135, v78, v79
  v_mfma_f32_32x32x16_bf16 v[160:175], v[56:59], v[144:147], v[160:175]
  v_exp_f32 v80, v80
  v_exp_f32 v81, v81
  v_exp_f32 v82, v82
  v_exp_f32 v83, v83
  v_exp_f32 v84, v84
  v_exp_f32 v85, v85
  v_mfma_f32_32x32x16_bf16 v[160:175], v[60:63], v[148:151], v[160:175]
  v_exp_f32 v86, v86
  v_exp_f32 v87, v87
  v_exp_f32 v88, v88
  v_exp_f32 v89, v89
  v_exp_f32 v90, v90
  v_exp_f32 v91, v91
  v_mfma_f32_32x32x16_bf16 v[176:191], v[56:59], v[152:155], v[176:191]
  v_exp_f32 v92, v92
  v_exp_f32 v93, v93
  v_exp_f32 v94, v94
  v_exp_f32 v95, v95
  v_cvt_pk_bf16_f32 v136, v80, v81
  v_cvt_pk_bf16_f32 v137, v82, v83
  v_mfma_f32_32x32x16_bf16 v[176:191], v[60:63], v[156:159], v[176:191]
  v_cvt_pk_bf16_f32 v138, v84, v85
  v_cvt_pk_bf16_f32 v139, v86, v87
  v_cvt_pk_bf16_f32 v140, v88, v89
  v_cvt_pk_bf16_f32 v141, v90, v91
  v_cvt_pk_bf16_f32 v142, v92, v93
  v_cvt_pk_bf16_f32 v143, v94, v95
  ds_read_b128 v[40:43], v13 offset:53248
  ds_read_b128 v[44:47], v13 offset:54272
  ds_read_b128 v[56:59], v13 offset:47104
  ds_read_b128 v[60:63], v13 offset:48128
  s_waitcnt lgkmcnt(4)
  v_mfma_f32_32x32x16_bf16 v[64:79], v[32:35], v[16:19], 0
  v_exp_f32 v96, v96
  v_exp_f32 v97, v97
  v_exp_f32 v98, v98
  v_exp_f32 v99, v99
  v_exp_f32 v100, v100
  v_exp_f32 v101, v101
  v_mfma_f32_32x32x16_bf16 v[64:79], v[36:39], v[20:23], v[64:79]
  v_exp_f32 v102, v102
  v_exp_f32 v103, v103
  v_exp_f32 v104, v104
  v_exp_f32 v105, v105
  v_exp_f32 v106, v106
  v_exp_f32 v107, v107
  v_mfma_f32_32x32x16_bf16 v[80:95], v[32:35], v[24:27], 0
  v_exp_f32 v108, v108
  v_exp_f32 v109, v109
  v_exp_f32 v110, v110
  v_exp_f32 v111, v111
  v_cvt_pk_bf16_f32 v144, v96, v97
  v_cvt_pk_bf16_f32 v145, v98, v99
  v_mfma_f32_32x32x16_bf16 v[80:95], v[36:39], v[28:31], v[80:95]
  v_cvt_pk_bf16_f32 v146, v100, v101
  v_cvt_pk_bf16_f32 v147, v102, v103
  v_cvt_pk_bf16_f32 v148, v104, v105
  v_cvt_pk_bf16_f32 v149, v106, v107
  v_cvt_pk_bf16_f32 v150, v108, v109
  v_cvt_pk_bf16_f32 v151, v110, v111
  v_mfma_f32_32x32x16_bf16 v[160:175], v[48:51], v[128:131], v[160:175]
  v_exp_f32 v112, v112
  v_exp_f32 v113, v113
  v_exp_f32 v114, v114
  v_exp_f32 v115, v115
  v_exp_f32 v116, v116
  v_exp_f32 v117, v117
  v_mfma_f32_32x32x16_bf16 v[160:175], v[52:55], v[132:135], v[160:175]
  v_exp_f32 v118, v118
  v_exp_f32 v119, v119
  v_exp_f32 v120, v120
  v_exp_f32 v121, v121
  v_exp_f32 v122, v122
  v_exp_f32 v123, v123
  v_mfma_f32_32x32x16_bf16 v[176:191], v[48:51], v[136:139], v[176:191]
  v_exp_f32 v124, v124
  v_exp_f32 v125, v125
  v_exp_f32 v126, v126
  v_exp_f32 v127, v127
  v_cvt_pk_bf16_f32 v152, v112, v113
  v_cvt_pk_bf16_f32 v153, v114, v115
  v_mfma_f32_32x32x16_bf16 v[176:191], v[52:55], v[140:143], v[176:191]
  v_cvt_pk_bf16_f32 v154, v116, v117
  v_cvt_pk_bf16_f32 v155, v118, v119
  v_cvt_pk_bf16_f32 v156, v120, v121
  v_cvt_pk_bf16_f32 v157, v122, v123
  v_cvt_pk_bf16_f32 v158, v124, v125
  v_cvt_pk_bf16_f32 v159, v126, v127
  ds_read_b128 v[32:35], v13 offset:57344
  ds_read_b128 v[36:39], v13 offset:58368
  ds_read_b128 v[48:51], v13 offset:51200
  ds_read_b128 v[52:55], v13 offset:52224
  s_waitcnt lgkmcnt(4)
  v_mfma_f32_32x32x16_bf16 v[96:111], v[40:43], v[16:19], 0
  v_exp_f32 v64, v64
  v_exp_f32 v65, v65
  v_exp_f32 v66, v66
  v_exp_f32 v67, v67
  v_exp_f32 v68, v68
  v_exp_f32 v69, v69
  v_mfma_f32_32x32x16_bf16 v[96:111], v[44:47], v[20:23], v[96:111]
  v_exp_f32 v70, v70
  v_exp_f32 v71, v71
  v_exp_f32 v72, v72
  v_exp_f32 v73, v73
  v_exp_f32 v74, v74
  v_exp_f32 v75, v75
  v_mfma_f32_32x32x16_bf16 v[112:127], v[40:43], v[24:27], 0
  v_exp_f32 v76, v76
  v_exp_f32 v77, v77
  v_exp_f32 v78, v78
  v_exp_f32 v79, v79
  v_cvt_pk_bf16_f32 v128, v64, v65
  v_cvt_pk_bf16_f32 v129, v66, v67
  v_mfma_f32_32x32x16_bf16 v[112:127], v[44:47], v[28:31], v[112:127]
  v_cvt_pk_bf16_f32 v130, v68, v69
  v_cvt_pk_bf16_f32 v131, v70, v71
  v_cvt_pk_bf16_f32 v132, v72, v73
  v_cvt_pk_bf16_f32 v133, v74, v75
  v_cvt_pk_bf16_f32 v134, v76, v77
  v_cvt_pk_bf16_f32 v135, v78, v79
  v_mfma_f32_32x32x16_bf16 v[160:175], v[56:59], v[144:147], v[160:175]
  v_exp_f32 v80, v80
  v_exp_f32 v81, v81
  v_exp_f32 v82, v82
  v_exp_f32 v83, v83
  v_exp_f32 v84, v84
  v_exp_f32 v85, v85
  v_mfma_f32_32x32x16_bf16 v[160:175], v[60:63], v[148:151], v[160:175]
  v_exp_f32 v86, v86
  v_exp_f32 v87, v87
  v_exp_f32 v88, v88
  v_exp_f32 v89, v89
  v_exp_f32 v90, v90
  v_exp_f32 v91, v91
  v_mfma_f32_32x32x16_bf16 v[176:191], v[56:59], v[152:155], v[176:191]
  v_exp_f32 v92, v92
  v_exp_f32 v93, v93
  v_exp_f32 v94, v94
  v_exp_f32 v95, v95
  v_cvt_pk_bf16_f32 v136, v80, v81
  v_cvt_pk_bf16_f32 v137, v82, v83
  v_mfma_f32_32x32x16_bf16 v[176:191], v[60:63], v[156:159], v[176:191]
  v_cvt_pk_bf16_f32 v138, v84, v85
  v_cvt_pk_bf16_f32 v139, v86, v87
  v_cvt_pk_bf16_f32 v140, v88, v89
  v_cvt_pk_bf16_f32 v141, v90, v91
  v_cvt_pk_bf16_f32 v142, v92, v93
  v_cvt_pk_bf16_f32 v143, v94, v95
  ds_read_b128 v[40:43], v13 offset:61440
  ds_read_b128 v[44:47], v13 offset:62464
  ds_read_b128 v[56:59], v13 offset:55296
  ds_read_b128 v[60:63], v13 offset:56320
  s_waitcnt lgkmcnt(4)
  v_mfma_f32_32x32x16_bf16 v[64:79], v[32:35], v[16:19], 0
  v_exp_f32 v96, v96
  v_exp_f32 v97, v97
  v_exp_f32 v98, v98
  v_exp_f32 v99, v99
  v_exp_f32 v100, v100
  v_exp_f32 v101, v101
  v_mfma_f32_32x32x16_bf16 v[64:79], v[36:39], v[20:23], v[64:79]
  v_exp_f32 v102, v102
  v_exp_f32 v103, v103
  v_exp_f32 v104, v104
  v_exp_f32 v105, v105
  v_exp_f32 v106, v106
  v_exp_f32 v107, v107
  v_mfma_f32_32x32x16_bf16 v[80:95], v[32:35], v[24:27], 0
  v_exp_f32 v108, v108
  v_exp_f32 v109, v109
  v_exp_f32 v110, v110
  v_exp_f32 v111, v111
  v_cvt_pk_bf16_f32 v144, v96, v97
  v_cvt_pk_bf16_f32 v145, v98, v99
  v_mfma_f32_32x32x16_bf16 v[80:95], v[36:39], v[28:31], v[80:95]
  v_cvt_pk_bf16_f32 v146, v100, v101
  v_cvt_pk_bf16_f32 v147, v102, v103
  v_cvt_pk_bf16_f32 v148, v104, v105
  v_cvt_pk_bf16_f32 v149, v106, v107
  v_cvt_pk_bf16_f32 v150, v108, v109
  v_cvt_pk_bf16_f32 v151, v110, v111
  v_mfma_f32_32x32x16_bf16 v[160:175], v[48:51], v[128:131], v[160:175]
  v_exp_f32 v112, v112
  v_exp_f32 v113, v113
  v_exp_f32 v114, v114
  v_exp_f32 v115, v115
  v_exp_f32 v116, v116
  v_exp_f32 v117, v117
  v_mfma_f32_32x32x16_bf16 v[160:175], v[52:55], v[132:135], v[160:175]
  v_exp_f32 v118, v118
  v_exp_f32 v119, v119
  v_exp_f32 v120, v120
  v_exp_f32 v121, v121
  v_exp_f32 v122, v122
  v_exp_f32 v123, v123
  v_mfma_f32_32x32x16_bf16 v[176:191], v[48:51], v[136:139], v[176:191]
  v_exp_f32 v124, v124
  v_exp_f32 v125, v125
  v_exp_f32 v126, v126
  v_exp_f32 v127, v127
  v_cvt_pk_bf16_f32 v152, v112, v113
  v_cvt_pk_bf16_f32 v153, v114, v115
  v_mfma_f32_32x32x16_bf16 v[176:191], v[52:55], v[140:143], v[176:191]
  v_cvt_pk_bf16_f32 v154, v116, v117
  v_cvt_pk_bf16_f32 v155, v118, v119
  v_cvt_pk_bf16_f32 v156, v120, v121
  v_cvt_pk_bf16_f32 v157, v122, v123
  v_cvt_pk_bf16_f32 v158, v124, v125
  v_cvt_pk_bf16_f32 v159, v126, v127
  ds_read_b128 v[48:51], v13 offset:59392
  ds_read_b128 v[52:55], v13 offset:60416
  s_waitcnt lgkmcnt(2)
  v_mfma_f32_32x32x16_bf16 v[96:111], v[40:43], v[16:19], 0
  v_exp_f32 v64, v64
  v_exp_f32 v65, v65
  v_exp_f32 v66, v66
  v_exp_f32 v67, v67
  v_exp_f32 v68, v68
  v_exp_f32 v69, v69
  v_mfma_f32_32x32x16_bf16 v[96:111], v[44:47], v[20:23], v[96:111]
  v_exp_f32 v70, v70
  v_exp_f32 v71, v71
  v_exp_f32 v72, v72
  v_exp_f32 v73, v73
  v_exp_f32 v74, v74
  v_exp_f32 v75, v75
  v_mfma_f32_32x32x16_bf16 v[112:127], v[40:43], v[24:27], 0
  v_exp_f32 v76, v76
  v_exp_f32 v77, v77
  v_exp_f32 v78, v78
  v_exp_f32 v79, v79
  v_cvt_pk_bf16_f32 v128, v64, v65
  v_cvt_pk_bf16_f32 v129, v66, v67
  v_mfma_f32_32x32x16_bf16 v[112:127], v[44:47], v[28:31], v[112:127]
  v_cvt_pk_bf16_f32 v130, v68, v69
  v_cvt_pk_bf16_f32 v131, v70, v71
  v_cvt_pk_bf16_f32 v132, v72, v73
  v_cvt_pk_bf16_f32 v133, v74, v75
  v_cvt_pk_bf16_f32 v134, v76, v77
  v_cvt_pk_bf16_f32 v135, v78, v79
  v_mfma_f32_32x32x16_bf16 v[160:175], v[56:59], v[144:147], v[160:175]
  v_exp_f32 v80, v80
  v_exp_f32 v81, v81
  v_exp_f32 v82, v82
  v_exp_f32 v83, v83
  v_exp_f32 v84, v84
  v_exp_f32 v85, v85
  v_mfma_f32_32x32x16_bf16 v[160:175], v[60:63], v[148:151], v[160:175]
  v_exp_f32 v86, v86
  v_exp_f32 v87, v87
  v_exp_f32 v88, v88
  v_exp_f32 v89, v89
  v_exp_f32 v90, v90
  v_exp_f32 v91, v91
  v_mfma_f32_32x32x16_bf16 v[176:191], v[56:59], v[152:155], v[176:191]
  v_exp_f32 v92, v92
  v_exp_f32 v93, v93
  v_exp_f32 v94, v94
  v_exp_f32 v95, v95
  v_cvt_pk_bf16_f32 v136, v80, v81
  v_cvt_pk_bf16_f32 v137, v82, v83
  v_mfma_f32_32x32x16_bf16 v[176:191], v[60:63], v[156:159], v[176:191]
  v_cvt_pk_bf16_f32 v138, v84, v85
  v_cvt_pk_bf16_f32 v139, v86, v87
  v_cvt_pk_bf16_f32 v140, v88, v89
  v_cvt_pk_bf16_f32 v141, v90, v91
  v_cvt_pk_bf16_f32 v142, v92, v93
  v_cvt_pk_bf16_f32 v143, v94, v95
  ds_read_b128 v[56:59], v13 offset:63488
  ds_read_b128 v[60:63], v13 offset:64512
  s_waitcnt lgkmcnt(2)
  v_mfma_f32_32x32x16_bf16 v[160:175], v[48:51], v[128:131], v[160:175]
  v_exp_f32 v96, v96
  v_exp_f32 v97, v97
  v_exp_f32 v98, v98
  v_exp_f32 v99, v99
  v_exp_f32 v100, v100
  v_exp_f32 v101, v101
  v_exp_f32 v102, v102
  v_exp_f32 v103, v103
  v_exp_f32 v104, v104
  v_exp_f32 v105, v105
  v_exp_f32 v106, v106
  v_exp_f32 v107, v107
  v_mfma_f32_32x32x16_bf16 v[160:175], v[52:55], v[132:135], v[160:175]
  v_exp_f32 v108, v108
  v_exp_f32 v109, v109
  v_exp_f32 v110, v110
  v_exp_f32 v111, v111
  v_cvt_pk_bf16_f32 v144, v96, v97
  v_cvt_pk_bf16_f32 v145, v98, v99
  v_cvt_pk_bf16_f32 v146, v100, v101
  v_cvt_pk_bf16_f32 v147, v102, v103
  v_cvt_pk_bf16_f32 v148, v104, v105
  v_cvt_pk_bf16_f32 v149, v106, v107
  v_cvt_pk_bf16_f32 v150, v108, v109
  v_cvt_pk_bf16_f32 v151, v110, v111
  v_mfma_f32_32x32x16_bf16 v[176:191], v[48:51], v[136:139], v[176:191]
  v_exp_f32 v112, v112
  v_exp_f32 v113, v113
  v_exp_f32 v114, v114
  v_exp_f32 v115, v115
  v_exp_f32 v116, v116
  v_exp_f32 v117, v117
  v_exp_f32 v118, v118
  v_exp_f32 v119, v119
  v_exp_f32 v120, v120
  v_exp_f32 v121, v121
  v_exp_f32 v122, v122
  v_exp_f32 v123, v123
  v_mfma_f32_32x32x16_bf16 v[176:191], v[52:55], v[140:143], v[176:191]
  v_exp_f32 v124, v124
  v_exp_f32 v125, v125
  v_exp_f32 v126, v126
  v_exp_f32 v127, v127
  v_cvt_pk_bf16_f32 v152, v112, v113
  v_cvt_pk_bf16_f32 v153, v114, v115
  v_cvt_pk_bf16_f32 v154, v116, v117
  v_cvt_pk_bf16_f32 v155, v118, v119
  v_cvt_pk_bf16_f32 v156, v120, v121
  v_cvt_pk_bf16_f32 v157, v122, v123
  v_cvt_pk_bf16_f32 v158, v124, v125
  v_cvt_pk_bf16_f32 v159, v126, v127
  s_waitcnt lgkmcnt(0)
  v_mfma_f32_32x32x16_bf16 v[160:175], v[56:59], v[144:147], v[160:175]
  v_mfma_f32_32x32x16_bf16 v[160:175], v[60:63], v[148:151], v[160:175]
  v_mfma_f32_32x32x16_bf16 v[176:191], v[56:59], v[152:155], v[176:191]
  v_mfma_f32_32x32x16_bf16 v[176:191], v[60:63], v[156:159], v[176:191]
  s_waitcnt vmcnt(0)
  s_barrier
  s_and_b32 s22, s20, 3
  s_lshl_b32 s22, s22, 13
  v_lshlrev_b32 v2, 4, v1
  v_add_u32 v2, s22, v2
  s_cmp_eq_u32 s21, 0
  s_cbranch_scc1 L_lo_att_kernel
  s_nop 1
  ds_write_b128 v2, v[160:163] offset:0
  ds_write_b128 v2, v[164:167] offset:1024
  ds_write_b128 v2, v[168:171] offset:2048
  ds_write_b128 v2, v[172:175] offset:3072
  ds_write_b128 v2, v[176:179] offset:4096
  ds_write_b128 v2, v[180:183] offset:5120
  ds_write_b128 v2, v[184:187] offset:6144
  ds_write_b128 v2, v[188:191] offset:7168
  s_waitcnt lgkmcnt(0)
  s_barrier
  s_branch L_flag_att_kernel
L_lo_att_kernel:
  s_barrier
  ds_read_b128 v[64:67], v2 offset:0
  ds_read_b128 v[68:71], v2 offset:1024
  ds_read_b128 v[72:75], v2 offset:2048
  ds_read_b128 v[76:79], v2 offset:3072
  ds_read_b128 v[80:83], v2 offset:4096
  ds_read_b128 v[84:87], v2 offset:5120
  ds_read_b128 v[88:91], v2 offset:6144
  ds_read_b128 v[92:95], v2 offset:7168
  s_waitcnt lgkmcnt(0)
  v_add_f32 v160, v160, v64
  v_add_f32 v161, v161, v65
  v_add_f32 v162, v162, v66
  v_add_f32 v163, v163, v67
  v_add_f32 v164, v164, v68
  v_add_f32 v165, v165, v69
  v_add_f32 v166, v166, v70
  v_add_f32 v167, v167, v71
  v_add_f32 v168, v168, v72
  v_add_f32 v169, v169, v73
  v_add_f32 v170, v170, v74
  v_add_f32 v171, v171, v75
  v_add_f32 v172, v172, v76
  v_add_f32 v173, v173, v77
  v_add_f32 v174, v174, v78
  v_add_f32 v175, v175, v79
  v_add_f32 v176, v176, v80
  v_add_f32 v177, v177, v81
  v_add_f32 v178, v178, v82
  v_add_f32 v179, v179, v83
  v_add_f32 v180, v180, v84
  v_add_f32 v181, v181, v85
  v_add_f32 v182, v182, v86
  v_add_f32 v183, v183, v87
  v_add_f32 v184, v184, v88
  v_add_f32 v185, v185, v89
  v_add_f32 v186, v186, v90
  v_add_f32 v187, v187, v91
  v_add_f32 v188, v188, v92
  v_add_f32 v189, v189, v93
  v_add_f32 v190, v190, v94
  v_add_f32 v191, v191, v95
  v_mov_b32 v3, 0x71800000
  v_cmp_nlt_f32 vcc, v168, v3
  s_mov_b32 s22, vcc_hi
  v_cmp_nlt_f32 vcc, v184, v3
  s_or_b32 s22, s22, vcc_hi
  v_mov_b32 v3, s22
  s_and_b32 s22, s20, 3
  s_lshl_b32 s22, s22, 2
  s_add_u32 s22, s22, 131072
  v_mov_b32 v4, s22
  ds_write_b32 v4, v3
L_flag_att_kernel:
  s_waitcnt lgkmcnt(0)
  s_barrier
  v_mov_b32 v4, 131072
  ds_read_b128 v[6:9], v4
  s_waitcnt lgkmcnt(0)
  v_or_b32 v6, v6, v7
  v_or_b32 v8, v8, v9
  v_or_b32 v6, v6, v8
  s_nop 0
  v_readfirstlane_b32 s22, v6
  s_nop 0
  s_cmp_eq_u32 s22, 0
  s_cbranch_scc1 L_ok_att_kernel
  s_cmp_lg_u32 s30, 0
  s_cbranch_scc1 L_ok_att_kernel
  s_mov_b32 s30, 1
  s_barrier
  s_and_b32 s22, s20, 3
  s_lshl_b32 s28, s22, 12
  s_add_u32 s28, s28, s29
  s_add_u32 m0, s26, 0
  s_nop 0
  buffer_load_dwordx4 v12, s[8:11], s28 offen offset:0 lds
  buffer_load_dwordx4 v12, s[8:11], s28 offen offset:1024 lds
  buffer_load_dwordx4 v12, s[8:11], s28 offen offset:2048 lds
  buffer_load_dwordx4 v12, s[8:11], s28 offen offset:3072 lds
  s_add_u32 s28, s28, 16384
  s_add_u32 m0, s26, 16384
  s_nop 0
  buffer_load_dwordx4 v12, s[8:11], s28 offen offset:0 lds
  buffer_load_dwordx4 v12, s[8:11], s28 offen offset:1024 lds
  buffer_load_dwordx4 v12, s[8:11], s28 offen offset:2048 lds
  buffer_load_dwordx4 v12, s[8:11], s28 offen offset:3072 lds
  s_add_u32 s28, s28, 16384
  s_add_u32 m0, s26, 32768
  s_nop 0
  buffer_load_dwordx4 v12, s[8:11], s28 offen offset:0 lds
  buffer_load_dwordx4 v12, s[8:11], s28 offen offset:1024 lds
  buffer_load_dwordx4 v12, s[8:11], s28 offen offset:2048 lds
  buffer_load_dwordx4 v12, s[8:11], s28 offen offset:3072 lds
  s_add_u32 s28, s28, 16384
  s_add_u32 m0, s26, 49152
  s_nop 0
  buffer_load_dwordx4 v12, s[8:11], s28 offen offset:0 lds
  buffer_load_dwordx4 v12, s[8:11], s28 offen offset:1024 lds
  buffer_load_dwordx4 v12, s[8:11], s28 offen offset:2048 lds
  buffer_load_dwordx4 v12, s[8:11], s28 offen offset:3072 lds
  s_add_u32 s28, s28, 16384
  v_mov_b32 v22, 0
  v_mov_b32 v10, 0xff800000
  v_mov_b32 v30, 0
  v_mov_b32 v11, 0xff800000
  s_waitcnt vmcnt(12)
  s_barrier
  ds_read_b128 v[32:35], v13 offset:0
  ds_read_b128 v[36:39], v13 offset:1024
  s_waitcnt lgkmcnt(0)
  v_mfma_f32_32x32x16_bf16 v[64:79], v[32:35], v[16:19], 0
  v_mfma_f32_32x32x16_bf16 v[64:79], v[36:39], v[20:23], v[64:79]
  v_mfma_f32_32x32x16_bf16 v[80:95], v[32:35], v[24:27], 0
  v_mfma_f32_32x32x16_bf16 v[80:95], v[36:39], v[28:31], v[80:95]
  s_nop 9
  v_max3_f32 v10, v10, v64, v65
  v_max3_f32 v10, v10, v66, v67
  v_max3_f32 v10, v10, v68, v69
  v_max3_f32 v10, v10, v70, v71
  v_max3_f32 v10, v10, v72, v73
  v_max3_f32 v10, v10, v74, v75
  v_max3_f32 v10, v10, v76, v77
  v_max3_f32 v10, v10, v78, v79
  v_max3_f32 v11, v11, v80, v81
  v_max3_f32 v11, v11, v82, v83
  v_max3_f32 v11, v11, v84, v85
  v_max3_f32 v11, v11, v86, v87
  v_max3_f32 v11, v11, v88, v89
  v_max3_f32 v11, v11, v90, v91
  v_max3_f32 v11, v11, v92, v93
  v_max3_f32 v11, v11, v94, v95
  ds_read_b128 v[32:35], v13 offset:4096
  ds_read_b128 v[36:39], v13 offset:5120
  s_waitcnt lgkmcnt(0)
  v_mfma_f32_32x32x16_bf16 v[64:79], v[32:35], v[16:19], 0
  v_mfma_f32_32x32x16_bf16 v[64:79], v[36:39], v[20:23], v[64:79]
  v_mfma_f32_32x32x16_bf16 v[80:95], v[32:35], v[24:27], 0
  v_mfma_f32_32x32x16_bf16 v[80:95], v[36:39], v[28:31], v[80:95]
  s_nop 9
  v_max3_f32 v10, v10, v64, v65
  v_max3_f32 v10, v10, v66, v67
  v_max3_f32 v10, v10, v68, v69
  v_max3_f32 v10, v10, v70, v71
  v_max3_f32 v10, v10, v72, v73
  v_max3_f32 v10, v10, v74, v75
  v_max3_f32 v10, v10, v76, v77
  v_max3_f32 v10, v10, v78, v79
  v_max3_f32 v11, v11, v80, v81
  v_max3_f32 v11, v11, v82, v83
  v_max3_f32 v11, v11, v84, v85
  v_max3_f32 v11, v11, v86, v87
  v_max3_f32 v11, v11, v88, v89
  v_max3_f32 v11, v11, v90, v91
  v_max3_f32 v11, v11, v92, v93
  v_max3_f32 v11, v11, v94, v95
  ds_read_b128 v[32:35], v13 offset:8192
  ds_read_b128 v[36:39], v13 offset:9216
  s_waitcnt lgkmcnt(0)
  v_mfma_f32_32x32x16_bf16 v[64:79], v[32:35], v[16:19], 0
  v_mfma_f32_32x32x16_bf16 v[64:79], v[36:39], v[20:23], v[64:79]
  v_mfma_f32_32x32x16_bf16 v[80:95], v[32:35], v[24:27], 0
  v_mfma_f32_32x32x16_bf16 v[80:95], v[36:39], v[28:31], v[80:95]
  s_nop 9
  v_max3_f32 v10, v10, v64, v65
  v_max3_f32 v10, v10, v66, v67
  v_max3_f32 v10, v10, v68, v69
  v_max3_f32 v10, v10, v70, v71
  v_max3_f32 v10, v10, v72, v73
  v_max3_f32 v10, v10, v74, v75
  v_max3_f32 v10, v10, v76, v77
  v_max3_f32 v10, v10, v78, v79
  v_max3_f32 v11, v11, v80, v81
  v_max3_f32 v11, v11, v82, v83
  v_max3_f32 v11, v11, v84, v85
  v_max3_f32 v11, v11, v86, v87
  v_max3_f32 v11, v11, v88, v89
  v_max3_f32 v11, v11, v90, v91
  v_max3_f32 v11, v11, v92, v93
  v_max3_f32 v11, v11, v94, v95
  ds_read_b128 v[32:35], v13 offset:12288
  ds_read_b128 v[36:39], v13 offset:13312
  s_waitcnt lgkmcnt(0)
  v_mfma_f32_32x32x16_bf16 v[64:79], v[32:35], v[16:19], 0
  v_mfma_f32_32x32x16_bf16 v[64:79], v[36:39], v[20:23], v[64:79]
  v_mfma_f32_32x32x16_bf16 v[80:95], v[32:35], v[24:27], 0
  v_mfma_f32_32x32x16_bf16 v[80:95], v[36:39], v[28:31], v[80:95]
  s_nop 9
  v_max3_f32 v10, v10, v64, v65
  v_max3_f32 v10, v10, v66, v67
  v_max3_f32 v10, v10, v68, v69
  v_max3_f32 v10, v10, v70, v71
  v_max3_f32 v10, v10, v72, v73
  v_max3_f32 v10, v10, v74, v75
  v_max3_f32 v10, v10, v76, v77
  v_max3_f32 v10, v10, v78, v79
  v_max3_f32 v11, v11, v80, v81
  v_max3_f32 v11, v11, v82, v83
  v_max3_f32 v11, v11, v84, v85
  v_max3_f32 v11, v11, v86, v87
  v_max3_f32 v11, v11, v88, v89
  v_max3_f32 v11, v11, v90, v91
  v_max3_f32 v11, v11, v92, v93
  v_max3_f32 v11, v11, v94, v95
  s_waitcnt vmcnt(8)
  s_barrier
  ds_read_b128 v[32:35], v13 offset:16384
  ds_read_b128 v[36:39], v13 offset:17408
  s_waitcnt lgkmcnt(0)
  v_mfma_f32_32x32x16_bf16 v[64:79], v[32:35], v[16:19], 0
  v_mfma_f32_32x32x16_bf16 v[64:79], v[36:39], v[20:23], v[64:79]
  v_mfma_f32_32x32x16_bf16 v[80:95], v[32:35], v[24:27], 0
  v_mfma_f32_32x32x16_bf16 v[80:95], v[36:39], v[28:31], v[80:95]
  s_nop 9
  v_max3_f32 v10, v10, v64, v65
  v_max3_f32 v10, v10, v66, v67
  v_max3_f32 v10, v10, v68, v69
  v_max3_f32 v10, v10, v70, v71
  v_max3_f32 v10, v10, v72, v73
  v_max3_f32 v10, v10, v74, v75
  v_max3_f32 v10, v10, v76, v77
  v_max3_f32 v10, v10, v78, v79
  v_max3_f32 v11, v11, v80, v81
  v_max3_f32 v11, v11, v82, v83
  v_max3_f32 v11, v11, v84, v85
  v_max3_f32 v11, v11, v86, v87
  v_max3_f32 v11, v11, v88, v89
  v_max3_f32 v11, v11, v90, v91
  v_max3_f32 v11, v11, v92, v93
  v_max3_f32 v11, v11, v94, v95
  ds_read_b128 v[32:35], v13 offset:20480
  ds_read_b128 v[36:39], v13 offset:21504
  s_waitcnt lgkmcnt(0)
  v_mfma_f32_32x32x16_bf16 v[64:79], v[32:35], v[16:19], 0
  v_mfma_f32_32x32x16_bf16 v[64:79], v[36:39], v[20:23], v[64:79]
  v_mfma_f32_32x32x16_bf16 v[80:95], v[32:35], v[24:27], 0
  v_mfma_f32_32x32x16_bf16 v[80:95], v[36:39], v[28:31], v[80:95]
  s_nop 9
  v_max3_f32 v10, v10, v64, v65
  v_max3_f32 v10, v10, v66, v67
  v_max3_f32 v10, v10, v68, v69
  v_max3_f32 v10, v10, v70, v71
  v_max3_f32 v10, v10, v72, v73
  v_max3_f32 v10, v10, v74, v75
  v_max3_f32 v10, v10, v76, v77
  v_max3_f32 v10, v10, v78, v79
  v_max3_f32 v11, v11, v80, v81
  v_max3_f32 v11, v11, v82, v83
  v_max3_f32 v11, v11, v84, v85
  v_max3_f32 v11, v11, v86, v87
  v_max3_f32 v11, v11, v88, v89
  v_max3_f32 v11, v11, v90, v91
  v_max3_f32 v11, v11, v92, v93
  v_max3_f32 v11, v11, v94, v95
  ds_read_b128 v[32:35], v13 offset:24576
  ds_read_b128 v[36:39], v13 offset:25600
  s_waitcnt lgkmcnt(0)
  v_mfma_f32_32x32x16_bf16 v[64:79], v[32:35], v[16:19], 0
  v_mfma_f32_32x32x16_bf16 v[64:79], v[36:39], v[20:23], v[64:79]
  v_mfma_f32_32x32x16_bf16 v[80:95], v[32:35], v[24:27], 0
  v_mfma_f32_32x32x16_bf16 v[80:95], v[36:39], v[28:31], v[80:95]
  s_nop 9
  v_max3_f32 v10, v10, v64, v65
  v_max3_f32 v10, v10, v66, v67
  v_max3_f32 v10, v10, v68, v69
  v_max3_f32 v10, v10, v70, v71
  v_max3_f32 v10, v10, v72, v73
  v_max3_f32 v10, v10, v74, v75
  v_max3_f32 v10, v10, v76, v77
  v_max3_f32 v10, v10, v78, v79
  v_max3_f32 v11, v11, v80, v81
  v_max3_f32 v11, v11, v82, v83
  v_max3_f32 v11, v11, v84, v85
  v_max3_f32 v11, v11, v86, v87
  v_max3_f32 v11, v11, v88, v89
  v_max3_f32 v11, v11, v90, v91
  v_max3_f32 v11, v11, v92, v93
  v_max3_f32 v11, v11, v94, v95
  ds_read_b128 v[32:35], v13 offset:28672
  ds_read_b128 v[36:39], v13 offset:29696
  s_waitcnt lgkmcnt(0)
  v_mfma_f32_32x32x16_bf16 v[64:79], v[32:35], v[16:19], 0
  v_mfma_f32_32x32x16_bf16 v[64:79], v[36:39], v[20:23], v[64:79]
  v_mfma_f32_32x32x16_bf16 v[80:95], v[32:35], v[24:27], 0
  v_mfma_f32_32x32x16_bf16 v[80:95], v[36:39], v[28:31], v[80:95]
  s_nop 9
  v_max3_f32 v10, v10, v64, v65
  v_max3_f32 v10, v10, v66, v67
  v_max3_f32 v10, v10, v68, v69
  v_max3_f32 v10, v10, v70, v71
  v_max3_f32 v10, v10, v72, v73
  v_max3_f32 v10, v10, v74, v75
  v_max3_f32 v10, v10, v76, v77
  v_max3_f32 v10, v10, v78, v79
  v_max3_f32 v11, v11, v80, v81
  v_max3_f32 v11, v11, v82, v83
  v_max3_f32 v11, v11, v84, v85
  v_max3_f32 v11, v11, v86, v87
  v_max3_f32 v11, v11, v88, v89
  v_max3_f32 v11, v11, v90, v91
  v_max3_f32 v11, v11, v92, v93
  v_max3_f32 v11, v11, v94, v95
  s_waitcnt vmcnt(4)
  s_barrier
  s_add_u32 m0, s26, 0
  s_nop 0
  buffer_load_dwordx4 v12, s[8:11], s28 offen offset:0 lds
  buffer_load_dwordx4 v12, s[8:11], s28 offen offset:1024 lds
  buffer_load_dwordx4 v12, s[8:11], s28 offen offset:2048 lds
  buffer_load_dwordx4 v12, s[8:11], s28 offen offset:3072 lds
  s_add_u32 s28, s28, 16384
  ds_read_b128 v[32:35], v13 offset:32768
  ds_read_b128 v[36:39], v13 offset:33792
  s_waitcnt lgkmcnt(0)
  v_mfma_f32_32x32x16_bf16 v[64:79], v[32:35], v[16:19], 0
  v_mfma_f32_32x32x16_bf16 v[64:79], v[36:39], v[20:23], v[64:79]
  v_mfma_f32_32x32x16_bf16 v[80:95], v[32:35], v[24:27], 0
  v_mfma_f32_32x32x16_bf16 v[80:95], v[36:39], v[28:31], v[80:95]
  s_nop 9
  v_max3_f32 v10, v10, v64, v65
  v_max3_f32 v10, v10, v66, v67
  v_max3_f32 v10, v10, v68, v69
  v_max3_f32 v10, v10, v70, v71
  v_max3_f32 v10, v10, v72, v73
  v_max3_f32 v10, v10, v74, v75
  v_max3_f32 v10, v10, v76, v77
  v_max3_f32 v10, v10, v78, v79
  v_max3_f32 v11, v11, v80, v81
  v_max3_f32 v11, v11, v82, v83
  v_max3_f32 v11, v11, v84, v85
  v_max3_f32 v11, v11, v86, v87
  v_max3_f32 v11, v11, v88, v89
  v_max3_f32 v11, v11, v90, v91
  v_max3_f32 v11, v11, v92, v93
  v_max3_f32 v11, v11, v94, v95
  ds_read_b128 v[32:35], v13 offset:36864
  ds_read_b128 v[36:39], v13 offset:37888
  s_waitcnt lgkmcnt(0)
  v_mfma_f32_32x32x16_bf16 v[64:79], v[32:35], v[16:19], 0
  v_mfma_f32_32x32x16_bf16 v[64:79], v[36:39], v[20:23], v[64:79]
  v_mfma_f32_32x32x16_bf16 v[80:95], v[32:35], v[24:27], 0
  v_mfma_f32_32x32x16_bf16 v[80:95], v[36:39], v[28:31], v[80:95]
  s_nop 9
  v_max3_f32 v10, v10, v64, v65
  v_max3_f32 v10, v10, v66, v67
  v_max3_f32 v10, v10, v68, v69
  v_max3_f32 v10, v10, v70, v71
  v_max3_f32 v10, v10, v72, v73
  v_max3_f32 v10, v10, v74, v75
  v_max3_f32 v10, v10, v76, v77
  v_max3_f32 v10, v10, v78, v79
  v_max3_f32 v11, v11, v80, v81
  v_max3_f32 v11, v11, v82, v83
  v_max3_f32 v11, v11, v84, v85
  v_max3_f32 v11, v11, v86, v87
  v_max3_f32 v11, v11, v88, v89
  v_max3_f32 v11, v11, v90, v91
  v_max3_f32 v11, v11, v92, v93
  v_max3_f32 v11, v11, v94, v95
  ds_read_b128 v[32:35], v13 offset:40960
  ds_read_b128 v[36:39], v13 offset:41984
  s_waitcnt lgkmcnt(0)
  v_mfma_f32_32x32x16_bf16 v[64:79], v[32:35], v[16:19], 0
  v_mfma_f32_32x32x16_bf16 v[64:79], v[36:39], v[20:23], v[64:79]
  v_mfma_f32_32x32x16_bf16 v[80:95], v[32:35], v[24:27], 0
  v_mfma_f32_32x32x16_bf16 v[80:95], v[36:39], v[28:31], v[80:95]
  s_nop 9
  v_max3_f32 v10, v10, v64, v65
  v_max3_f32 v10, v10, v66, v67
  v_max3_f32 v10, v10, v68, v69
  v_max3_f32 v10, v10, v70, v71
  v_max3_f32 v10, v10, v72, v73
  v_max3_f32 v10, v10, v74, v75
  v_max3_f32 v10, v10, v76, v77
  v_max3_f32 v10, v10, v78, v79
  v_max3_f32 v11, v11, v80, v81
  v_max3_f32 v11, v11, v82, v83
  v_max3_f32 v11, v11, v84, v85
  v_max3_f32 v11, v11, v86, v87
  v_max3_f32 v11, v11, v88, v89
  v_max3_f32 v11, v11, v90, v91
  v_max3_f32 v11, v11, v92, v93
  v_max3_f32 v11, v11, v94, v95
  ds_read_b128 v[32:35], v13 offset:45056
  ds_read_b128 v[36:39], v13 offset:46080
  s_waitcnt lgkmcnt(0)
  v_mfma_f32_32x32x16_bf16 v[64:79], v[32:35], v[16:19], 0
  v_mfma_f32_32x32x16_bf16 v[64:79], v[36:39], v[20:23], v[64:79]
  v_mfma_f32_32x32x16_bf16 v[80:95], v[32:35], v[24:27], 0
  v_mfma_f32_32x32x16_bf16 v[80:95], v[36:39], v[28:31], v[80:95]
  s_nop 9
  v_max3_f32 v10, v10, v64, v65
  v_max3_f32 v10, v10, v66, v67
  v_max3_f32 v10, v10, v68, v69
  v_max3_f32 v10, v10, v70, v71
  v_max3_f32 v10, v10, v72, v73
  v_max3_f32 v10, v10, v74, v75
  v_max3_f32 v10, v10, v76, v77
  v_max3_f32 v10, v10, v78, v79
  v_max3_f32 v11, v11, v80, v81
  v_max3_f32 v11, v11, v82, v83
  v_max3_f32 v11, v11, v84, v85
  v_max3_f32 v11, v11, v86, v87
  v_max3_f32 v11, v11, v88, v89
  v_max3_f32 v11, v11, v90, v91
  v_max3_f32 v11, v11, v92, v93
  v_max3_f32 v11, v11, v94, v95
  s_waitcnt vmcnt(4)
  s_barrier
  s_add_u32 m0, s26, 16384
  s_nop 0
  buffer_load_dwordx4 v12, s[8:11], s28 offen offset:0 lds
  buffer_load_dwordx4 v12, s[8:11], s28 offen offset:1024 lds
  buffer_load_dwordx4 v12, s[8:11], s28 offen offset:2048 lds
  buffer_load_dwordx4 v12, s[8:11], s28 offen offset:3072 lds
  s_add_u32 s28, s28, 16384
  ds_read_b128 v[32:35], v13 offset:49152
  ds_read_b128 v[36:39], v13 offset:50176
  s_waitcnt lgkmcnt(0)
  v_mfma_f32_32x32x16_bf16 v[64:79], v[32:35], v[16:19], 0
  v_mfma_f32_32x32x16_bf16 v[64:79], v[36:39], v[20:23], v[64:79]
  v_mfma_f32_32x32x16_bf16 v[80:95], v[32:35], v[24:27], 0
  v_mfma_f32_32x32x16_bf16 v[80:95], v[36:39], v[28:31], v[80:95]
  s_nop 9
  v_max3_f32 v10, v10, v64, v65
  v_max3_f32 v10, v10, v66, v67
  v_max3_f32 v10, v10, v68, v69
  v_max3_f32 v10, v10, v70, v71
  v_max3_f32 v10, v10, v72, v73
  v_max3_f32 v10, v10, v74, v75
  v_max3_f32 v10, v10, v76, v77
  v_max3_f32 v10, v10, v78, v79
  v_max3_f32 v11, v11, v80, v81
  v_max3_f32 v11, v11, v82, v83
  v_max3_f32 v11, v11, v84, v85
  v_max3_f32 v11, v11, v86, v87
  v_max3_f32 v11, v11, v88, v89
  v_max3_f32 v11, v11, v90, v91
  v_max3_f32 v11, v11, v92, v93
  v_max3_f32 v11, v11, v94, v95
  ds_read_b128 v[32:35], v13 offset:53248
  ds_read_b128 v[36:39], v13 offset:54272
  s_waitcnt lgkmcnt(0)
  v_mfma_f32_32x32x16_bf16 v[64:79], v[32:35], v[16:19], 0
  v_mfma_f32_32x32x16_bf16 v[64:79], v[36:39], v[20:23], v[64:79]
  v_mfma_f32_32x32x16_bf16 v[80:95], v[32:35], v[24:27], 0
  v_mfma_f32_32x32x16_bf16 v[80:95], v[36:39], v[28:31], v[80:95]
  s_nop 9
  v_max3_f32 v10, v10, v64, v65
  v_max3_f32 v10, v10, v66, v67
  v_max3_f32 v10, v10, v68, v69
  v_max3_f32 v10, v10, v70, v71
  v_max3_f32 v10, v10, v72, v73
  v_max3_f32 v10, v10, v74, v75
  v_max3_f32 v10, v10, v76, v77
  v_max3_f32 v10, v10, v78, v79
  v_max3_f32 v11, v11, v80, v81
  v_max3_f32 v11, v11, v82, v83
  v_max3_f32 v11, v11, v84, v85
  v_max3_f32 v11, v11, v86, v87
  v_max3_f32 v11, v11, v88, v89
  v_max3_f32 v11, v11, v90, v91
  v_max3_f32 v11, v11, v92, v93
  v_max3_f32 v11, v11, v94, v95
  ds_read_b128 v[32:35], v13 offset:57344
  ds_read_b128 v[36:39], v13 offset:58368
  s_waitcnt lgkmcnt(0)
  v_mfma_f32_32x32x16_bf16 v[64:79], v[32:35], v[16:19], 0
  v_mfma_f32_32x32x16_bf16 v[64:79], v[36:39], v[20:23], v[64:79]
  v_mfma_f32_32x32x16_bf16 v[80:95], v[32:35], v[24:27], 0
  v_mfma_f32_32x32x16_bf16 v[80:95], v[36:39], v[28:31], v[80:95]
  s_nop 9
  v_max3_f32 v10, v10, v64, v65
  v_max3_f32 v10, v10, v66, v67
  v_max3_f32 v10, v10, v68, v69
  v_max3_f32 v10, v10, v70, v71
  v_max3_f32 v10, v10, v72, v73
  v_max3_f32 v10, v10, v74, v75
  v_max3_f32 v10, v10, v76, v77
  v_max3_f32 v10, v10, v78, v79
  v_max3_f32 v11, v11, v80, v81
  v_max3_f32 v11, v11, v82, v83
  v_max3_f32 v11, v11, v84, v85
  v_max3_f32 v11, v11, v86, v87
  v_max3_f32 v11, v11, v88, v89
  v_max3_f32 v11, v11, v90, v91
  v_max3_f32 v11, v11, v92, v93
  v_max3_f32 v11, v11, v94, v95
  ds_read_b128 v[32:35], v13 offset:61440
  ds_read_b128 v[36:39], v13 offset:62464
  s_waitcnt lgkmcnt(0)
  v_mfma_f32_32x32x16_bf16 v[64:79], v[32:35], v[16:19], 0
  v_mfma_f32_32x32x16_bf16 v[64:79], v[36:39], v[20:23], v[64:79]
  v_mfma_f32_32x32x16_bf16 v[80:95], v[32:35], v[24:27], 0
  v_mfma_f32_32x32x16_bf16 v[80:95], v[36:39], v[28:31], v[80:95]
  s_nop 9
  v_max3_f32 v10, v10, v64, v65
  v_max3_f32 v10, v10, v66, v67
  v_max3_f32 v10, v10, v68, v69
  v_max3_f32 v10, v10, v70, v71
  v_max3_f32 v10, v10, v72, v73
  v_max3_f32 v10, v10, v74, v75
  v_max3_f32 v10, v10, v76, v77
  v_max3_f32 v10, v10, v78, v79
  v_max3_f32 v11, v11, v80, v81
  v_max3_f32 v11, v11, v82, v83
  v_max3_f32 v11, v11, v84, v85
  v_max3_f32 v11, v11, v86, v87
  v_max3_f32 v11, v11, v88, v89
  v_max3_f32 v11, v11, v90, v91
  v_max3_f32 v11, v11, v92, v93
  v_max3_f32 v11, v11, v94, v95
  s_waitcnt vmcnt(4)
  s_barrier
  s_add_u32 m0, s26, 32768
  s_nop 0
  buffer_load_dwordx4 v12, s[8:11], s28 offen offset:0 lds
  buffer_load_dwordx4 v12, s[8:11], s28 offen offset:1024 lds
  buffer_load_dwordx4 v12, s[8:11], s28 offen offset:2048 lds
  buffer_load_dwordx4 v12, s[8:11], s28 offen offset:3072 lds
  s_add_u32 s28, s28, 16384
  ds_read_b128 v[32:35], v13 offset:0
  ds_read_b128 v[36:39], v13 offset:1024
  s_waitcnt lgkmcnt(0)
  v_mfma_f32_32x32x16_bf16 v[64:79], v[32:35], v[16:19], 0
  v_mfma_f32_32x32x16_bf16 v[64:79], v[36:39], v[20:23], v[64:79]
  v_mfma_f32_32x32x16_bf16 v[80:95], v[32:35], v[24:27], 0
  v_mfma_f32_32x32x16_bf16 v[80:95], v[36:39], v[28:31], v[80:95]
  s_nop 9
  v_max3_f32 v10, v10, v64, v65
  v_max3_f32 v10, v10, v66, v67
  v_max3_f32 v10, v10, v68, v69
  v_max3_f32 v10, v10, v70, v71
  v_max3_f32 v10, v10, v72, v73
  v_max3_f32 v10, v10, v74, v75
  v_max3_f32 v10, v10, v76, v77
  v_max3_f32 v10, v10, v78, v79
  v_max3_f32 v11, v11, v80, v81
  v_max3_f32 v11, v11, v82, v83
  v_max3_f32 v11, v11, v84, v85
  v_max3_f32 v11, v11, v86, v87
  v_max3_f32 v11, v11, v88, v89
  v_max3_f32 v11, v11, v90, v91
  v_max3_f32 v11, v11, v92, v93
  v_max3_f32 v11, v11, v94, v95
  ds_read_b128 v[32:35], v13 offset:4096
  ds_read_b128 v[36:39], v13 offset:5120
  s_waitcnt lgkmcnt(0)
  v_mfma_f32_32x32x16_bf16 v[64:79], v[32:35], v[16:19], 0
  v_mfma_f32_32x32x16_bf16 v[64:79], v[36:39], v[20:23], v[64:79]
  v_mfma_f32_32x32x16_bf16 v[80:95], v[32:35], v[24:27], 0
  v_mfma_f32_32x32x16_bf16 v[80:95], v[36:39], v[28:31], v[80:95]
  s_nop 9
  v_max3_f32 v10, v10, v64, v65
  v_max3_f32 v10, v10, v66, v67
  v_max3_f32 v10, v10, v68, v69
  v_max3_f32 v10, v10, v70, v71
  v_max3_f32 v10, v10, v72, v73
  v_max3_f32 v10, v10, v74, v75
  v_max3_f32 v10, v10, v76, v77
  v_max3_f32 v10, v10, v78, v79
  v_max3_f32 v11, v11, v80, v81
  v_max3_f32 v11, v11, v82, v83
  v_max3_f32 v11, v11, v84, v85
  v_max3_f32 v11, v11, v86, v87
  v_max3_f32 v11, v11, v88, v89
  v_max3_f32 v11, v11, v90, v91
  v_max3_f32 v11, v11, v92, v93
  v_max3_f32 v11, v11, v94, v95
  ds_read_b128 v[32:35], v13 offset:8192
  ds_read_b128 v[36:39], v13 offset:9216
  s_waitcnt lgkmcnt(0)
  v_mfma_f32_32x32x16_bf16 v[64:79], v[32:35], v[16:19], 0
  v_mfma_f32_32x32x16_bf16 v[64:79], v[36:39], v[20:23], v[64:79]
  v_mfma_f32_32x32x16_bf16 v[80:95], v[32:35], v[24:27], 0
  v_mfma_f32_32x32x16_bf16 v[80:95], v[36:39], v[28:31], v[80:95]
  s_nop 9
  v_max3_f32 v10, v10, v64, v65
  v_max3_f32 v10, v10, v66, v67
  v_max3_f32 v10, v10, v68, v69
  v_max3_f32 v10, v10, v70, v71
  v_max3_f32 v10, v10, v72, v73
  v_max3_f32 v10, v10, v74, v75
  v_max3_f32 v10, v10, v76, v77
  v_max3_f32 v10, v10, v78, v79
  v_max3_f32 v11, v11, v80, v81
  v_max3_f32 v11, v11, v82, v83
  v_max3_f32 v11, v11, v84, v85
  v_max3_f32 v11, v11, v86, v87
  v_max3_f32 v11, v11, v88, v89
  v_max3_f32 v11, v11, v90, v91
  v_max3_f32 v11, v11, v92, v93
  v_max3_f32 v11, v11, v94, v95
  ds_read_b128 v[32:35], v13 offset:12288
  ds_read_b128 v[36:39], v13 offset:13312
  s_waitcnt lgkmcnt(0)
  v_mfma_f32_32x32x16_bf16 v[64:79], v[32:35], v[16:19], 0
  v_mfma_f32_32x32x16_bf16 v[64:79], v[36:39], v[20:23], v[64:79]
  v_mfma_f32_32x32x16_bf16 v[80:95], v[32:35], v[24:27], 0
  v_mfma_f32_32x32x16_bf16 v[80:95], v[36:39], v[28:31], v[80:95]
  s_nop 9
  v_max3_f32 v10, v10, v64, v65
  v_max3_f32 v10, v10, v66, v67
  v_max3_f32 v10, v10, v68, v69
  v_max3_f32 v10, v10, v70, v71
  v_max3_f32 v10, v10, v72, v73
  v_max3_f32 v10, v10, v74, v75
  v_max3_f32 v10, v10, v76, v77
  v_max3_f32 v10, v10, v78, v79
  v_max3_f32 v11, v11, v80, v81
  v_max3_f32 v11, v11, v82, v83
  v_max3_f32 v11, v11, v84, v85
  v_max3_f32 v11, v11, v86, v87
  v_max3_f32 v11, v11, v88, v89
  v_max3_f32 v11, v11, v90, v91
  v_max3_f32 v11, v11, v92, v93
  v_max3_f32 v11, v11, v94, v95
  s_waitcnt vmcnt(4)
  s_barrier
  s_add_u32 m0, s26, 49152
  s_nop 0
  buffer_load_dwordx4 v12, s[8:11], s28 offen offset:0 lds
  buffer_load_dwordx4 v12, s[8:11], s28 offen offset:1024 lds
  buffer_load_dwordx4 v12, s[8:11], s28 offen offset:2048 lds
  buffer_load_dwordx4 v12, s[8:11], s28 offen offset:3072 lds
  s_add_u32 s28, s28, 16384
  ds_read_b128 v[32:35], v13 offset:16384
  ds_read_b128 v[36:39], v13 offset:17408
  s_waitcnt lgkmcnt(0)
  v_mfma_f32_32x32x16_bf16 v[64:79], v[32:35], v[16:19], 0
  v_mfma_f32_32x32x16_bf16 v[64:79], v[36:39], v[20:23], v[64:79]
  v_mfma_f32_32x32x16_bf16 v[80:95], v[32:35], v[24:27], 0
  v_mfma_f32_32x32x16_bf16 v[80:95], v[36:39], v[28:31], v[80:95]
  s_nop 9
  v_max3_f32 v10, v10, v64, v65
  v_max3_f32 v10, v10, v66, v67
  v_max3_f32 v10, v10, v68, v69
  v_max3_f32 v10, v10, v70, v71
  v_max3_f32 v10, v10, v72, v73
  v_max3_f32 v10, v10, v74, v75
  v_max3_f32 v10, v10, v76, v77
  v_max3_f32 v10, v10, v78, v79
  v_max3_f32 v11, v11, v80, v81
  v_max3_f32 v11, v11, v82, v83
  v_max3_f32 v11, v11, v84, v85
  v_max3_f32 v11, v11, v86, v87
  v_max3_f32 v11, v11, v88, v89
  v_max3_f32 v11, v11, v90, v91
  v_max3_f32 v11, v11, v92, v93
  v_max3_f32 v11, v11, v94, v95
  ds_read_b128 v[32:35], v13 offset:20480
  ds_read_b128 v[36:39], v13 offset:21504
  s_waitcnt lgkmcnt(0)
  v_mfma_f32_32x32x16_bf16 v[64:79], v[32:35], v[16:19], 0
  v_mfma_f32_32x32x16_bf16 v[64:79], v[36:39], v[20:23], v[64:79]
  v_mfma_f32_32x32x16_bf16 v[80:95], v[32:35], v[24:27], 0
  v_mfma_f32_32x32x16_bf16 v[80:95], v[36:39], v[28:31], v[80:95]
  s_nop 9
  v_max3_f32 v10, v10, v64, v65
  v_max3_f32 v10, v10, v66, v67
  v_max3_f32 v10, v10, v68, v69
  v_max3_f32 v10, v10, v70, v71
  v_max3_f32 v10, v10, v72, v73
  v_max3_f32 v10, v10, v74, v75
  v_max3_f32 v10, v10, v76, v77
  v_max3_f32 v10, v10, v78, v79
  v_max3_f32 v11, v11, v80, v81
  v_max3_f32 v11, v11, v82, v83
  v_max3_f32 v11, v11, v84, v85
  v_max3_f32 v11, v11, v86, v87
  v_max3_f32 v11, v11, v88, v89
  v_max3_f32 v11, v11, v90, v91
  v_max3_f32 v11, v11, v92, v93
  v_max3_f32 v11, v11, v94, v95
  ds_read_b128 v[32:35], v13 offset:24576
  ds_read_b128 v[36:39], v13 offset:25600
  s_waitcnt lgkmcnt(0)
  v_mfma_f32_32x32x16_bf16 v[64:79], v[32:35], v[16:19], 0
  v_mfma_f32_32x32x16_bf16 v[64:79], v[36:39], v[20:23], v[64:79]
  v_mfma_f32_32x32x16_bf16 v[80:95], v[32:35], v[24:27], 0
  v_mfma_f32_32x32x16_bf16 v[80:95], v[36:39], v[28:31], v[80:95]
  s_nop 9
  v_max3_f32 v10, v10, v64, v65
  v_max3_f32 v10, v10, v66, v67
  v_max3_f32 v10, v10, v68, v69
  v_max3_f32 v10, v10, v70, v71
  v_max3_f32 v10, v10, v72, v73
  v_max3_f32 v10, v10, v74, v75
  v_max3_f32 v10, v10, v76, v77
  v_max3_f32 v10, v10, v78, v79
  v_max3_f32 v11, v11, v80, v81
  v_max3_f32 v11, v11, v82, v83
  v_max3_f32 v11, v11, v84, v85
  v_max3_f32 v11, v11, v86, v87
  v_max3_f32 v11, v11, v88, v89
  v_max3_f32 v11, v11, v90, v91
  v_max3_f32 v11, v11, v92, v93
  v_max3_f32 v11, v11, v94, v95
  ds_read_b128 v[32:35], v13 offset:28672
  ds_read_b128 v[36:39], v13 offset:29696
  s_waitcnt lgkmcnt(0)
  v_mfma_f32_32x32x16_bf16 v[64:79], v[32:35], v[16:19], 0
  v_mfma_f32_32x32x16_bf16 v[64:79], v[36:39], v[20:23], v[64:79]
  v_mfma_f32_32x32x16_bf16 v[80:95], v[32:35], v[24:27], 0
  v_mfma_f32_32x32x16_bf16 v[80:95], v[36:39], v[28:31], v[80:95]
  s_nop 9
  v_max3_f32 v10, v10, v64, v65
  v_max3_f32 v10, v10, v66, v67
  v_max3_f32 v10, v10, v68, v69
  v_max3_f32 v10, v10, v70, v71
  v_max3_f32 v10, v10, v72, v73
  v_max3_f32 v10, v10, v74, v75
  v_max3_f32 v10, v10, v76, v77
  v_max3_f32 v10, v10, v78, v79
  v_max3_f32 v11, v11, v80, v81
  v_max3_f32 v11, v11, v82, v83
  v_max3_f32 v11, v11, v84, v85
  v_max3_f32 v11, v11, v86, v87
  v_max3_f32 v11, v11, v88, v89
  v_max3_f32 v11, v11, v90, v91
  v_max3_f32 v11, v11, v92, v93
  v_max3_f32 v11, v11, v94, v95
  s_waitcnt vmcnt(4)
  s_barrier
  ds_read_b128 v[32:35], v13 offset:32768
  ds_read_b128 v[36:39], v13 offset:33792
  s_waitcnt lgkmcnt(0)
  v_mfma_f32_32x32x16_bf16 v[64:79], v[32:35], v[16:19], 0
  v_mfma_f32_32x32x16_bf16 v[64:79], v[36:39], v[20:23], v[64:79]
  v_mfma_f32_32x32x16_bf16 v[80:95], v[32:35], v[24:27], 0
  v_mfma_f32_32x32x16_bf16 v[80:95], v[36:39], v[28:31], v[80:95]
  s_nop 9
  v_max3_f32 v10, v10, v64, v65
  v_max3_f32 v10, v10, v66, v67
  v_max3_f32 v10, v10, v68, v69
  v_max3_f32 v10, v10, v70, v71
  v_max3_f32 v10, v10, v72, v73
  v_max3_f32 v10, v10, v74, v75
  v_max3_f32 v10, v10, v76, v77
  v_max3_f32 v10, v10, v78, v79
  v_max3_f32 v11, v11, v80, v81
  v_max3_f32 v11, v11, v82, v83
  v_max3_f32 v11, v11, v84, v85
  v_max3_f32 v11, v11, v86, v87
  v_max3_f32 v11, v11, v88, v89
  v_max3_f32 v11, v11, v90, v91
  v_max3_f32 v11, v11, v92, v93
  v_max3_f32 v11, v11, v94, v95
  ds_read_b128 v[32:35], v13 offset:36864
  ds_read_b128 v[36:39], v13 offset:37888
  s_waitcnt lgkmcnt(0)
  v_mfma_f32_32x32x16_bf16 v[64:79], v[32:35], v[16:19], 0
  v_mfma_f32_32x32x16_bf16 v[64:79], v[36:39], v[20:23], v[64:79]
  v_mfma_f32_32x32x16_bf16 v[80:95], v[32:35], v[24:27], 0
  v_mfma_f32_32x32x16_bf16 v[80:95], v[36:39], v[28:31], v[80:95]
  s_nop 9
  v_max3_f32 v10, v10, v64, v65
  v_max3_f32 v10, v10, v66, v67
  v_max3_f32 v10, v10, v68, v69
  v_max3_f32 v10, v10, v70, v71
  v_max3_f32 v10, v10, v72, v73
  v_max3_f32 v10, v10, v74, v75
  v_max3_f32 v10, v10, v76, v77
  v_max3_f32 v10, v10, v78, v79
  v_max3_f32 v11, v11, v80, v81
  v_max3_f32 v11, v11, v82, v83
  v_max3_f32 v11, v11, v84, v85
  v_max3_f32 v11, v11, v86, v87
  v_max3_f32 v11, v11, v88, v89
  v_max3_f32 v11, v11, v90, v91
  v_max3_f32 v11, v11, v92, v93
  v_max3_f32 v11, v11, v94, v95
  ds_read_b128 v[32:35], v13 offset:40960
  ds_read_b128 v[36:39], v13 offset:41984
  s_waitcnt lgkmcnt(0)
  v_mfma_f32_32x32x16_bf16 v[64:79], v[32:35], v[16:19], 0
  v_mfma_f32_32x32x16_bf16 v[64:79], v[36:39], v[20:23], v[64:79]
  v_mfma_f32_32x32x16_bf16 v[80:95], v[32:35], v[24:27], 0
  v_mfma_f32_32x32x16_bf16 v[80:95], v[36:39], v[28:31], v[80:95]
  s_nop 9
  v_max3_f32 v10, v10, v64, v65
  v_max3_f32 v10, v10, v66, v67
  v_max3_f32 v10, v10, v68, v69
  v_max3_f32 v10, v10, v70, v71
  v_max3_f32 v10, v10, v72, v73
  v_max3_f32 v10, v10, v74, v75
  v_max3_f32 v10, v10, v76, v77
  v_max3_f32 v10, v10, v78, v79
  v_max3_f32 v11, v11, v80, v81
  v_max3_f32 v11, v11, v82, v83
  v_max3_f32 v11, v11, v84, v85
  v_max3_f32 v11, v11, v86, v87
  v_max3_f32 v11, v11, v88, v89
  v_max3_f32 v11, v11, v90, v91
  v_max3_f32 v11, v11, v92, v93
  v_max3_f32 v11, v11, v94, v95
  ds_read_b128 v[32:35], v13 offset:45056
  ds_read_b128 v[36:39], v13 offset:46080
  s_waitcnt lgkmcnt(0)
  v_mfma_f32_32x32x16_bf16 v[64:79], v[32:35], v[16:19], 0
  v_mfma_f32_32x32x16_bf16 v[64:79], v[36:39], v[20:23], v[64:79]
  v_mfma_f32_32x32x16_bf16 v[80:95], v[32:35], v[24:27], 0
  v_mfma_f32_32x32x16_bf16 v[80:95], v[36:39], v[28:31], v[80:95]
  s_nop 9
  v_max3_f32 v10, v10, v64, v65
  v_max3_f32 v10, v10, v66, v67
  v_max3_f32 v10, v10, v68, v69
  v_max3_f32 v10, v10, v70, v71
  v_max3_f32 v10, v10, v72, v73
  v_max3_f32 v10, v10, v74, v75
  v_max3_f32 v10, v10, v76, v77
  v_max3_f32 v10, v10, v78, v79
  v_max3_f32 v11, v11, v80, v81
  v_max3_f32 v11, v11, v82, v83
  v_max3_f32 v11, v11, v84, v85
  v_max3_f32 v11, v11, v86, v87
  v_max3_f32 v11, v11, v88, v89
  v_max3_f32 v11, v11, v90, v91
  v_max3_f32 v11, v11, v92, v93
  v_max3_f32 v11, v11, v94, v95
  s_waitcnt vmcnt(0)
  s_barrier
  ds_read_b128 v[32:35], v13 offset:49152
  ds_read_b128 v[36:39], v13 offset:50176
  s_waitcnt lgkmcnt(0)
  v_mfma_f32_32x32x16_bf16 v[64:79], v[32:35], v[16:19], 0
  v_mfma_f32_32x32x16_bf16 v[64:79], v[36:39], v[20:23], v[64:79]
  v_mfma_f32_32x32x16_bf16 v[80:95], v[32:35], v[24:27], 0
  v_mfma_f32_32x32x16_bf16 v[80:95], v[36:39], v[28:31], v[80:95]
  s_nop 9
  v_max3_f32 v10, v10, v64, v65
  v_max3_f32 v10, v10, v66, v67
  v_max3_f32 v10, v10, v68, v69
  v_max3_f32 v10, v10, v70, v71
  v_max3_f32 v10, v10, v72, v73
  v_max3_f32 v10, v10, v74, v75
  v_max3_f32 v10, v10, v76, v77
  v_max3_f32 v10, v10, v78, v79
  v_max3_f32 v11, v11, v80, v81
  v_max3_f32 v11, v11, v82, v83
  v_max3_f32 v11, v11, v84, v85
  v_max3_f32 v11, v11, v86, v87
  v_max3_f32 v11, v11, v88, v89
  v_max3_f32 v11, v11, v90, v91
  v_max3_f32 v11, v11, v92, v93
  v_max3_f32 v11, v11, v94, v95
  ds_read_b128 v[32:35], v13 offset:53248
  ds_read_b128 v[36:39], v13 offset:54272
  s_waitcnt lgkmcnt(0)
  v_mfma_f32_32x32x16_bf16 v[64:79], v[32:35], v[16:19], 0
  v_mfma_f32_32x32x16_bf16 v[64:79], v[36:39], v[20:23], v[64:79]
  v_mfma_f32_32x32x16_bf16 v[80:95], v[32:35], v[24:27], 0
  v_mfma_f32_32x32x16_bf16 v[80:95], v[36:39], v[28:31], v[80:95]
  s_nop 9
  v_max3_f32 v10, v10, v64, v65
  v_max3_f32 v10, v10, v66, v67
  v_max3_f32 v10, v10, v68, v69
  v_max3_f32 v10, v10, v70, v71
  v_max3_f32 v10, v10, v72, v73
  v_max3_f32 v10, v10, v74, v75
  v_max3_f32 v10, v10, v76, v77
  v_max3_f32 v10, v10, v78, v79
  v_max3_f32 v11, v11, v80, v81
  v_max3_f32 v11, v11, v82, v83
  v_max3_f32 v11, v11, v84, v85
  v_max3_f32 v11, v11, v86, v87
  v_max3_f32 v11, v11, v88, v89
  v_max3_f32 v11, v11, v90, v91
  v_max3_f32 v11, v11, v92, v93
  v_max3_f32 v11, v11, v94, v95
  ds_read_b128 v[32:35], v13 offset:57344
  ds_read_b128 v[36:39], v13 offset:58368
  s_waitcnt lgkmcnt(0)
  v_mfma_f32_32x32x16_bf16 v[64:79], v[32:35], v[16:19], 0
  v_mfma_f32_32x32x16_bf16 v[64:79], v[36:39], v[20:23], v[64:79]
  v_mfma_f32_32x32x16_bf16 v[80:95], v[32:35], v[24:27], 0
  v_mfma_f32_32x32x16_bf16 v[80:95], v[36:39], v[28:31], v[80:95]
  s_nop 9
  v_max3_f32 v10, v10, v64, v65
  v_max3_f32 v10, v10, v66, v67
  v_max3_f32 v10, v10, v68, v69
  v_max3_f32 v10, v10, v70, v71
  v_max3_f32 v10, v10, v72, v73
  v_max3_f32 v10, v10, v74, v75
  v_max3_f32 v10, v10, v76, v77
  v_max3_f32 v10, v10, v78, v79
  v_max3_f32 v11, v11, v80, v81
  v_max3_f32 v11, v11, v82, v83
  v_max3_f32 v11, v11, v84, v85
  v_max3_f32 v11, v11, v86, v87
  v_max3_f32 v11, v11, v88, v89
  v_max3_f32 v11, v11, v90, v91
  v_max3_f32 v11, v11, v92, v93
  v_max3_f32 v11, v11, v94, v95
  ds_read_b128 v[32:35], v13 offset:61440
  ds_read_b128 v[36:39], v13 offset:62464
  s_waitcnt lgkmcnt(0)
  v_mfma_f32_32x32x16_bf16 v[64:79], v[32:35], v[16:19], 0
  v_mfma_f32_32x32x16_bf16 v[64:79], v[36:39], v[20:23], v[64:79]
  v_mfma_f32_32x32x16_bf16 v[80:95], v[32:35], v[24:27], 0
  v_mfma_f32_32x32x16_bf16 v[80:95], v[36:39], v[28:31], v[80:95]
  s_nop 9
  v_max3_f32 v10, v10, v64, v65
  v_max3_f32 v10, v10, v66, v67
  v_max3_f32 v10, v10, v68, v69
  v_max3_f32 v10, v10, v70, v71
  v_max3_f32 v10, v10, v72, v73
  v_max3_f32 v10, v10, v74, v75
  v_max3_f32 v10, v10, v76, v77
  v_max3_f32 v10, v10, v78, v79
  v_max3_f32 v11, v11, v80, v81
  v_max3_f32 v11, v11, v82, v83
  v_max3_f32 v11, v11, v84, v85
  v_max3_f32 v11, v11, v86, v87
  v_max3_f32 v11, v11, v88, v89
  v_max3_f32 v11, v11, v90, v91
  v_max3_f32 v11, v11, v92, v93
  v_max3_f32 v11, v11, v94, v95
  s_waitcnt vmcnt(0)
  s_barrier
  v_mov_b32 v8, v10
  s_nop 1
  v_permlane32_swap_b32 v10, v8
  v_max_f32 v10, v10, v8
  v_mov_b32 v8, v11
  s_nop 1
  v_permlane32_swap_b32 v11, v8
  v_max_f32 v11, v11, v8
  s_and_b32 s22, s20, 3
  s_lshl_b32 s22, s22, 10
  s_lshl_b32 s25, s21, 9
  s_add_u32 s22, s22, s25
  v_lshlrev_b32 v2, 2, v1
  v_add_u32 v2, s22, v2
  ds_write_b32 v2, v10
  ds_write_b32 v2, v11 offset:256
  s_waitcnt lgkmcnt(0)
  s_barrier
  v_xor_b32 v2, 512, v2
  ds_read_b32 v6, v2
  ds_read_b32 v7, v2 offset:256
  s_waitcnt lgkmcnt(0)
  v_cmp_gt_u32 vcc, 32, v1
  v_max_f32 v10, v10, v6
  v_sub_f32 v10, 0, v10
  v_cvt_pk_bf16_f32 v10, v10, v10
  v_and_b32 v10, 0xffff, v10
  v_cndmask_b32 v22, 0, v10, vcc
  v_mov_b32 v160, 0
  v_mov_b32 v161, 0
  v_mov_b32 v162, 0
  v_mov_b32 v163, 0
  v_mov_b32 v164, 0
  v_mov_b32 v165, 0
  v_mov_b32 v166, 0
  v_mov_b32 v167, 0
  v_mov_b32 v168, 0
  v_mov_b32 v169, 0
  v_mov_b32 v170, 0
  v_mov_b32 v171, 0
  v_mov_b32 v172, 0
  v_mov_b32 v173, 0
  v_mov_b32 v174, 0
  v_mov_b32 v175, 0
  v_max_f32 v11, v11, v7
  v_sub_f32 v11, 0, v11
  v_cvt_pk_bf16_f32 v11, v11, v11
  v_and_b32 v11, 0xffff, v11
  v_cndmask_b32 v30, 0, v11, vcc
  v_mov_b32 v176, 0
  v_mov_b32 v177, 0
  v_mov_b32 v178, 0
  v_mov_b32 v179, 0
  v_mov_b32 v180, 0
  v_mov_b32 v181, 0
  v_mov_b32 v182, 0
  v_mov_b32 v183, 0
  v_mov_b32 v184, 0
  v_mov_b32 v185, 0
  v_mov_b32 v186, 0
  v_mov_b32 v187, 0
  v_mov_b32 v188, 0
  v_mov_b32 v189, 0
  v_mov_b32 v190, 0
  v_mov_b32 v191, 0
  s_barrier
  s_and_b32 s22, s20, 3
  s_lshl_b32 s28, s22, 12
  s_add_u32 s28, s28, s29
  s_add_u32 m0, s26, 0
  s_nop 0
  buffer_load_dwordx4 v12, s[8:11], s28 offen offset:0 lds
  buffer_load_dwordx4 v12, s[8:11], s28 offen offset:1024 lds
  buffer_load_dwordx4 v12, s[8:11], s28 offen offset:2048 lds
  buffer_load_dwordx4 v12, s[8:11], s28 offen offset:3072 lds
  s_add_u32 s28, s28, 16384
  s_add_u32 m0, s26, 16384
  s_nop 0
  buffer_load_dwordx4 v12, s[8:11], s28 offen offset:0 lds
  buffer_load_dwordx4 v12, s[8:11], s28 offen offset:1024 lds
  buffer_load_dwordx4 v12, s[8:11], s28 offen offset:2048 lds
  buffer_load_dwordx4 v12, s[8:11], s28 offen offset:3072 lds
  s_add_u32 s28, s28, 16384
  s_add_u32 m0, s26, 32768
  s_nop 0
  buffer_load_dwordx4 v12, s[8:11], s28 offen offset:0 lds
  buffer_load_dwordx4 v12, s[8:11], s28 offen offset:1024 lds
  buffer_load_dwordx4 v12, s[8:11], s28 offen offset:2048 lds
  buffer_load_dwordx4 v12, s[8:11], s28 offen offset:3072 lds
  s_add_u32 s28, s28, 16384
  s_add_u32 m0, s26, 49152
  s_nop 0
  buffer_load_dwordx4 v12, s[8:11], s28 offen offset:0 lds
  buffer_load_dwordx4 v12, s[8:11], s28 offen offset:1024 lds
  buffer_load_dwordx4 v12, s[8:11], s28 offen offset:2048 lds
  buffer_load_dwordx4 v12, s[8:11], s28 offen offset:3072 lds
  s_add_u32 s28, s28, 16384
  s_branch L_retry_att_kernel
L_ok_att_kernel:
  s_cmp_lg_u32 s21, 0
  s_cbranch_scc1 L_end_att_kernel
  v_and_b32 v3, 31, v1
  s_lshl_b32 s22, s23, 6
  v_add_u32 v3, s22, v3
  v_mul_u32_u24 v3, 1280, v3
  v_lshrrev_b32 v4, 5, v1
  v_lshl_add_u32 v3, v4, 3, v3
  s_mul_i32 s22, s24, 40
  v_add_u32 v3, s22, v3
  v_add_u32 v4, 40960, v3
  v_mov_b32 v5, v168
  v_mov_b32 v6, v168
  s_nop 1
  v_permlane32_swap_b32 v5, v6
  v_rcp_f32 v6, v6
  s_nop 0
  v_mul_f32 v160, v160, v6
  v_mul_f32 v161, v161, v6
  v_mul_f32 v162, v162, v6
  v_mul_f32 v163, v163, v6
  v_cvt_pk_bf16_f32 v128, v160, v161
  v_cvt_pk_bf16_f32 v129, v162, v163
  v_mul_f32 v164, v164, v6
  v_mul_f32 v165, v165, v6
  v_mul_f32 v166, v166, v6
  v_mul_f32 v167, v167, v6
  v_cvt_pk_bf16_f32 v130, v164, v165
  v_cvt_pk_bf16_f32 v131, v166, v167
  v_mul_f32 v168, v168, v6
  v_mul_f32 v169, v169, v6
  v_mul_f32 v170, v170, v6
  v_mul_f32 v171, v171, v6
  v_cvt_pk_bf16_f32 v132, v168, v169
  v_cvt_pk_bf16_f32 v133, v170, v171
  buffer_store_dwordx2 v[128:129], v3, s[12:15], 0 offen offset:0
  buffer_store_dwordx2 v[130:131], v3, s[12:15], 0 offen offset:16
  v_cmp_gt_u32 vcc, 32, v1
  s_nop 0
  s_and_saveexec_b64 s[44:45], vcc
  buffer_store_dwordx2 v[132:133], v3, s[12:15], 0 offen offset:32
  s_mov_b64 exec, -1
  v_mov_b32 v5, v184
  v_mov_b32 v6, v184
  s_nop 1
  v_permlane32_swap_b32 v5, v6
  v_rcp_f32 v6, v6
  s_nop 0
  v_mul_f32 v176, v176, v6
  v_mul_f32 v177, v177, v6
  v_mul_f32 v178, v178, v6
  v_mul_f32 v179, v179, v6
  v_cvt_pk_bf16_f32 v128, v176, v177
  v_cvt_pk_bf16_f32 v129, v178, v179
  v_mul_f32 v180, v180, v6
  v_mul_f32 v181, v181, v6
  v_mul_f32 v182, v182, v6
  v_mul_f32 v183, v183, v6
  v_cvt_pk_bf16_f32 v130, v180, v181
  v_cvt_pk_bf16_f32 v131, v182, v183
  v_mul_f32 v184, v184, v6
  v_mul_f32 v185, v185, v6
  v_mul_f32 v186, v186, v6
  v_mul_f32 v187, v187, v6
  v_cvt_pk_bf16_f32 v132, v184, v185
  v_cvt_pk_bf16_f32 v133, v186, v187
  buffer_store_dwordx2 v[128:129], v4, s[12:15], 0 offen offset:0
  buffer_store_dwordx2 v[130:131], v4, s[12:15], 0 offen offset:16
  v_cmp_gt_u32 vcc, 32, v1
  s_nop 0
  s_and_saveexec_b64 s[44:45], vcc
  buffer_store_dwordx2 v[132:133], v4, s[12:15], 0 offen offset:32
  s_mov_b64 exec, -1
L_end_att_kernel:
  s_endpgm
.globl g2a_kernel
.p2align 8
.type g2a_kernel,@function
g2a_kernel:
  s_cmp_ge_u32 s2, 256
  s_cbranch_scc1 L_end_g2a_kernel
  s_load_dwordx2 s[32:33], s[0:1], 88
  s_load_dwordx2 s[34:35], s[0:1], 0
  s_load_dwordx2 s[36:37], s[0:1], 32
  v_lshrrev_b32 v15, 6, v0
  v_and_b32 v1, 63, v0
  v_readfirstlane_b32 s20, v15
  s_and_b32 s28, s2, 7
  s_lshr_b32 s30, s2, 3
  s_and_b32 s27, s30, 3
  s_lshr_b32 s30, s30, 2
  s_lshl_b32 s28, s28, 2
  s_add_u32 s28, s28, s27
  s_lshl_b32 s28, s28, 6
  s_mul_i32 s29, s30, 80
  s_waitcnt lgkmcnt(0)
  s_add_u32 s42, s32, 3145728
  s_addc_u32 s43, s33, 0
  s_mov_b32 s4, s42
  s_mov_b32 s5, s43
  s_mov_b32 s6, 2621440
  s_mov_b32 s7, 0x00020000
  s_mov_b32 s8, s36
  s_mov_b32 s9, s37
  s_mov_b32 s10, 819200
  s_mov_b32 s11, 0x00020000
  s_add_u32 s42, s32, 6291456
  s_addc_u32 s43, s33, 0
  s_mov_b32 s12, s42
  s_mov_b32 s13, s43
  s_mov_b32 s14, 2621440
  s_mov_b32 s15, 0x00020000
  s_mov_b32 s16, s34
  s_mov_b32 s17, s35
  s_mov_b32 s18, 2621440
  s_mov_b32 s19, 0x00020000
  s_sub_u32 s22, 23, s20
  s_lshr_b32 s22, s22, 2
  s_mul_i32 s27, s20, 5
  s_min_u32 s23, s20, 0
  s_add_u32 s27, s27, s23
  s_lshl_b32 s23, s27, 6
  s_mul_i32 s24, s27, 40960
  s_mul_i32 s21, s20, 36864
  v_lshrrev_b32 v15, 2, v1
  v_lshrrev_b32 v16, 3, v1
  v_xor_b32 v16, v16, v1
  v_and_b32 v16, 3, v16
  v_add_u32 v15, s28, v15
  s_mov_b32 s27, 1280
  v_mul_lo_u32 v15, v15, s27
  v_lshl_add_u32 v2, v16, 4, v15
  v_add_u32 v3, 20480, v2
  v_add_u32 v4, 40960, v2
  v_add_u32 v5, 61440, v2
  v_add_u32 v15, 0, v1
  v_mul_u32_u24 v16, 6554, v15
  v_lshrrev_b32 v16, 16, v16
  v_mul_u32_u24 v17, 10, v16
  v_sub_u32 v17, v15, v17
  v_mul_u32_u24 v16, 1280, v16
  v_lshl_add_u32 v6, v17, 4, v16
  v_add_u32 v15, 64, v1
  v_mul_u32_u24 v16, 6554, v15
  v_lshrrev_b32 v16, 16, v16
  v_mul_u32_u24 v17, 10, v16
  v_sub_u32 v17, v15, v17
  v_mul_u32_u24 v16, 1280, v16
  v_lshl_add_u32 v7, v17, 4, v16
  v_add_u32 v15, 128, v1
  v_mul_u32_u24 v16, 6554, v15
  v_lshrrev_b32 v16, 16, v16
  v_mul_u32_u24 v17, 10, v16
  v_sub_u32 v17, v15, v17
  v_mul_u32_u24 v16, 1280, v16
  v_lshl_add_u32 v8, v17, 4, v16
  v_add_u32 v15, 192, v1
  v_mul_u32_u24 v16, 6554, v15
  v_lshrrev_b32 v16, 16, v16
  v_mul_u32_u24 v17, 10, v16
  v_sub_u32 v17, v15, v17
  v_mul_u32_u24 v16, 1280, v16
  v_lshl_add_u32 v9, v17, 4, v16
  v_add_u32 v15, 256, v1
  v_mul_u32_u24 v16, 6554, v15
  v_lshrrev_b32 v16, 16, v16
  v_mul_u32_u24 v17, 10, v16
  v_sub_u32 v17, v15, v17
  v_mul_u32_u24 v16, 1280, v16
  v_lshl_add_u32 v10, v17, 4, v16
  s_lshl_b32 s27, s29, 1
  v_add_u32 v6, s27, v6
  v_add_u32 v7, s27, v7
  v_add_u32 v8, s27, v8
  v_add_u32 v9, s27, v9
  v_add_u32 v10, s27, v10
  v_and_b32 v15, 15, v1
  v_lshrrev_b32 v16, 4, v1
  v_lshrrev_b32 v17, 1, v15
  v_xor_b32 v17, v17, v16
  v_and_b32 v17, 3, v17
  v_lshlrev_b32 v17, 4, v17
  v_lshl_add_u32 v11, v15, 6, v17
  v_add_u32 v11, s21, v11
  v_lshrrev_b32 v17, 2, v15
  v_lshl_add_u32 v17, v16, 3, v17
  v_mov_b32 v19, v17
  v_mul_u32_u24 v17, 160, v17
  v_and_b32 v18, 3, v1
  v_lshl_add_u32 v12, v18, 3, v17
  v_add_u32 v12, 4096, v12
  v_add_u32 v12, s21, v12
  v_mov_b32 v60, 0
  v_mov_b32 v61, 0
  v_mov_b32 v62, 0
  v_mov_b32 v63, 0
  v_mov_b32 v64, 0
  v_mov_b32 v65, 0
  v_mov_b32 v66, 0
  v_mov_b32 v67, 0
  v_mov_b32 v68, 0
  v_mov_b32 v69, 0
  v_mov_b32 v70, 0
  v_mov_b32 v71, 0
  v_mov_b32 v72, 0
  v_mov_b32 v73, 0
  v_mov_b32 v74, 0
  v_mov_b32 v75, 0
  v_mov_b32 v76, 0
  v_mov_b32 v77, 0
  v_mov_b32 v78, 0
  v_mov_b32 v79, 0
  v_mov_b32 v80, 0
  v_mov_b32 v81, 0
  v_mov_b32 v82, 0
  v_mov_b32 v83, 0
  v_mov_b32 v84, 0
  v_mov_b32 v85, 0
  v_mov_b32 v86, 0
  v_mov_b32 v87, 0
  v_mov_b32 v88, 0
  v_mov_b32 v89, 0
  v_mov_b32 v90, 0
  v_mov_b32 v91, 0
  v_mov_b32 v92, 0
  v_mov_b32 v93, 0
  v_mov_b32 v94, 0
  v_mov_b32 v95, 0
  v_mov_b32 v96, 0
  v_mov_b32 v97, 0
  v_mov_b32 v98, 0
  v_mov_b32 v99, 0
  v_mov_b32 v100, 0
  v_mov_b32 v101, 0
  v_mov_b32 v102, 0
  v_mov_b32 v103, 0
  v_mov_b32 v104, 0
  v_mov_b32 v105, 0
  v_mov_b32 v106, 0
  v_mov_b32 v107, 0
  v_mov_b32 v108, 0
  v_mov_b32 v109, 0
  v_mov_b32 v110, 0
  v_mov_b32 v111, 0
  v_mov_b32 v112, 0
  v_mov_b32 v113, 0
  v_mov_b32 v114, 0
  v_mov_b32 v115, 0
  v_mov_b32 v116, 0
  v_mov_b32 v117, 0
  v_mov_b32 v118, 0
  v_mov_b32 v119, 0
  v_mov_b32 v120, 0
  v_mov_b32 v121, 0
  v_mov_b32 v122, 0
  v_mov_b32 v123, 0
  v_mov_b32 v124, 0
  v_mov_b32 v125, 0
  v_mov_b32 v126, 0
  v_mov_b32 v127, 0
  v_mov_b32 v128, 0
  v_mov_b32 v129, 0
  v_mov_b32 v130, 0
  v_mov_b32 v131, 0
  v_mov_b32 v132, 0
  v_mov_b32 v133, 0
  v_mov_b32 v134, 0
  v_mov_b32 v135, 0
  v_mov_b32 v136, 0
  v_mov_b32 v137, 0
  v_mov_b32 v138, 0
  v_mov_b32 v139, 0
  s_mov_b32 s25, s21
  s_mov_b32 s26, 0
  v_and_b32 v15, 15, v1
  v_lshrrev_b32 v16, 4, v1
  s_lshl_b32 s27, s20, 4
  s_add_u32 s27, s27, s28
  v_add_u32 v15, s27, v15
  v_mul_u32_u24 v15, 1280, v15
  v_lshl_add_u32 v16, v16, 3, v15
  s_lshl_b32 s27, s29, 1
  v_add_u32 v23, s27, v16
  buffer_load_dwordx2 v[154:155], v23, s[16:19], 0 offen offset:0
  buffer_load_dwordx2 v[156:157], v23, s[16:19], 0 offen offset:32
  buffer_load_dwordx2 v[158:159], v23, s[16:19], 0 offen offset:64
  buffer_load_dwordx2 v[160:161], v23, s[16:19], 0 offen offset:96
  buffer_load_dwordx2 v[162:163], v23, s[16:19], 0 offen offset:128
  s_add_u32 m0, s25, 0
  s_nop 0
  buffer_load_dwordx4 v2, s[4:7], s23 offen lds
  s_add_u32 m0, s25, 1024
  s_nop 0
  buffer_load_dwordx4 v3, s[4:7], s23 offen lds
  s_add_u32 m0, s25, 2048
  s_nop 0
  buffer_load_dwordx4 v4, s[4:7], s23 offen lds
  s_add_u32 m0, s25, 3072
  s_nop 0
  buffer_load_dwordx4 v5, s[4:7], s23 offen lds
  s_add_u32 m0, s25, 4096
  s_nop 0
  buffer_load_dwordx4 v6, s[8:11], s24 offen lds
  s_add_u32 m0, s25, 5120
  s_nop 0
  buffer_load_dwordx4 v7, s[8:11], s24 offen lds
  s_add_u32 m0, s25, 6144
  s_nop 0
  buffer_load_dwordx4 v8, s[8:11], s24 offen lds
  s_add_u32 m0, s25, 7168
  s_nop 0
  buffer_load_dwordx4 v9, s[8:11], s24 offen lds
  s_add_u32 m0, s25, 8192
  s_nop 0
  buffer_load_dwordx4 v10, s[8:11], s24 offen lds
  s_add_u32 s24, s24, 40960
  s_add_u32 s23, s23, 64
  s_add_u32 s25, s25, 9216
  s_add_u32 s27, s21, 36864
  s_cmp_ge_u32 s25, s27
  s_cselect_b32 s25, s21, s25
  s_add_u32 m0, s25, 0
  s_nop 0
  buffer_load_dwordx4 v2, s[4:7], s23 offen lds
  s_add_u32 m0, s25, 1024
  s_nop 0
  buffer_load_dwordx4 v3, s[4:7], s23 offen lds
  s_add_u32 m0, s25, 2048
  s_nop 0
  buffer_load_dwordx4 v4, s[4:7], s23 offen lds
  s_add_u32 m0, s25, 3072
  s_nop 0
  buffer_load_dwordx4 v5, s[4:7], s23 offen lds
  s_add_u32 m0, s25, 4096
  s_nop 0
  buffer_load_dwordx4 v6, s[8:11], s24 offen lds
  s_add_u32 m0, s25, 5120
  s_nop 0
  buffer_load_dwordx4 v7, s[8:11], s24 offen lds
  s_add_u32 m0, s25, 6144
  s_nop 0
  buffer_load_dwordx4 v8, s[8:11], s24 offen lds
  s_add_u32 m0, s25, 7168
  s_nop 0
  buffer_load_dwordx4 v9, s[8:11], s24 offen lds
  s_add_u32 m0, s25, 8192
  s_nop 0
  buffer_load_dwordx4 v10, s[8:11], s24 offen lds
  s_add_u32 s24, s24, 40960
  s_add_u32 s23, s23, 64
  s_add_u32 s25, s25, 9216
  s_add_u32 s27, s21, 36864
  s_cmp_ge_u32 s25, s27
  s_cselect_b32 s25, s21, s25
  s_add_u32 m0, s25, 0
  s_nop 0
  buffer_load_dwordx4 v2, s[4:7], s23 offen lds
  s_add_u32 m0, s25, 1024
  s_nop 0
  buffer_load_dwordx4 v3, s[4:7], s23 offen lds
  s_add_u32 m0, s25, 2048
  s_nop 0
  buffer_load_dwordx4 v4, s[4:7], s23 offen lds
  s_add_u32 m0, s25, 3072
  s_nop 0
  buffer_load_dwordx4 v5, s[4:7], s23 offen lds
  s_add_u32 m0, s25, 4096
  s_nop 0
  buffer_load_dwordx4 v6, s[8:11], s24 offen lds
  s_add_u32 m0, s25, 5120
  s_nop 0
  buffer_load_dwordx4 v7, s[8:11], s24 offen lds
  s_add_u32 m0, s25, 6144
  s_nop 0
  buffer_load_dwordx4 v8, s[8:11], s24 offen lds
  s_add_u32 m0, s25, 7168
  s_nop 0
  buffer_load_dwordx4 v9, s[8:11], s24 offen lds
  s_add_u32 m0, s25, 8192
  s_nop 0
  buffer_load_dwordx4 v10, s[8:11], s24 offen lds
  s_add_u32 s24, s24, 40960
  s_add_u32 s23, s23, 64
  s_add_u32 s25, s25, 9216
  s_add_u32 s27, s21, 36864
  s_cmp_ge_u32 s25, s27
  s_cselect_b32 s25, s21, s25
L_loop_g2a_kernel:
  s_add_u32 m0, s25, 0
  s_nop 0
  buffer_load_dwordx4 v2, s[4:7], s23 offen lds
  s_add_u32 m0, s25, 1024
  s_nop 0
  buffer_load_dwordx4 v3, s[4:7], s23 offen lds
  s_add_u32 m0, s25, 2048
  s_nop 0
  buffer_load_dwordx4 v4, s[4:7], s23 offen lds
  s_add_u32 m0, s25, 3072
  s_nop 0
  buffer_load_dwordx4 v5, s[4:7], s23 offen lds
  s_add_u32 m0, s25, 4096
  s_nop 0
  buffer_load_dwordx4 v6, s[8:11], s24 offen lds
  s_add_u32 m0, s25, 5120
  s_nop 0
  buffer_load_dwordx4 v7, s[8:11], s24 offen lds
  s_add_u32 m0, s25, 6144
  s_nop 0
  buffer_load_dwordx4 v8, s[8:11], s24 offen lds
  s_add_u32 m0, s25, 7168
  s_nop 0
  buffer_load_dwordx4 v9, s[8:11], s24 offen lds
  s_add_u32 m0, s25, 8192
  s_nop 0
  buffer_load_dwordx4 v10, s[8:11], s24 offen lds
  s_add_u32 s24, s24, 40960
  s_add_u32 s23, s23, 64
  s_add_u32 s25, s25, 9216
  s_add_u32 s27, s21, 36864
  s_cmp_ge_u32 s25, s27
  s_cselect_b32 s25, s21, s25
  s_waitcnt vmcnt(27)
  v_add_u32 v13, s26, v11
  v_add_u32 v14, s26, v12
  ds_read_b128 v[24:27], v13 offset:0
  ds_read_b128 v[28:31], v13 offset:1024
  ds_read_b128 v[32:35], v13 offset:2048
  ds_read_b128 v[36:39], v13 offset:3072
  ds_read_b64_tr_b16 v[40:41], v14 offset:0
  ds_read_b64_tr_b16 v[42:43], v14 offset:640
  ds_read_b64_tr_b16 v[44:45], v14 offset:32
  ds_read_b64_tr_b16 v[46:47], v14 offset:672
  ds_read_b64_tr_b16 v[48:49], v14 offset:64
  ds_read_b64_tr_b16 v[50:51], v14 offset:704
  ds_read_b64_tr_b16 v[52:53], v14 offset:96
  ds_read_b64_tr_b16 v[54:55], v14 offset:736
  ds_read_b64_tr_b16 v[56:57], v14 offset:128
  ds_read_b64_tr_b16 v[58:59], v14 offset:768
  s_add_u32 s26, s26, 9216
  s_cmp_ge_u32 s26, 36864
  s_cselect_b32 s26, 0, s26
  s_waitcnt lgkmcnt(0)
  v_mfma_f32_16x16x32_bf16 v[60:63], v[40:43], v[24:27], v[60:63]
  v_mfma_f32_16x16x32_bf16 v[64:67], v[44:47], v[24:27], v[64:67]
  v_mfma_f32_16x16x32_bf16 v[68:71], v[48:51], v[24:27], v[68:71]
  v_mfma_f32_16x16x32_bf16 v[72:75], v[52:55], v[24:27], v[72:75]
  v_mfma_f32_16x16x32_bf16 v[76:79], v[56:59], v[24:27], v[76:79]
  v_mfma_f32_16x16x32_bf16 v[80:83], v[40:43], v[28:31], v[80:83]
  v_mfma_f32_16x16x32_bf16 v[84:87], v[44:47], v[28:31], v[84:87]
  v_mfma_f32_16x16x32_bf16 v[88:91], v[48:51], v[28:31], v[88:91]
  v_mfma_f32_16x16x32_bf16 v[92:95], v[52:55], v[28:31], v[92:95]
  v_mfma_f32_16x16x32_bf16 v[96:99], v[56:59], v[28:31], v[96:99]
  v_mfma_f32_16x16x32_bf16 v[100:103], v[40:43], v[32:35], v[100:103]
  v_mfma_f32_16x16x32_bf16 v[104:107], v[44:47], v[32:35], v[104:107]
  v_mfma_f32_16x16x32_bf16 v[108:111], v[48:51], v[32:35], v[108:111]
  v_mfma_f32_16x16x32_bf16 v[112:115], v[52:55], v[32:35], v[112:115]
  v_mfma_f32_16x16x32_bf16 v[116:119], v[56:59], v[32:35], v[116:119]
  v_mfma_f32_16x16x32_bf16 v[120:123], v[40:43], v[36:39], v[120:123]
  v_mfma_f32_16x16x32_bf16 v[124:127], v[44:47], v[36:39], v[124:127]
  v_mfma_f32_16x16x32_bf16 v[128:131], v[48:51], v[36:39], v[128:131]
  v_mfma_f32_16x16x32_bf16 v[132:135], v[52:55], v[36:39], v[132:135]
  v_mfma_f32_16x16x32_bf16 v[136:139], v[56:59], v[36:39], v[136:139]
  s_sub_u32 s22, s22, 1
  s_cmp_lg_u32 s22, 0
  s_cbranch_scc1 L_loop_g2a_kernel
  s_waitcnt vmcnt(0)
  v_lshlrev_b32 v15, 4, v1
  v_add_u32 v15, s21, v15
  ds_write_b128 v15, v[60:63] offset:0
  ds_write_b128 v15, v[64:67] offset:1024
  ds_write_b128 v15, v[68:71] offset:2048
  ds_write_b128 v15, v[72:75] offset:3072
  ds_write_b128 v15, v[76:79] offset:4096
  ds_write_b128 v15, v[80:83] offset:5120
  ds_write_b128 v15, v[84:87] offset:6144
  ds_write_b128 v15, v[88:91] offset:7168
  ds_write_b128 v15, v[92:95] offset:8192
  ds_write_b128 v15, v[96:99] offset:9216
  ds_write_b128 v15, v[100:103] offset:10240
  ds_write_b128 v15, v[104:107] offset:11264
  ds_write_b128 v15, v[108:111] offset:12288
  ds_write_b128 v15, v[112:115] offset:13312
  ds_write_b128 v15, v[116:119] offset:14336
  ds_write_b128 v15, v[120:123] offset:15360
  ds_write_b128 v15, v[124:127] offset:16384
  ds_write_b128 v15, v[128:131] offset:17408
  ds_write_b128 v15, v[132:135] offset:18432
  ds_write_b128 v15, v[136:139] offset:19456
  s_waitcnt lgkmcnt(0)
  s_barrier
  v_lshlrev_b32 v15, 4, v1
  s_mul_i32 s27, s20, 5120
  v_add_u32 v15, s27, v15
  v_add_u32 v16, 36864, v15
  v_add_u32 v17, 73728, v15
  v_add_u32 v18, 110592, v15
  ds_read_b128 v[60:63], v15 offset:0
  ds_read_b128 v[64:67], v15 offset:1024
  ds_read_b128 v[68:71], v15 offset:2048
  ds_read_b128 v[72:75], v15 offset:3072
  ds_read_b128 v[76:79], v15 offset:4096
  ds_read_b128 v[80:83], v16 offset:0
  ds_read_b128 v[84:87], v16 offset:1024
  ds_read_b128 v[88:91], v16 offset:2048
  ds_read_b128 v[92:95], v16 offset:3072
  ds_read_b128 v[96:99], v16 offset:4096
  ds_read_b128 v[100:103], v17 offset:0
  ds_read_b128 v[104:107], v17 offset:1024
  ds_read_b128 v[108:111], v17 offset:2048
  ds_read_b128 v[112:115], v17 offset:3072
  ds_read_b128 v[116:119], v17 offset:4096
  ds_read_b128 v[120:123], v18 offset:0
  ds_read_b128 v[124:127], v18 offset:1024
  ds_read_b128 v[128:131], v18 offset:2048
  ds_read_b128 v[132:135], v18 offset:3072
  ds_read_b128 v[136:139], v18 offset:4096
  s_waitcnt lgkmcnt(0)
  v_add_f32 v60, v60, v80
  v_add_f32 v61, v61, v81
  v_add_f32 v62, v62, v82
  v_add_f32 v63, v63, v83
  v_add_f32 v64, v64, v84
  v_add_f32 v65, v65, v85
  v_add_f32 v66, v66, v86
  v_add_f32 v67, v67, v87
  v_add_f32 v68, v68, v88
  v_add_f32 v69, v69, v89
  v_add_f32 v70, v70, v90
  v_add_f32 v71, v71, v91
  v_add_f32 v72, v72, v92
  v_add_f32 v73, v73, v93
  v_add_f32 v74, v74, v94
  v_add_f32 v75, v75, v95
  v_add_f32 v76, v76, v96
  v_add_f32 v77, v77, v97
  v_add_f32 v78, v78, v98
  v_add_f32 v79, v79, v99
  v_add_f32 v60, v60, v100
  v_add_f32 v61, v61, v101
  v_add_f32 v62, v62, v102
  v_add_f32 v63, v63, v103
  v_add_f32 v64, v64, v104
  v_add_f32 v65, v65, v105
  v_add_f32 v66, v66, v106
  v_add_f32 v67, v67, v107
  v_add_f32 v68, v68, v108
  v_add_f32 v69, v69, v109
  v_add_f32 v70, v70, v110
  v_add_f32 v71, v71, v111
  v_add_f32 v72, v72, v112
  v_add_f32 v73, v73, v113
  v_add_f32 v74, v74, v114
  v_add_f32 v75, v75, v115
  v_add_f32 v76, v76, v116
  v_add_f32 v77, v77, v117
  v_add_f32 v78, v78, v118
  v_add_f32 v79, v79, v119
  v_add_f32 v60, v60, v120
  v_add_f32 v61, v61, v121
  v_add_f32 v62, v62, v122
  v_add_f32 v63, v63, v123
  v_add_f32 v64, v64, v124
  v_add_f32 v65, v65, v125
  v_add_f32 v66, v66, v126
  v_add_f32 v67, v67, v127
  v_add_f32 v68, v68, v128
  v_add_f32 v69, v69, v129
  v_add_f32 v70, v70, v130
  v_add_f32 v71, v71, v131
  v_add_f32 v72, v72, v132
  v_add_f32 v73, v73, v133
  v_add_f32 v74, v74, v134
  v_add_f32 v75, v75, v135
  v_add_f32 v76, v76, v136
  v_add_f32 v77, v77, v137
  v_add_f32 v78, v78, v138
  v_add_f32 v79, v79, v139
  s_waitcnt vmcnt(0)
  v_mov_b32 v100, 0xffff0000
  v_mov_b32 v140, 0
  v_mov_b32 v141, 0
  v_lshlrev_b32 v17, 16, v154
  v_and_b32 v18, v100, v154
  v_add_f32 v60, v60, v17
  v_add_f32 v61, v61, v18
  v_cvt_pk_bf16_f32 v80, v60, v61
  v_lshlrev_b32 v17, 16, v80
  v_and_b32 v18, v100, v80
  v_add_f32 v140, v140, v17
  v_fmac_f32 v141, v17, v17
  v_add_f32 v140, v140, v18
  v_fmac_f32 v141, v18, v18
  v_lshlrev_b32 v17, 16, v155
  v_and_b32 v18, v100, v155
  v_add_f32 v62, v62, v17
  v_add_f32 v63, v63, v18
  v_cvt_pk_bf16_f32 v81, v62, v63
  v_lshlrev_b32 v17, 16, v81
  v_and_b32 v18, v100, v81
  v_add_f32 v140, v140, v17
  v_fmac_f32 v141, v17, v17
  v_add_f32 v140, v140, v18
  v_fmac_f32 v141, v18, v18
  buffer_store_dwordx2 v[80:81], v23, s[12:15], 0 offen offset:0
  v_lshlrev_b32 v17, 16, v156
  v_and_b32 v18, v100, v156
  v_add_f32 v64, v64, v17
  v_add_f32 v65, v65, v18
  v_cvt_pk_bf16_f32 v82, v64, v65
  v_lshlrev_b32 v17, 16, v82
  v_and_b32 v18, v100, v82
  v_add_f32 v140, v140, v17
  v_fmac_f32 v141, v17, v17
  v_add_f32 v140, v140, v18
  v_fmac_f32 v141, v18, v18
  v_lshlrev_b32 v17, 16, v157
  v_and_b32 v18, v100, v157
  v_add_f32 v66, v66, v17
  v_add_f32 v67, v67, v18
  v_cvt_pk_bf16_f32 v83, v66, v67
  v_lshlrev_b32 v17, 16, v83
  v_and_b32 v18, v100, v83
  v_add_f32 v140, v140, v17
  v_fmac_f32 v141, v17, v17
  v_add_f32 v140, v140, v18
  v_fmac_f32 v141, v18, v18
  buffer_store_dwordx2 v[82:83], v23, s[12:15], 0 offen offset:32
  v_lshlrev_b32 v17, 16, v158
  v_and_b32 v18, v100, v158
  v_add_f32 v68, v68, v17
  v_add_f32 v69, v69, v18
  v_cvt_pk_bf16_f32 v84, v68, v69
  v_lshlrev_b32 v17, 16, v84
  v_and_b32 v18, v100, v84
  v_add_f32 v140, v140, v17
  v_fmac_f32 v141, v17, v17
  v_add_f32 v140, v140, v18
  v_fmac_f32 v141, v18, v18
  v_lshlrev_b32 v17, 16, v159
  v_and_b32 v18, v100, v159
  v_add_f32 v70, v70, v17
  v_add_f32 v71, v71, v18
  v_cvt_pk_bf16_f32 v85, v70, v71
  v_lshlrev_b32 v17, 16, v85
  v_and_b32 v18, v100, v85
  v_add_f32 v140, v140, v17
  v_fmac_f32 v141, v17, v17
  v_add_f32 v140, v140, v18
  v_fmac_f32 v141, v18, v18
  buffer_store_dwordx2 v[84:85], v23, s[12:15], 0 offen offset:64
  v_lshlrev_b32 v17, 16, v160
  v_and_b32 v18, v100, v160
  v_add_f32 v72, v72, v17
  v_add_f32 v73, v73, v18
  v_cvt_pk_bf16_f32 v86, v72, v73
  v_lshlrev_b32 v17, 16, v86
  v_and_b32 v18, v100, v86
  v_add_f32 v140, v140, v17
  v_fmac_f32 v141, v17, v17
  v_add_f32 v140, v140, v18
  v_fmac_f32 v141, v18, v18
  v_lshlrev_b32 v17, 16, v161
  v_and_b32 v18, v100, v161
  v_add_f32 v74, v74, v17
  v_add_f32 v75, v75, v18
  v_cvt_pk_bf16_f32 v87, v74, v75
  v_lshlrev_b32 v17, 16, v87
  v_and_b32 v18, v100, v87
  v_add_f32 v140, v140, v17
  v_fmac_f32 v141, v17, v17
  v_add_f32 v140, v140, v18
  v_fmac_f32 v141, v18, v18
  buffer_store_dwordx2 v[86:87], v23, s[12:15], 0 offen offset:96
  v_lshlrev_b32 v17, 16, v162
  v_and_b32 v18, v100, v162
  v_add_f32 v76, v76, v17
  v_add_f32 v77, v77, v18
  v_cvt_pk_bf16_f32 v88, v76, v77
  v_lshlrev_b32 v17, 16, v88
  v_and_b32 v18, v100, v88
  v_add_f32 v140, v140, v17
  v_fmac_f32 v141, v17, v17
  v_add_f32 v140, v140, v18
  v_fmac_f32 v141, v18, v18
  v_lshlrev_b32 v17, 16, v163
  v_and_b32 v18, v100, v163
  v_add_f32 v78, v78, v17
  v_add_f32 v79, v79, v18
  v_cvt_pk_bf16_f32 v89, v78, v79
  v_lshlrev_b32 v17, 16, v89
  v_and_b32 v18, v100, v89
  v_add_f32 v140, v140, v17
  v_fmac_f32 v141, v17, v17
  v_add_f32 v140, v140, v18
  v_fmac_f32 v141, v18, v18
  buffer_store_dwordx2 v[88:89], v23, s[12:15], 0 offen offset:128
  v_mov_b32 v17, v140
  s_nop 1
  v_permlane16_swap_b32 v140, v17
  v_add_f32 v140, v140, v17
  v_mov_b32 v17, v140
  s_nop 1
  v_permlane32_swap_b32 v140, v17
  v_add_f32 v140, v140, v17
  v_mov_b32 v17, v141
  s_nop 1
  v_permlane16_swap_b32 v141, v17
  v_add_f32 v141, v141, v17
  v_mov_b32 v17, v141
  s_nop 1
  v_permlane32_swap_b32 v141, v17
  v_add_f32 v141, v141, v17
  s_add_u32 s42, s32, 13631488
  s_addc_u32 s43, s33, 0
  s_mov_b32 s12, s42
  s_mov_b32 s13, s43
  s_mov_b32 s14, 131072
  s_mov_b32 s15, 0x00020000
  v_and_b32 v15, 15, v1
  s_lshl_b32 s27, s20, 4
  s_add_u32 s27, s27, s28
  v_add_u32 v15, s27, v15
  v_lshl_add_u32 v15, v15, 3, s30
  v_lshlrev_b32 v15, 3, v15
  v_cmp_gt_u32 vcc, 16, v1
  s_nop 0
  s_and_saveexec_b64 s[44:45], vcc
  buffer_store_dwordx2 v[140:141], v15, s[12:15], 0 offen
  s_mov_b64 exec, -1
L_end_g2a_kernel:
  s_endpgm
.globl g3_kernel
.p2align 8
.type g3_kernel,@function
g3_kernel:
  s_cmp_ge_u32 s2, 216
  s_cbranch_scc1 L_end_g3_kernel
  s_load_dwordx2 s[32:33], s[0:1], 88
  s_load_dwordx2 s[34:35], s[0:1], 48
  s_load_dwordx2 s[36:37], s[0:1], 56
  v_lshrrev_b32 v2, 6, v0
  v_and_b32 v1, 63, v0
  v_readfirstlane_b32 s24, v2
  s_and_b32 s28, s2, 7
  s_lshl_b32 s28, s28, 8
  s_lshr_b32 s29, s2, 3
  s_lshl_b32 s29, s29, 6
  s_lshr_b32 s25, s24, 1
  s_and_b32 s26, s24, 1
  s_waitcnt lgkmcnt(0)
  s_add_u32 s38, s32, 6291456
  s_addc_u32 s39, s33, 0
  s_mov_b32 s4, s38
  s_mov_b32 s5, s39
  s_mov_b32 s6, 2621440
  s_mov_b32 s7, 0x00020000
  s_mov_b32 s8, s34
  s_mov_b32 s9, s35
  s_mov_b32 s10, 2211840
  s_mov_b32 s11, 0x00020000
  s_mov_b32 s12, s36
  s_mov_b32 s13, s37
  s_mov_b32 s14, 2211840
  s_mov_b32 s15, 0x00020000
  s_add_u32 s38, s32, 16777216
  s_addc_u32 s39, s33, 0
  s_mov_b32 s16, s38
  s_mov_b32 s17, s39
  s_mov_b32 s18, 7077888
  s_mov_b32 s19, 0x00020000
  s_add_u32 s38, s32, 13631488
  s_addc_u32 s39, s33, 0
  s_mov_b32 s20, s38
  s_mov_b32 s21, s39
  s_mov_b32 s22, 131072
  s_mov_b32 s23, 0x00020000
  v_and_b32 v2, 31, v1
  s_lshl_b32 s27, s25, 6
  s_add_u32 s27, s27, s28
  v_add_u32 v2, s27, v2
  v_lshlrev_b32 v3, 6, v2
  buffer_load_dwordx4 v[26:29], v3, s[20:23], 0 offen offset:0
  buffer_load_dwordx4 v[30:33], v3, s[20:23], 0 offen offset:16
  buffer_load_dwordx4 v[34:37], v3, s[20:23], 0 offen offset:32
  buffer_load_dwordx4 v[38:41], v3, s[20:23], 0 offen offset:48
  buffer_load_dwordx4 v[42:45], v3, s[20:23], 0 offen offset:2048
  buffer_load_dwordx4 v[46:49], v3, s[20:23], 0 offen offset:2064
  buffer_load_dwordx4 v[50:53], v3, s[20:23], 0 offen offset:2080
  buffer_load_dwordx4 v[54:57], v3, s[20:23], 0 offen offset:2096
  v_lshrrev_b32 v3, 3, v1
  s_lshl_b32 s27, s24, 5
  s_add_u32 s27, s27, s28
  v_add_u32 v3, s27, v3
  v_mul_u32_u24 v3, 1280, v3
  v_lshrrev_b32 v4, 4, v1
  v_and_b32 v5, 7, v1
  v_xor_b32 v6, v4, v5
  v_lshl_add_u32 v10, v6, 4, v3
  v_xor_b32 v6, v4, v5
  v_xor_b32 v6, 4, v6
  v_lshl_add_u32 v11, v6, 4, v3
  v_add_u32 v11, 10240, v11
  v_xor_b32 v6, v4, v5
  v_lshl_add_u32 v12, v6, 4, v3
  v_add_u32 v12, 20480, v12
  v_xor_b32 v6, v4, v5
  v_xor_b32 v6, 4, v6
  v_lshl_add_u32 v13, v6, 4, v3
  v_add_u32 v13, 30720, v13
  v_lshrrev_b32 v3, 3, v1
  v_and_b32 v4, 3, v3
  v_lshlrev_b32 v4, 1, v4
  v_xor_b32 v4, v4, v5
  s_lshl_b32 s27, s24, 3
  v_add_u32 v3, s27, v3
  v_mul_u32_u24 v3, 3456, v3
  v_lshl_add_u32 v14, v4, 4, v3
  s_lshl_b32 s27, s29, 1
  v_add_u32 v14, s27, v14
  v_and_b32 v2, 31, v1
  s_lshl_b32 s27, s25, 6
  v_add_u32 v2, s27, v2
  v_lshrrev_b32 v3, 1, v2
  v_and_b32 v3, 7, v3
  v_lshrrev_b32 v4, 5, v1
  v_xor_b32 v3, v3, v4
  v_lshlrev_b32 v3, 4, v3
  v_lshl_add_u32 v15, v2, 7, v3
  v_and_b32 v2, 15, v1
  v_lshrrev_b32 v3, 4, v1
  v_lshrrev_b32 v4, 1, v3
  v_lshlrev_b32 v4, 3, v4
  v_lshrrev_b32 v5, 2, v2
  v_add_u32 v4, v4, v5
  v_and_b32 v5, 1, v3
  v_lshlrev_b32 v5, 5, v5
  v_and_b32 v6, 3, v2
  v_lshl_add_u32 v5, v6, 3, v5
  s_lshl_b32 s27, s26, 6
  v_add_u32 v5, s27, v5
  v_add_u32 v7, 0, v4
  v_and_b32 v8, 3, v7
  v_lshlrev_b32 v8, 5, v8
  v_xor_b32 v8, v8, v5
  v_lshl_add_u32 v16, v7, 7, v8
  v_add_u32 v16, 32768, v16
  v_add_u32 v7, 4, v4
  v_and_b32 v8, 3, v7
  v_lshlrev_b32 v8, 5, v8
  v_xor_b32 v8, v8, v5
  v_lshl_add_u32 v17, v7, 7, v8
  v_add_u32 v17, 32768, v17
  v_mov_b32 v194, 0x3f803f80
  v_mov_b32 v18, 0
  v_mov_b32 v19, 0
  v_mov_b32 v90, 0
  v_mov_b32 v91, 0
  v_mov_b32 v92, 0
  v_mov_b32 v93, 0
  v_mov_b32 v94, 0
  v_mov_b32 v95, 0
  v_mov_b32 v96, 0
  v_mov_b32 v97, 0
  v_mov_b32 v98, 0
  v_mov_b32 v99, 0
  v_mov_b32 v100, 0
  v_mov_b32 v101, 0
  v_mov_b32 v102, 0
  v_mov_b32 v103, 0
  v_mov_b32 v104, 0
  v_mov_b32 v105, 0
  v_mov_b32 v106, 0
  v_mov_b32 v107, 0
  v_mov_b32 v108, 0
  v_mov_b32 v109, 0
  v_mov_b32 v110, 0
  v_mov_b32 v111, 0
  v_mov_b32 v112, 0
  v_mov_b32 v113, 0
  v_mov_b32 v114, 0
  v_mov_b32 v115, 0
  v_mov_b32 v116, 0
  v_mov_b32 v117, 0
  v_mov_b32 v118, 0
  v_mov_b32 v119, 0
  v_mov_b32 v120, 0
  v_mov_b32 v121, 0
  v_mov_b32 v122, 0
  v_mov_b32 v123, 0
  v_mov_b32 v124, 0
  v_mov_b32 v125, 0
  v_mov_b32 v126, 0
  v_mov_b32 v127, 0
  v_mov_b32 v128, 0
  v_mov_b32 v129, 0
  v_mov_b32 v130, 0
  v_mov_b32 v131, 0
  v_mov_b32 v132, 0
  v_mov_b32 v133, 0
  v_mov_b32 v134, 0
  v_mov_b32 v135, 0
  v_mov_b32 v136, 0
  v_mov_b32 v137, 0
  v_mov_b32 v138, 0
  v_mov_b32 v139, 0
  v_mov_b32 v140, 0
  v_mov_b32 v141, 0
  v_mov_b32 v142, 0
  v_mov_b32 v143, 0
  v_mov_b32 v144, 0
  v_mov_b32 v145, 0
  v_mov_b32 v146, 0
  v_mov_b32 v147, 0
  v_mov_b32 v148, 0
  v_mov_b32 v149, 0
  v_mov_b32 v150, 0
  v_mov_b32 v151, 0
  v_mov_b32 v152, 0
  v_mov_b32 v153, 0
  s_mov_b32 s30, 0
  s_mov_b32 s31, 0
  s_lshl_b32 s27, s24, 12
  s_add_u32 m0, s27, 0
  s_nop 0
  buffer_load_dwordx4 v10, s[4:7], s30 offen lds
  s_lshl_b32 s27, s24, 12
  s_add_u32 m0, s27, 1024
  s_nop 0
  buffer_load_dwordx4 v11, s[4:7], s30 offen lds
  s_lshl_b32 s27, s24, 12
  s_add_u32 m0, s27, 2048
  s_nop 0
  buffer_load_dwordx4 v12, s[4:7], s30 offen lds
  s_lshl_b32 s27, s24, 12
  s_add_u32 m0, s27, 3072
  s_nop 0
  buffer_load_dwordx4 v13, s[4:7], s30 offen lds
  s_lshl_b32 s27, s24, 10
  s_add_u32 m0, s27, 32768
  s_nop 0
  buffer_load_dwordx4 v14, s[8:11], s31 offen lds
  s_lshl_b32 s27, s24, 10
  s_add_u32 m0, s27, 40960
  s_nop 0
  buffer_load_dwordx4 v14, s[12:15], s31 offen lds
  s_add_u32 s30, s30, 128
  s_add_u32 s31, s31, 221184
  s_lshl_b32 s27, s24, 12
  s_add_u32 m0, s27, 49152
  s_nop 0
  buffer_load_dwordx4 v10, s[4:7], s30 offen lds
  s_lshl_b32 s27, s24, 12
  s_add_u32 m0, s27, 50176
  s_nop 0
  buffer_load_dwordx4 v11, s[4:7], s30 offen lds
  s_lshl_b32 s27, s24, 12
  s_add_u32 m0, s27, 51200
  s_nop 0
  buffer_load_dwordx4 v12, s[4:7], s30 offen lds
  s_lshl_b32 s27, s24, 12
  s_add_u32 m0, s27, 52224
  s_nop 0
  buffer_load_dwordx4 v13, s[4:7], s30 offen lds
  s_lshl_b32 s27, s24, 10
  s_add_u32 m0, s27, 81920
  s_nop 0
  buffer_load_dwordx4 v14, s[8:11], s31 offen lds
  s_lshl_b32 s27, s24, 10
  s_add_u32 m0, s27, 90112
  s_nop 0
  buffer_load_dwordx4 v14, s[12:15], s31 offen lds
  s_add_u32 s30, s30, 128
  s_add_u32 s31, s31, 221184
  s_waitcnt vmcnt(6)
  s_barrier
  s_lshl_b32 s27, s24, 12
  s_add_u32 m0, s27, 98304
  s_nop 0
  buffer_load_dwordx4 v10, s[4:7], s30 offen lds
  s_lshl_b32 s27, s24, 12
  s_add_u32 m0, s27, 99328
  s_nop 0
  buffer_load_dwordx4 v11, s[4:7], s30 offen lds
  s_lshl_b32 s27, s24, 12
  s_add_u32 m0, s27, 100352
  s_nop 0
  buffer_load_dwordx4 v12, s[4:7], s30 offen lds
  s_lshl_b32 s27, s24, 12
  s_add_u32 m0, s27, 101376
  s_nop 0
  buffer_load_dwordx4 v13, s[4:7], s30 offen lds
  s_lshl_b32 s27, s24, 10
  s_add_u32 m0, s27, 131072
  s_nop 0
  buffer_load_dwordx4 v14, s[8:11], s31 offen lds
  s_lshl_b32 s27, s24, 10
  s_add_u32 m0, s27, 139264
  s_nop 0
  buffer_load_dwordx4 v14, s[12:15], s31 offen lds
  s_add_u32 s30, s30, 128
  s_add_u32 s31, s31, 221184
  v_add_u32 v24, 0, v15
  v_add_u32 v22, 0, v16
  v_add_u32 v23, 0, v17
  v_xor_b32 v20, 0, v24
  ds_read_b128 v[58:61], v20 offset:0
  ds_read_b128 v[62:65], v20 offset:4096
  ds_read_b64_tr_b16 v[74:75], v22 offset:0
  ds_read_b64_tr_b16 v[76:77], v23 offset:0
  ds_read_b64_tr_b16 v[78:79], v22 offset:8192
  ds_read_b64_tr_b16 v[80:81], v23 offset:8192
  v_xor_b32 v21, 32, v24
  ds_read_b128 v[66:69], v21 offset:0
  ds_read_b128 v[70:73], v21 offset:4096
  ds_read_b64_tr_b16 v[82:83], v22 offset:2048
  ds_read_b64_tr_b16 v[84:85], v23 offset:2048
  ds_read_b64_tr_b16 v[86:87], v22 offset:10240
  ds_read_b64_tr_b16 v[88:89], v23 offset:10240
  s_waitcnt lgkmcnt(6)
  v_mfma_f32_32x32x16_bf16 v[90:105], v[74:77], v[58:61], v[90:105]
  v_mfma_f32_32x32x16_bf16 v[106:121], v[74:77], v[62:65], v[106:121]
  v_dot2_f32_bf16 v18, v74, v194, v18
  v_dot2_f32_bf16 v18, v75, v194, v18
  v_dot2_f32_bf16 v18, v76, v194, v18
  v_dot2_f32_bf16 v18, v77, v194, v18
  v_mfma_f32_32x32x16_bf16 v[122:137], v[78:81], v[58:61], v[122:137]
  v_mfma_f32_32x32x16_bf16 v[138:153], v[78:81], v[62:65], v[138:153]
  v_dot2_f32_bf16 v19, v78, v194, v19
  v_dot2_f32_bf16 v19, v79, v194, v19
  v_dot2_f32_bf16 v19, v80, v194, v19
  v_dot2_f32_bf16 v19, v81, v194, v19
  v_xor_b32 v20, 64, v24
  ds_read_b128 v[58:61], v20 offset:0
  ds_read_b128 v[62:65], v20 offset:4096
  ds_read_b64_tr_b16 v[74:75], v22 offset:4096
  ds_read_b64_tr_b16 v[76:77], v23 offset:4096
  ds_read_b64_tr_b16 v[78:79], v22 offset:12288
  ds_read_b64_tr_b16 v[80:81], v23 offset:12288
  s_waitcnt lgkmcnt(6)
  v_mfma_f32_32x32x16_bf16 v[90:105], v[82:85], v[66:69], v[90:105]
  v_mfma_f32_32x32x16_bf16 v[106:121], v[82:85], v[70:73], v[106:121]
  v_dot2_f32_bf16 v18, v82, v194, v18
  v_dot2_f32_bf16 v18, v83, v194, v18
  v_dot2_f32_bf16 v18, v84, v194, v18
  v_dot2_f32_bf16 v18, v85, v194, v18
  v_mfma_f32_32x32x16_bf16 v[122:137], v[86:89], v[66:69], v[122:137]
  v_mfma_f32_32x32x16_bf16 v[138:153], v[86:89], v[70:73], v[138:153]
  v_dot2_f32_bf16 v19, v86, v194, v19
  v_dot2_f32_bf16 v19, v87, v194, v19
  v_dot2_f32_bf16 v19, v88, v194, v19
  v_dot2_f32_bf16 v19, v89, v194, v19
  v_xor_b32 v21, 96, v24
  ds_read_b128 v[66:69], v21 offset:0
  ds_read_b128 v[70:73], v21 offset:4096
  ds_read_b64_tr_b16 v[82:83], v22 offset:6144
  ds_read_b64_tr_b16 v[84:85], v23 offset:6144
  ds_read_b64_tr_b16 v[86:87], v22 offset:14336
  ds_read_b64_tr_b16 v[88:89], v23 offset:14336
  s_waitcnt lgkmcnt(6)
  v_mfma_f32_32x32x16_bf16 v[90:105], v[74:77], v[58:61], v[90:105]
  v_mfma_f32_32x32x16_bf16 v[106:121], v[74:77], v[62:65], v[106:121]
  v_dot2_f32_bf16 v18, v74, v194, v18
  v_dot2_f32_bf16 v18, v75, v194, v18
  v_dot2_f32_bf16 v18, v76, v194, v18
  v_dot2_f32_bf16 v18, v77, v194, v18
  v_mfma_f32_32x32x16_bf16 v[122:137], v[78:81], v[58:61], v[122:137]
  v_mfma_f32_32x32x16_bf16 v[138:153], v[78:81], v[62:65], v[138:153]
  v_dot2_f32_bf16 v19, v78, v194, v19
  v_dot2_f32_bf16 v19, v79, v194, v19
  v_dot2_f32_bf16 v19, v80, v194, v19
  v_dot2_f32_bf16 v19, v81, v194, v19
  s_waitcnt lgkmcnt(0)
  v_mfma_f32_32x32x16_bf16 v[90:105], v[82:85], v[66:69], v[90:105]
  v_mfma_f32_32x32x16_bf16 v[106:121], v[82:85], v[70:73], v[106:121]
  v_dot2_f32_bf16 v18, v82, v194, v18
  v_dot2_f32_bf16 v18, v83, v194, v18
  v_dot2_f32_bf16 v18, v84, v194, v18
  v_dot2_f32_bf16 v18, v85, v194, v18
  v_mfma_f32_32x32x16_bf16 v[122:137], v[86:89], v[66:69], v[122:137]
  v_mfma_f32_32x32x16_bf16 v[138:153], v[86:89], v[70:73], v[138:153]
  v_dot2_f32_bf16 v19, v86, v194, v19
  v_dot2_f32_bf16 v19, v87, v194, v19
  v_dot2_f32_bf16 v19, v88, v194, v19
  v_dot2_f32_bf16 v19, v89, v194, v19
  s_waitcnt vmcnt(6)
  s_barrier
  s_lshl_b32 s27, s24, 12
  s_add_u32 m0, s27, 0
  s_nop 0
  buffer_load_dwordx4 v10, s[4:7], s30 offen lds
  s_lshl_b32 s27, s24, 12
  s_add_u32 m0, s27, 1024
  s_nop 0
  buffer_load_dwordx4 v11, s[4:7], s30 offen lds
  s_lshl_b32 s27, s24, 12
  s_add_u32 m0, s27, 2048
  s_nop 0
  buffer_load_dwordx4 v12, s[4:7], s30 offen lds
  s_lshl_b32 s27, s24, 12
  s_add_u32 m0, s27, 3072
  s_nop 0
  buffer_load_dwordx4 v13, s[4:7], s30 offen lds
  s_lshl_b32 s27, s24, 10
  s_add_u32 m0, s27, 32768
  s_nop 0
  buffer_load_dwordx4 v14, s[8:11], s31 offen lds
  s_lshl_b32 s27, s24, 10
  s_add_u32 m0, s27, 40960
  s_nop 0
  buffer_load_dwordx4 v14, s[12:15], s31 offen lds
  s_add_u32 s30, s30, 128
  s_add_u32 s31, s31, 221184
  v_add_u32 v24, 49152, v15
  v_add_u32 v22, 49152, v16
  v_add_u32 v23, 49152, v17
  v_xor_b32 v20, 0, v24
  ds_read_b128 v[58:61], v20 offset:0
  ds_read_b128 v[62:65], v20 offset:4096
  ds_read_b64_tr_b16 v[74:75], v22 offset:0
  ds_read_b64_tr_b16 v[76:77], v23 offset:0
  ds_read_b64_tr_b16 v[78:79], v22 offset:8192
  ds_read_b64_tr_b16 v[80:81], v23 offset:8192
  v_xor_b32 v21, 32, v24
  ds_read_b128 v[66:69], v21 offset:0
  ds_read_b128 v[70:73], v21 offset:4096
  ds_read_b64_tr_b16 v[82:83], v22 offset:2048
  ds_read_b64_tr_b16 v[84:85], v23 offset:2048
  ds_read_b64_tr_b16 v[86:87], v22 offset:10240
  ds_read_b64_tr_b16 v[88:89], v23 offset:10240
  s_waitcnt lgkmcnt(6)
  v_mfma_f32_32x32x16_bf16 v[90:105], v[74:77], v[58:61], v[90:105]
  v_mfma_f32_32x32x16_bf16 v[106:121], v[74:77], v[62:65], v[106:121]
  v_dot2_f32_bf16 v18, v74, v194, v18
  v_dot2_f32_bf16 v18, v75, v194, v18
  v_dot2_f32_bf16 v18, v76, v194, v18
  v_dot2_f32_bf16 v18, v77, v194, v18
  v_mfma_f32_32x32x16_bf16 v[122:137], v[78:81], v[58:61], v[122:137]
  v_mfma_f32_32x32x16_bf16 v[138:153], v[78:81], v[62:65], v[138:153]
  v_dot2_f32_bf16 v19, v78, v194, v19
  v_dot2_f32_bf16 v19, v79, v194, v19
  v_dot2_f32_bf16 v19, v80, v194, v19
  v_dot2_f32_bf16 v19, v81, v194, v19
  v_xor_b32 v20, 64, v24
  ds_read_b128 v[58:61], v20 offset:0
  ds_read_b128 v[62:65], v20 offset:4096
  ds_read_b64_tr_b16 v[74:75], v22 offset:4096
  ds_read_b64_tr_b16 v[76:77], v23 offset:4096
  ds_read_b64_tr_b16 v[78:79], v22 offset:12288
  ds_read_b64_tr_b16 v[80:81], v23 offset:12288
  s_waitcnt lgkmcnt(6)
  v_mfma_f32_32x32x16_bf16 v[90:105], v[82:85], v[66:69], v[90:105]
  v_mfma_f32_32x32x16_bf16 v[106:121], v[82:85], v[70:73], v[106:121]
  v_dot2_f32_bf16 v18, v82, v194, v18
  v_dot2_f32_bf16 v18, v83, v194, v18
  v_dot2_f32_bf16 v18, v84, v194, v18
  v_dot2_f32_bf16 v18, v85, v194, v18
  v_mfma_f32_32x32x16_bf16 v[122:137], v[86:89], v[66:69], v[122:137]
  v_mfma_f32_32x32x16_bf16 v[138:153], v[86:89], v[70:73], v[138:153]
  v_dot2_f32_bf16 v19, v86, v194, v19
  v_dot2_f32_bf16 v19, v87, v194, v19
  v_dot2_f32_bf16 v19, v88, v194, v19
  v_dot2_f32_bf16 v19, v89, v194, v19
  v_xor_b32 v21, 96, v24
  ds_read_b128 v[66:69], v21 offset:0
  ds_read_b128 v[70:73], v21 offset:4096
  ds_read_b64_tr_b16 v[82:83], v22 offset:6144
  ds_read_b64_tr_b16 v[84:85], v23 offset:6144
  ds_read_b64_tr_b16 v[86:87], v22 offset:14336
  ds_read_b64_tr_b16 v[88:89], v23 offset:14336
  s_waitcnt lgkmcnt(6)
  v_mfma_f32_32x32x16_bf16 v[90:105], v[74:77], v[58:61], v[90:105]
  v_mfma_f32_32x32x16_bf16 v[106:121], v[74:77], v[62:65], v[106:121]
  v_dot2_f32_bf16 v18, v74, v194, v18
  v_dot2_f32_bf16 v18, v75, v194, v18
  v_dot2_f32_bf16 v18, v76, v194, v18
  v_dot2_f32_bf16 v18, v77, v194, v18
  v_mfma_f32_32x32x16_bf16 v[122:137], v[78:81], v[58:61], v[122:137]
  v_mfma_f32_32x32x16_bf16 v[138:153], v[78:81], v[62:65], v[138:153]
  v_dot2_f32_bf16 v19, v78, v194, v19
  v_dot2_f32_bf16 v19, v79, v194, v19
  v_dot2_f32_bf16 v19, v80, v194, v19
  v_dot2_f32_bf16 v19, v81, v194, v19
  s_waitcnt lgkmcnt(0)
  v_mfma_f32_32x32x16_bf16 v[90:105], v[82:85], v[66:69], v[90:105]
  v_mfma_f32_32x32x16_bf16 v[106:121], v[82:85], v[70:73], v[106:121]
  v_dot2_f32_bf16 v18, v82, v194, v18
  v_dot2_f32_bf16 v18, v83, v194, v18
  v_dot2_f32_bf16 v18, v84, v194, v18
  v_dot2_f32_bf16 v18, v85, v194, v18
  v_mfma_f32_32x32x16_bf16 v[122:137], v[86:89], v[66:69], v[122:137]
  v_mfma_f32_32x32x16_bf16 v[138:153], v[86:89], v[70:73], v[138:153]
  v_dot2_f32_bf16 v19, v86, v194, v19
  v_dot2_f32_bf16 v19, v87, v194, v19
  v_dot2_f32_bf16 v19, v88, v194, v19
  v_dot2_f32_bf16 v19, v89, v194, v19
  s_waitcnt vmcnt(6)
  s_barrier
  s_lshl_b32 s27, s24, 12
  s_add_u32 m0, s27, 49152
  s_nop 0
  buffer_load_dwordx4 v10, s[4:7], s30 offen lds
  s_lshl_b32 s27, s24, 12
  s_add_u32 m0, s27, 50176
  s_nop 0
  buffer_load_dwordx4 v11, s[4:7], s30 offen lds
  s_lshl_b32 s27, s24, 12
  s_add_u32 m0, s27, 51200
  s_nop 0
  buffer_load_dwordx4 v12, s[4:7], s30 offen lds
  s_lshl_b32 s27, s24, 12
  s_add_u32 m0, s27, 52224
  s_nop 0
  buffer_load_dwordx4 v13, s[4:7], s30 offen lds
  s_lshl_b32 s27, s24, 10
  s_add_u32 m0, s27, 81920
  s_nop 0
  buffer_load_dwordx4 v14, s[8:11], s31 offen lds
  s_lshl_b32 s27, s24, 10
  s_add_u32 m0, s27, 90112
  s_nop 0
  buffer_load_dwordx4 v14, s[12:15], s31 offen lds
  s_add_u32 s30, s30, 128
  s_add_u32 s31, s31, 221184
  v_add_u32 v24, 98304, v15
  v_add_u32 v22, 98304, v16
  v_add_u32 v23, 98304, v17
  v_xor_b32 v20, 0, v24
  ds_read_b128 v[58:61], v20 offset:0
  ds_read_b128 v[62:65], v20 offset:4096
  ds_read_b64_tr_b16 v[74:75], v22 offset:0
  ds_read_b64_tr_b16 v[76:77], v23 offset:0
  ds_read_b64_tr_b16 v[78:79], v22 offset:8192
  ds_read_b64_tr_b16 v[80:81], v23 offset:8192
  v_xor_b32 v21, 32, v24
  ds_read_b128 v[66:69], v21 offset:0
  ds_read_b128 v[70:73], v21 offset:4096
  ds_read_b64_tr_b16 v[82:83], v22 offset:2048
  ds_read_b64_tr_b16 v[84:85], v23 offset:2048
  ds_read_b64_tr_b16 v[86:87], v22 offset:10240
  ds_read_b64_tr_b16 v[88:89], v23 offset:10240
  s_waitcnt lgkmcnt(6)
  v_mfma_f32_32x32x16_bf16 v[90:105], v[74:77], v[58:61], v[90:105]
  v_mfma_f32_32x32x16_bf16 v[106:121], v[74:77], v[62:65], v[106:121]
  v_dot2_f32_bf16 v18, v74, v194, v18
  v_dot2_f32_bf16 v18, v75, v194, v18
  v_dot2_f32_bf16 v18, v76, v194, v18
  v_dot2_f32_bf16 v18, v77, v194, v18
  v_mfma_f32_32x32x16_bf16 v[122:137], v[78:81], v[58:61], v[122:137]
  v_mfma_f32_32x32x16_bf16 v[138:153], v[78:81], v[62:65], v[138:153]
  v_dot2_f32_bf16 v19, v78, v194, v19
  v_dot2_f32_bf16 v19, v79, v194, v19
  v_dot2_f32_bf16 v19, v80, v194, v19
  v_dot2_f32_bf16 v19, v81, v194, v19
  v_xor_b32 v20, 64, v24
  ds_read_b128 v[58:61], v20 offset:0
  ds_read_b128 v[62:65], v20 offset:4096
  ds_read_b64_tr_b16 v[74:75], v22 offset:4096
  ds_read_b64_tr_b16 v[76:77], v23 offset:4096
  ds_read_b64_tr_b16 v[78:79], v22 offset:12288
  ds_read_b64_tr_b16 v[80:81], v23 offset:12288
  s_waitcnt lgkmcnt(6)
  v_mfma_f32_32x32x16_bf16 v[90:105], v[82:85], v[66:69], v[90:105]
  v_mfma_f32_32x32x16_bf16 v[106:121], v[82:85], v[70:73], v[106:121]
  v_dot2_f32_bf16 v18, v82, v194, v18
  v_dot2_f32_bf16 v18, v83, v194, v18
  v_dot2_f32_bf16 v18, v84, v194, v18
  v_dot2_f32_bf16 v18, v85, v194, v18
  v_mfma_f32_32x32x16_bf16 v[122:137], v[86:89], v[66:69], v[122:137]
  v_mfma_f32_32x32x16_bf16 v[138:153], v[86:89], v[70:73], v[138:153]
  v_dot2_f32_bf16 v19, v86, v194, v19
  v_dot2_f32_bf16 v19, v87, v194, v19
  v_dot2_f32_bf16 v19, v88, v194, v19
  v_dot2_f32_bf16 v19, v89, v194, v19
  v_xor_b32 v21, 96, v24
  ds_read_b128 v[66:69], v21 offset:0
  ds_read_b128 v[70:73], v21 offset:4096
  ds_read_b64_tr_b16 v[82:83], v22 offset:6144
  ds_read_b64_tr_b16 v[84:85], v23 offset:6144
  ds_read_b64_tr_b16 v[86:87], v22 offset:14336
  ds_read_b64_tr_b16 v[88:89], v23 offset:14336
  s_waitcnt lgkmcnt(6)
  v_mfma_f32_32x32x16_bf16 v[90:105], v[74:77], v[58:61], v[90:105]
  v_mfma_f32_32x32x16_bf16 v[106:121], v[74:77], v[62:65], v[106:121]
  v_dot2_f32_bf16 v18, v74, v194, v18
  v_dot2_f32_bf16 v18, v75, v194, v18
  v_dot2_f32_bf16 v18, v76, v194, v18
  v_dot2_f32_bf16 v18, v77, v194, v18
  v_mfma_f32_32x32x16_bf16 v[122:137], v[78:81], v[58:61], v[122:137]
  v_mfma_f32_32x32x16_bf16 v[138:153], v[78:81], v[62:65], v[138:153]
  v_dot2_f32_bf16 v19, v78, v194, v19
  v_dot2_f32_bf16 v19, v79, v194, v19
  v_dot2_f32_bf16 v19, v80, v194, v19
  v_dot2_f32_bf16 v19, v81, v194, v19
  s_waitcnt lgkmcnt(0)
  v_mfma_f32_32x32x16_bf16 v[90:105], v[82:85], v[66:69], v[90:105]
  v_mfma_f32_32x32x16_bf16 v[106:121], v[82:85], v[70:73], v[106:121]
  v_dot2_f32_bf16 v18, v82, v194, v18
  v_dot2_f32_bf16 v18, v83, v194, v18
  v_dot2_f32_bf16 v18, v84, v194, v18
  v_dot2_f32_bf16 v18, v85, v194, v18
  v_mfma_f32_32x32x16_bf16 v[122:137], v[86:89], v[66:69], v[122:137]
  v_mfma_f32_32x32x16_bf16 v[138:153], v[86:89], v[70:73], v[138:153]
  v_dot2_f32_bf16 v19, v86, v194, v19
  v_dot2_f32_bf16 v19, v87, v194, v19
  v_dot2_f32_bf16 v19, v88, v194, v19
  v_dot2_f32_bf16 v19, v89, v194, v19
  s_waitcnt vmcnt(6)
  s_barrier
  s_lshl_b32 s27, s24, 12
  s_add_u32 m0, s27, 98304
  s_nop 0
  buffer_load_dwordx4 v10, s[4:7], s30 offen lds
  s_lshl_b32 s27, s24, 12
  s_add_u32 m0, s27, 99328
  s_nop 0
  buffer_load_dwordx4 v11, s[4:7], s30 offen lds
  s_lshl_b32 s27, s24, 12
  s_add_u32 m0, s27, 100352
  s_nop 0
  buffer_load_dwordx4 v12, s[4:7], s30 offen lds
  s_lshl_b32 s27, s24, 12
  s_add_u32 m0, s27, 101376
  s_nop 0
  buffer_load_dwordx4 v13, s[4:7], s30 offen lds
  s_lshl_b32 s27, s24, 10
  s_add_u32 m0, s27, 131072
  s_nop 0
  buffer_load_dwordx4 v14, s[8:11], s31 offen lds
  s_lshl_b32 s27, s24, 10
  s_add_u32 m0, s27, 139264
  s_nop 0
  buffer_load_dwordx4 v14, s[12:15], s31 offen lds
  s_add_u32 s30, s30, 128
  s_add_u32 s31, s31, 221184
  v_add_u32 v24, 0, v15
  v_add_u32 v22, 0, v16
  v_add_u32 v23, 0, v17
  v_xor_b32 v20, 0, v24
  ds_read_b128 v[58:61], v20 offset:0
  ds_read_b128 v[62:65], v20 offset:4096
  ds_read_b64_tr_b16 v[74:75], v22 offset:0
  ds_read_b64_tr_b16 v[76:77], v23 offset:0
  ds_read_b64_tr_b16 v[78:79], v22 offset:8192
  ds_read_b64_tr_b16 v[80:81], v23 offset:8192
  v_xor_b32 v21, 32, v24
  ds_read_b128 v[66:69], v21 offset:0
  ds_read_b128 v[70:73], v21 offset:4096
  ds_read_b64_tr_b16 v[82:83], v22 offset:2048
  ds_read_b64_tr_b16 v[84:85], v23 offset:2048
  ds_read_b64_tr_b16 v[86:87], v22 offset:10240
  ds_read_b64_tr_b16 v[88:89], v23 offset:10240
  s_waitcnt lgkmcnt(6)
  v_mfma_f32_32x32x16_bf16 v[90:105], v[74:77], v[58:61], v[90:105]
  v_mfma_f32_32x32x16_bf16 v[106:121], v[74:77], v[62:65], v[106:121]
  v_dot2_f32_bf16 v18, v74, v194, v18
  v_dot2_f32_bf16 v18, v75, v194, v18
  v_dot2_f32_bf16 v18, v76, v194, v18
  v_dot2_f32_bf16 v18, v77, v194, v18
  v_mfma_f32_32x32x16_bf16 v[122:137], v[78:81], v[58:61], v[122:137]
  v_mfma_f32_32x32x16_bf16 v[138:153], v[78:81], v[62:65], v[138:153]
  v_dot2_f32_bf16 v19, v78, v194, v19
  v_dot2_f32_bf16 v19, v79, v194, v19
  v_dot2_f32_bf16 v19, v80, v194, v19
  v_dot2_f32_bf16 v19, v81, v194, v19
  v_xor_b32 v20, 64, v24
  ds_read_b128 v[58:61], v20 offset:0
  ds_read_b128 v[62:65], v20 offset:4096
  ds_read_b64_tr_b16 v[74:75], v22 offset:4096
  ds_read_b64_tr_b16 v[76:77], v23 offset:4096
  ds_read_b64_tr_b16 v[78:79], v22 offset:12288
  ds_read_b64_tr_b16 v[80:81], v23 offset:12288
  s_waitcnt lgkmcnt(6)
  v_mfma_f32_32x32x16_bf16 v[90:105], v[82:85], v[66:69], v[90:105]
  v_mfma_f32_32x32x16_bf16 v[106:121], v[82:85], v[70:73], v[106:121]
  v_dot2_f32_bf16 v18, v82, v194, v18
  v_dot2_f32_bf16 v18, v83, v194, v18
  v_dot2_f32_bf16 v18, v84, v194, v18
  v_dot2_f32_bf16 v18, v85, v194, v18
  v_mfma_f32_32x32x16_bf16 v[122:137], v[86:89], v[66:69], v[122:137]
  v_mfma_f32_32x32x16_bf16 v[138:153], v[86:89], v[70:73], v[138:153]
  v_dot2_f32_bf16 v19, v86, v194, v19
  v_dot2_f32_bf16 v19, v87, v194, v19
  v_dot2_f32_bf16 v19, v88, v194, v19
  v_dot2_f32_bf16 v19, v89, v194, v19
  v_xor_b32 v21, 96, v24
  ds_read_b128 v[66:69], v21 offset:0
  ds_read_b128 v[70:73], v21 offset:4096
  ds_read_b64_tr_b16 v[82:83], v22 offset:6144
  ds_read_b64_tr_b16 v[84:85], v23 offset:6144
  ds_read_b64_tr_b16 v[86:87], v22 offset:14336
  ds_read_b64_tr_b16 v[88:89], v23 offset:14336
  s_waitcnt lgkmcnt(6)
  v_mfma_f32_32x32x16_bf16 v[90:105], v[74:77], v[58:61], v[90:105]
  v_mfma_f32_32x32x16_bf16 v[106:121], v[74:77], v[62:65], v[106:121]
  v_dot2_f32_bf16 v18, v74, v194, v18
  v_dot2_f32_bf16 v18, v75, v194, v18
  v_dot2_f32_bf16 v18, v76, v194, v18
  v_dot2_f32_bf16 v18, v77, v194, v18
  v_mfma_f32_32x32x16_bf16 v[122:137], v[78:81], v[58:61], v[122:137]
  v_mfma_f32_32x32x16_bf16 v[138:153], v[78:81], v[62:65], v[138:153]
  v_dot2_f32_bf16 v19, v78, v194, v19
  v_dot2_f32_bf16 v19, v79, v194, v19
  v_dot2_f32_bf16 v19, v80, v194, v19
  v_dot2_f32_bf16 v19, v81, v194, v19
  s_waitcnt lgkmcnt(0)
  v_mfma_f32_32x32x16_bf16 v[90:105], v[82:85], v[66:69], v[90:105]
  v_mfma_f32_32x32x16_bf16 v[106:121], v[82:85], v[70:73], v[106:121]
  v_dot2_f32_bf16 v18, v82, v194, v18
  v_dot2_f32_bf16 v18, v83, v194, v18
  v_dot2_f32_bf16 v18, v84, v194, v18
  v_dot2_f32_bf16 v18, v85, v194, v18
  v_mfma_f32_32x32x16_bf16 v[122:137], v[86:89], v[66:69], v[122:137]
  v_mfma_f32_32x32x16_bf16 v[138:153], v[86:89], v[70:73], v[138:153]
  v_dot2_f32_bf16 v19, v86, v194, v19
  v_dot2_f32_bf16 v19, v87, v194, v19
  v_dot2_f32_bf16 v19, v88, v194, v19
  v_dot2_f32_bf16 v19, v89, v194, v19
  s_waitcnt vmcnt(6)
  s_barrier
  s_lshl_b32 s27, s24, 12
  s_add_u32 m0, s27, 0
  s_nop 0
  buffer_load_dwordx4 v10, s[4:7], s30 offen lds
  s_lshl_b32 s27, s24, 12
  s_add_u32 m0, s27, 1024
  s_nop 0
  buffer_load_dwordx4 v11, s[4:7], s30 offen lds
  s_lshl_b32 s27, s24, 12
  s_add_u32 m0, s27, 2048
  s_nop 0
  buffer_load_dwordx4 v12, s[4:7], s30 offen lds
  s_lshl_b32 s27, s24, 12
  s_add_u32 m0, s27, 3072
  s_nop 0
  buffer_load_dwordx4 v13, s[4:7], s30 offen lds
  s_lshl_b32 s27, s24, 10
  s_add_u32 m0, s27, 32768
  s_nop 0
  buffer_load_dwordx4 v14, s[8:11], s31 offen lds
  s_lshl_b32 s27, s24, 10
  s_add_u32 m0, s27, 40960
  s_nop 0
  buffer_load_dwordx4 v14, s[12:15], s31 offen lds
  s_add_u32 s30, s30, 128
  s_add_u32 s31, s31, 221184
  v_add_u32 v24, 49152, v15
  v_add_u32 v22, 49152, v16
  v_add_u32 v23, 49152, v17
  v_xor_b32 v20, 0, v24
  ds_read_b128 v[58:61], v20 offset:0
  ds_read_b128 v[62:65], v20 offset:4096
  ds_read_b64_tr_b16 v[74:75], v22 offset:0
  ds_read_b64_tr_b16 v[76:77], v23 offset:0
  ds_read_b64_tr_b16 v[78:79], v22 offset:8192
  ds_read_b64_tr_b16 v[80:81], v23 offset:8192
  v_xor_b32 v21, 32, v24
  ds_read_b128 v[66:69], v21 offset:0
  ds_read_b128 v[70:73], v21 offset:4096
  ds_read_b64_tr_b16 v[82:83], v22 offset:2048
  ds_read_b64_tr_b16 v[84:85], v23 offset:2048
  ds_read_b64_tr_b16 v[86:87], v22 offset:10240
  ds_read_b64_tr_b16 v[88:89], v23 offset:10240
  s_waitcnt lgkmcnt(6)
  v_mfma_f32_32x32x16_bf16 v[90:105], v[74:77], v[58:61], v[90:105]
  v_mfma_f32_32x32x16_bf16 v[106:121], v[74:77], v[62:65], v[106:121]
  v_dot2_f32_bf16 v18, v74, v194, v18
  v_dot2_f32_bf16 v18, v75, v194, v18
  v_dot2_f32_bf16 v18, v76, v194, v18
  v_dot2_f32_bf16 v18, v77, v194, v18
  v_mfma_f32_32x32x16_bf16 v[122:137], v[78:81], v[58:61], v[122:137]
  v_mfma_f32_32x32x16_bf16 v[138:153], v[78:81], v[62:65], v[138:153]
  v_dot2_f32_bf16 v19, v78, v194, v19
  v_dot2_f32_bf16 v19, v79, v194, v19
  v_dot2_f32_bf16 v19, v80, v194, v19
  v_dot2_f32_bf16 v19, v81, v194, v19
  v_xor_b32 v20, 64, v24
  ds_read_b128 v[58:61], v20 offset:0
  ds_read_b128 v[62:65], v20 offset:4096
  ds_read_b64_tr_b16 v[74:75], v22 offset:4096
  ds_read_b64_tr_b16 v[76:77], v23 offset:4096
  ds_read_b64_tr_b16 v[78:79], v22 offset:12288
  ds_read_b64_tr_b16 v[80:81], v23 offset:12288
  s_waitcnt lgkmcnt(6)
  v_mfma_f32_32x32x16_bf16 v[90:105], v[82:85], v[66:69], v[90:105]
  v_mfma_f32_32x32x16_bf16 v[106:121], v[82:85], v[70:73], v[106:121]
  v_dot2_f32_bf16 v18, v82, v194, v18
  v_dot2_f32_bf16 v18, v83, v194, v18
  v_dot2_f32_bf16 v18, v84, v194, v18
  v_dot2_f32_bf16 v18, v85, v194, v18
  v_mfma_f32_32x32x16_bf16 v[122:137], v[86:89], v[66:69], v[122:137]
  v_mfma_f32_32x32x16_bf16 v[138:153], v[86:89], v[70:73], v[138:153]
  v_dot2_f32_bf16 v19, v86, v194, v19
  v_dot2_f32_bf16 v19, v87, v194, v19
  v_dot2_f32_bf16 v19, v88, v194, v19
  v_dot2_f32_bf16 v19, v89, v194, v19
  v_xor_b32 v21, 96, v24
  ds_read_b128 v[66:69], v21 offset:0
  ds_read_b128 v[70:73], v21 offset:4096
  ds_read_b64_tr_b16 v[82:83], v22 offset:6144
  ds_read_b64_tr_b16 v[84:85], v23 offset:6144
  ds_read_b64_tr_b16 v[86:87], v22 offset:14336
  ds_read_b64_tr_b16 v[88:89], v23 offset:14336
  s_waitcnt lgkmcnt(6)
  v_mfma_f32_32x32x16_bf16 v[90:105], v[74:77], v[58:61], v[90:105]
  v_mfma_f32_32x32x16_bf16 v[106:121], v[74:77], v[62:65], v[106:121]
  v_dot2_f32_bf16 v18, v74, v194, v18
  v_dot2_f32_bf16 v18, v75, v194, v18
  v_dot2_f32_bf16 v18, v76, v194, v18
  v_dot2_f32_bf16 v18, v77, v194, v18
  v_mfma_f32_32x32x16_bf16 v[122:137], v[78:81], v[58:61], v[122:137]
  v_mfma_f32_32x32x16_bf16 v[138:153], v[78:81], v[62:65], v[138:153]
  v_dot2_f32_bf16 v19, v78, v194, v19
  v_dot2_f32_bf16 v19, v79, v194, v19
  v_dot2_f32_bf16 v19, v80, v194, v19
  v_dot2_f32_bf16 v19, v81, v194, v19
  s_waitcnt lgkmcnt(0)
  v_mfma_f32_32x32x16_bf16 v[90:105], v[82:85], v[66:69], v[90:105]
  v_mfma_f32_32x32x16_bf16 v[106:121], v[82:85], v[70:73], v[106:121]
  v_dot2_f32_bf16 v18, v82, v194, v18
  v_dot2_f32_bf16 v18, v83, v194, v18
  v_dot2_f32_bf16 v18, v84, v194, v18
  v_dot2_f32_bf16 v18, v85, v194, v18
  v_mfma_f32_32x32x16_bf16 v[122:137], v[86:89], v[66:69], v[122:137]
  v_mfma_f32_32x32x16_bf16 v[138:153], v[86:89], v[70:73], v[138:153]
  v_dot2_f32_bf16 v19, v86, v194, v19
  v_dot2_f32_bf16 v19, v87, v194, v19
  v_dot2_f32_bf16 v19, v88, v194, v19
  v_dot2_f32_bf16 v19, v89, v194, v19
  s_waitcnt vmcnt(6)
  s_barrier
  s_lshl_b32 s27, s24, 12
  s_add_u32 m0, s27, 49152
  s_nop 0
  buffer_load_dwordx4 v10, s[4:7], s30 offen lds
  s_lshl_b32 s27, s24, 12
  s_add_u32 m0, s27, 50176
  s_nop 0
  buffer_load_dwordx4 v11, s[4:7], s30 offen lds
  s_lshl_b32 s27, s24, 12
  s_add_u32 m0, s27, 51200
  s_nop 0
  buffer_load_dwordx4 v12, s[4:7], s30 offen lds
  s_lshl_b32 s27, s24, 12
  s_add_u32 m0, s27, 52224
  s_nop 0
  buffer_load_dwordx4 v13, s[4:7], s30 offen lds
  s_lshl_b32 s27, s24, 10
  s_add_u32 m0, s27, 81920
  s_nop 0
  buffer_load_dwordx4 v14, s[8:11], s31 offen lds
  s_lshl_b32 s27, s24, 10
  s_add_u32 m0, s27, 90112
  s_nop 0
  buffer_load_dwordx4 v14, s[12:15], s31 offen lds
  s_add_u32 s30, s30, 128
  s_add_u32 s31, s31, 221184
  v_add_u32 v24, 98304, v15
  v_add_u32 v22, 98304, v16
  v_add_u32 v23, 98304, v17
  v_xor_b32 v20, 0, v24
  ds_read_b128 v[58:61], v20 offset:0
  ds_read_b128 v[62:65], v20 offset:4096
  ds_read_b64_tr_b16 v[74:75], v22 offset:0
  ds_read_b64_tr_b16 v[76:77], v23 offset:0
  ds_read_b64_tr_b16 v[78:79], v22 offset:8192
  ds_read_b64_tr_b16 v[80:81], v23 offset:8192
  v_xor_b32 v21, 32, v24
  ds_read_b128 v[66:69], v21 offset:0
  ds_read_b128 v[70:73], v21 offset:4096
  ds_read_b64_tr_b16 v[82:83], v22 offset:2048
  ds_read_b64_tr_b16 v[84:85], v23 offset:2048
  ds_read_b64_tr_b16 v[86:87], v22 offset:10240
  ds_read_b64_tr_b16 v[88:89], v23 offset:10240
  s_waitcnt lgkmcnt(6)
  v_mfma_f32_32x32x16_bf16 v[90:105], v[74:77], v[58:61], v[90:105]
  v_mfma_f32_32x32x16_bf16 v[106:121], v[74:77], v[62:65], v[106:121]
  v_dot2_f32_bf16 v18, v74, v194, v18
  v_dot2_f32_bf16 v18, v75, v194, v18
  v_dot2_f32_bf16 v18, v76, v194, v18
  v_dot2_f32_bf16 v18, v77, v194, v18
  v_mfma_f32_32x32x16_bf16 v[122:137], v[78:81], v[58:61], v[122:137]
  v_mfma_f32_32x32x16_bf16 v[138:153], v[78:81], v[62:65], v[138:153]
  v_dot2_f32_bf16 v19, v78, v194, v19
  v_dot2_f32_bf16 v19, v79, v194, v19
  v_dot2_f32_bf16 v19, v80, v194, v19
  v_dot2_f32_bf16 v19, v81, v194, v19
  v_xor_b32 v20, 64, v24
  ds_read_b128 v[58:61], v20 offset:0
  ds_read_b128 v[62:65], v20 offset:4096
  ds_read_b64_tr_b16 v[74:75], v22 offset:4096
  ds_read_b64_tr_b16 v[76:77], v23 offset:4096
  ds_read_b64_tr_b16 v[78:79], v22 offset:12288
  ds_read_b64_tr_b16 v[80:81], v23 offset:12288
  s_waitcnt lgkmcnt(6)
  v_mfma_f32_32x32x16_bf16 v[90:105], v[82:85], v[66:69], v[90:105]
  v_mfma_f32_32x32x16_bf16 v[106:121], v[82:85], v[70:73], v[106:121]
  v_dot2_f32_bf16 v18, v82, v194, v18
  v_dot2_f32_bf16 v18, v83, v194, v18
  v_dot2_f32_bf16 v18, v84, v194, v18
  v_dot2_f32_bf16 v18, v85, v194, v18
  v_mfma_f32_32x32x16_bf16 v[122:137], v[86:89], v[66:69], v[122:137]
  v_mfma_f32_32x32x16_bf16 v[138:153], v[86:89], v[70:73], v[138:153]
  v_dot2_f32_bf16 v19, v86, v194, v19
  v_dot2_f32_bf16 v19, v87, v194, v19
  v_dot2_f32_bf16 v19, v88, v194, v19
  v_dot2_f32_bf16 v19, v89, v194, v19
  v_xor_b32 v21, 96, v24
  ds_read_b128 v[66:69], v21 offset:0
  ds_read_b128 v[70:73], v21 offset:4096
  ds_read_b64_tr_b16 v[82:83], v22 offset:6144
  ds_read_b64_tr_b16 v[84:85], v23 offset:6144
  ds_read_b64_tr_b16 v[86:87], v22 offset:14336
  ds_read_b64_tr_b16 v[88:89], v23 offset:14336
  s_waitcnt lgkmcnt(6)
  v_mfma_f32_32x32x16_bf16 v[90:105], v[74:77], v[58:61], v[90:105]
  v_mfma_f32_32x32x16_bf16 v[106:121], v[74:77], v[62:65], v[106:121]
  v_dot2_f32_bf16 v18, v74, v194, v18
  v_dot2_f32_bf16 v18, v75, v194, v18
  v_dot2_f32_bf16 v18, v76, v194, v18
  v_dot2_f32_bf16 v18, v77, v194, v18
  v_mfma_f32_32x32x16_bf16 v[122:137], v[78:81], v[58:61], v[122:137]
  v_mfma_f32_32x32x16_bf16 v[138:153], v[78:81], v[62:65], v[138:153]
  v_dot2_f32_bf16 v19, v78, v194, v19
  v_dot2_f32_bf16 v19, v79, v194, v19
  v_dot2_f32_bf16 v19, v80, v194, v19
  v_dot2_f32_bf16 v19, v81, v194, v19
  s_waitcnt lgkmcnt(0)
  v_mfma_f32_32x32x16_bf16 v[90:105], v[82:85], v[66:69], v[90:105]
  v_mfma_f32_32x32x16_bf16 v[106:121], v[82:85], v[70:73], v[106:121]
  v_dot2_f32_bf16 v18, v82, v194, v18
  v_dot2_f32_bf16 v18, v83, v194, v18
  v_dot2_f32_bf16 v18, v84, v194, v18
  v_dot2_f32_bf16 v18, v85, v194, v18
  v_mfma_f32_32x32x16_bf16 v[122:137], v[86:89], v[66:69], v[122:137]
  v_mfma_f32_32x32x16_bf16 v[138:153], v[86:89], v[70:73], v[138:153]
  v_dot2_f32_bf16 v19, v86, v194, v19
  v_dot2_f32_bf16 v19, v87, v194, v19
  v_dot2_f32_bf16 v19, v88, v194, v19
  v_dot2_f32_bf16 v19, v89, v194, v19
  s_waitcnt vmcnt(6)
  s_barrier
  s_lshl_b32 s27, s24, 12
  s_add_u32 m0, s27, 98304
  s_nop 0
  buffer_load_dwordx4 v10, s[4:7], s30 offen lds
  s_lshl_b32 s27, s24, 12
  s_add_u32 m0, s27, 99328
  s_nop 0
  buffer_load_dwordx4 v11, s[4:7], s30 offen lds
  s_lshl_b32 s27, s24, 12
  s_add_u32 m0, s27, 100352
  s_nop 0
  buffer_load_dwordx4 v12, s[4:7], s30 offen lds
  s_lshl_b32 s27, s24, 12
  s_add_u32 m0, s27, 101376
  s_nop 0
  buffer_load_dwordx4 v13, s[4:7], s30 offen lds
  s_lshl_b32 s27, s24, 10
  s_add_u32 m0, s27, 131072
  s_nop 0
  buffer_load_dwordx4 v14, s[8:11], s31 offen lds
  s_lshl_b32 s27, s24, 10
  s_add_u32 m0, s27, 139264
  s_nop 0
  buffer_load_dwordx4 v14, s[12:15], s31 offen lds
  s_add_u32 s30, s30, 128
  s_add_u32 s31, s31, 221184
  v_add_u32 v24, 0, v15
  v_add_u32 v22, 0, v16
  v_add_u32 v23, 0, v17
  v_xor_b32 v20, 0, v24
  ds_read_b128 v[58:61], v20 offset:0
  ds_read_b128 v[62:65], v20 offset:4096
  ds_read_b64_tr_b16 v[74:75], v22 offset:0
  ds_read_b64_tr_b16 v[76:77], v23 offset:0
  ds_read_b64_tr_b16 v[78:79], v22 offset:8192
  ds_read_b64_tr_b16 v[80:81], v23 offset:8192
  v_xor_b32 v21, 32, v24
  ds_read_b128 v[66:69], v21 offset:0
  ds_read_b128 v[70:73], v21 offset:4096
  ds_read_b64_tr_b16 v[82:83], v22 offset:2048
  ds_read_b64_tr_b16 v[84:85], v23 offset:2048
  ds_read_b64_tr_b16 v[86:87], v22 offset:10240
  ds_read_b64_tr_b16 v[88:89], v23 offset:10240
  s_waitcnt lgkmcnt(6)
  v_mfma_f32_32x32x16_bf16 v[90:105], v[74:77], v[58:61], v[90:105]
  v_mfma_f32_32x32x16_bf16 v[106:121], v[74:77], v[62:65], v[106:121]
  v_dot2_f32_bf16 v18, v74, v194, v18
  v_dot2_f32_bf16 v18, v75, v194, v18
  v_dot2_f32_bf16 v18, v76, v194, v18
  v_dot2_f32_bf16 v18, v77, v194, v18
  v_mfma_f32_32x32x16_bf16 v[122:137], v[78:81], v[58:61], v[122:137]
  v_mfma_f32_32x32x16_bf16 v[138:153], v[78:81], v[62:65], v[138:153]
  v_dot2_f32_bf16 v19, v78, v194, v19
  v_dot2_f32_bf16 v19, v79, v194, v19
  v_dot2_f32_bf16 v19, v80, v194, v19
  v_dot2_f32_bf16 v19, v81, v194, v19
  v_xor_b32 v20, 64, v24
  ds_read_b128 v[58:61], v20 offset:0
  ds_read_b128 v[62:65], v20 offset:4096
  ds_read_b64_tr_b16 v[74:75], v22 offset:4096
  ds_read_b64_tr_b16 v[76:77], v23 offset:4096
  ds_read_b64_tr_b16 v[78:79], v22 offset:12288
  ds_read_b64_tr_b16 v[80:81], v23 offset:12288
  s_waitcnt lgkmcnt(6)
  v_mfma_f32_32x32x16_bf16 v[90:105], v[82:85], v[66:69], v[90:105]
  v_mfma_f32_32x32x16_bf16 v[106:121], v[82:85], v[70:73], v[106:121]
  v_dot2_f32_bf16 v18, v82, v194, v18
  v_dot2_f32_bf16 v18, v83, v194, v18
  v_dot2_f32_bf16 v18, v84, v194, v18
  v_dot2_f32_bf16 v18, v85, v194, v18
  v_mfma_f32_32x32x16_bf16 v[122:137], v[86:89], v[66:69], v[122:137]
  v_mfma_f32_32x32x16_bf16 v[138:153], v[86:89], v[70:73], v[138:153]
  v_dot2_f32_bf16 v19, v86, v194, v19
  v_dot2_f32_bf16 v19, v87, v194, v19
  v_dot2_f32_bf16 v19, v88, v194, v19
  v_dot2_f32_bf16 v19, v89, v194, v19
  v_xor_b32 v21, 96, v24
  ds_read_b128 v[66:69], v21 offset:0
  ds_read_b128 v[70:73], v21 offset:4096
  ds_read_b64_tr_b16 v[82:83], v22 offset:6144
  ds_read_b64_tr_b16 v[84:85], v23 offset:6144
  ds_read_b64_tr_b16 v[86:87], v22 offset:14336
  ds_read_b64_tr_b16 v[88:89], v23 offset:14336
  s_waitcnt lgkmcnt(6)
  v_mfma_f32_32x32x16_bf16 v[90:105], v[74:77], v[58:61], v[90:105]
  v_mfma_f32_32x32x16_bf16 v[106:121], v[74:77], v[62:65], v[106:121]
  v_dot2_f32_bf16 v18, v74, v194, v18
  v_dot2_f32_bf16 v18, v75, v194, v18
  v_dot2_f32_bf16 v18, v76, v194, v18
  v_dot2_f32_bf16 v18, v77, v194, v18
  v_mfma_f32_32x32x16_bf16 v[122:137], v[78:81], v[58:61], v[122:137]
  v_mfma_f32_32x32x16_bf16 v[138:153], v[78:81], v[62:65], v[138:153]
  v_dot2_f32_bf16 v19, v78, v194, v19
  v_dot2_f32_bf16 v19, v79, v194, v19
  v_dot2_f32_bf16 v19, v80, v194, v19
  v_dot2_f32_bf16 v19, v81, v194, v19
  s_waitcnt lgkmcnt(0)
  v_mfma_f32_32x32x16_bf16 v[90:105], v[82:85], v[66:69], v[90:105]
  v_mfma_f32_32x32x16_bf16 v[106:121], v[82:85], v[70:73], v[106:121]
  v_dot2_f32_bf16 v18, v82, v194, v18
  v_dot2_f32_bf16 v18, v83, v194, v18
  v_dot2_f32_bf16 v18, v84, v194, v18
  v_dot2_f32_bf16 v18, v85, v194, v18
  v_mfma_f32_32x32x16_bf16 v[122:137], v[86:89], v[66:69], v[122:137]
  v_mfma_f32_32x32x16_bf16 v[138:153], v[86:89], v[70:73], v[138:153]
  v_dot2_f32_bf16 v19, v86, v194, v19
  v_dot2_f32_bf16 v19, v87, v194, v19
  v_dot2_f32_bf16 v19, v88, v194, v19
  v_dot2_f32_bf16 v19, v89, v194, v19
  s_waitcnt vmcnt(6)
  s_barrier
  s_lshl_b32 s27, s24, 12
  s_add_u32 m0, s27, 0
  s_nop 0
  buffer_load_dwordx4 v10, s[4:7], s30 offen lds
  s_lshl_b32 s27, s24, 12
  s_add_u32 m0, s27, 1024
  s_nop 0
  buffer_load_dwordx4 v11, s[4:7], s30 offen lds
  s_lshl_b32 s27, s24, 12
  s_add_u32 m0, s27, 2048
  s_nop 0
  buffer_load_dwordx4 v12, s[4:7], s30 offen lds
  s_lshl_b32 s27, s24, 12
  s_add_u32 m0, s27, 3072
  s_nop 0
  buffer_load_dwordx4 v13, s[4:7], s30 offen lds
  s_lshl_b32 s27, s24, 10
  s_add_u32 m0, s27, 32768
  s_nop 0
  buffer_load_dwordx4 v14, s[8:11], s31 offen lds
  s_lshl_b32 s27, s24, 10
  s_add_u32 m0, s27, 40960
  s_nop 0
  buffer_load_dwordx4 v14, s[12:15], s31 offen lds
  s_add_u32 s30, s30, 128
  s_add_u32 s31, s31, 221184
  v_add_u32 v24, 49152, v15
  v_add_u32 v22, 49152, v16
  v_add_u32 v23, 49152, v17
  v_xor_b32 v20, 0, v24
  ds_read_b128 v[58:61], v20 offset:0
  ds_read_b128 v[62:65], v20 offset:4096
  ds_read_b64_tr_b16 v[74:75], v22 offset:0
  ds_read_b64_tr_b16 v[76:77], v23 offset:0
  ds_read_b64_tr_b16 v[78:79], v22 offset:8192
  ds_read_b64_tr_b16 v[80:81], v23 offset:8192
  v_xor_b32 v21, 32, v24
  ds_read_b128 v[66:69], v21 offset:0
  ds_read_b128 v[70:73], v21 offset:4096
  ds_read_b64_tr_b16 v[82:83], v22 offset:2048
  ds_read_b64_tr_b16 v[84:85], v23 offset:2048
  ds_read_b64_tr_b16 v[86:87], v22 offset:10240
  ds_read_b64_tr_b16 v[88:89], v23 offset:10240
  s_waitcnt lgkmcnt(6)
  v_mfma_f32_32x32x16_bf16 v[90:105], v[74:77], v[58:61], v[90:105]
  v_mfma_f32_32x32x16_bf16 v[106:121], v[74:77], v[62:65], v[106:121]
  v_dot2_f32_bf16 v18, v74, v194, v18
  v_dot2_f32_bf16 v18, v75, v194, v18
  v_dot2_f32_bf16 v18, v76, v194, v18
  v_dot2_f32_bf16 v18, v77, v194, v18
  v_mfma_f32_32x32x16_bf16 v[122:137], v[78:81], v[58:61], v[122:137]
  v_mfma_f32_32x32x16_bf16 v[138:153], v[78:81], v[62:65], v[138:153]
  v_dot2_f32_bf16 v19, v78, v194, v19
  v_dot2_f32_bf16 v19, v79, v194, v19
  v_dot2_f32_bf16 v19, v80, v194, v19
  v_dot2_f32_bf16 v19, v81, v194, v19
  v_xor_b32 v20, 64, v24
  ds_read_b128 v[58:61], v20 offset:0
  ds_read_b128 v[62:65], v20 offset:4096
  ds_read_b64_tr_b16 v[74:75], v22 offset:4096
  ds_read_b64_tr_b16 v[76:77], v23 offset:4096
  ds_read_b64_tr_b16 v[78:79], v22 offset:12288
  ds_read_b64_tr_b16 v[80:81], v23 offset:12288
  s_waitcnt lgkmcnt(6)
  v_mfma_f32_32x32x16_bf16 v[90:105], v[82:85], v[66:69], v[90:105]
  v_mfma_f32_32x32x16_bf16 v[106:121], v[82:85], v[70:73], v[106:121]
  v_dot2_f32_bf16 v18, v82, v194, v18
  v_dot2_f32_bf16 v18, v83, v194, v18
  v_dot2_f32_bf16 v18, v84, v194, v18
  v_dot2_f32_bf16 v18, v85, v194, v18
  v_mfma_f32_32x32x16_bf16 v[122:137], v[86:89], v[66:69], v[122:137]
  v_mfma_f32_32x32x16_bf16 v[138:153], v[86:89], v[70:73], v[138:153]
  v_dot2_f32_bf16 v19, v86, v194, v19
  v_dot2_f32_bf16 v19, v87, v194, v19
  v_dot2_f32_bf16 v19, v88, v194, v19
  v_dot2_f32_bf16 v19, v89, v194, v19
  v_xor_b32 v21, 96, v24
  ds_read_b128 v[66:69], v21 offset:0
  ds_read_b128 v[70:73], v21 offset:4096
  ds_read_b64_tr_b16 v[82:83], v22 offset:6144
  ds_read_b64_tr_b16 v[84:85], v23 offset:6144
  ds_read_b64_tr_b16 v[86:87], v22 offset:14336
  ds_read_b64_tr_b16 v[88:89], v23 offset:14336
  s_waitcnt lgkmcnt(6)
  v_mfma_f32_32x32x16_bf16 v[90:105], v[74:77], v[58:61], v[90:105]
  v_mfma_f32_32x32x16_bf16 v[106:121], v[74:77], v[62:65], v[106:121]
  v_dot2_f32_bf16 v18, v74, v194, v18
  v_dot2_f32_bf16 v18, v75, v194, v18
  v_dot2_f32_bf16 v18, v76, v194, v18
  v_dot2_f32_bf16 v18, v77, v194, v18
  v_mfma_f32_32x32x16_bf16 v[122:137], v[78:81], v[58:61], v[122:137]
  v_mfma_f32_32x32x16_bf16 v[138:153], v[78:81], v[62:65], v[138:153]
  v_dot2_f32_bf16 v19, v78, v194, v19
  v_dot2_f32_bf16 v19, v79, v194, v19
  v_dot2_f32_bf16 v19, v80, v194, v19
  v_dot2_f32_bf16 v19, v81, v194, v19
  s_waitcnt lgkmcnt(0)
  v_mfma_f32_32x32x16_bf16 v[90:105], v[82:85], v[66:69], v[90:105]
  v_mfma_f32_32x32x16_bf16 v[106:121], v[82:85], v[70:73], v[106:121]
  v_dot2_f32_bf16 v18, v82, v194, v18
  v_dot2_f32_bf16 v18, v83, v194, v18
  v_dot2_f32_bf16 v18, v84, v194, v18
  v_dot2_f32_bf16 v18, v85, v194, v18
  v_mfma_f32_32x32x16_bf16 v[122:137], v[86:89], v[66:69], v[122:137]
  v_mfma_f32_32x32x16_bf16 v[138:153], v[86:89], v[70:73], v[138:153]
  v_dot2_f32_bf16 v19, v86, v194, v19
  v_dot2_f32_bf16 v19, v87, v194, v19
  v_dot2_f32_bf16 v19, v88, v194, v19
  v_dot2_f32_bf16 v19, v89, v194, v19
  s_waitcnt vmcnt(6)
  s_barrier
  v_add_u32 v24, 98304, v15
  v_add_u32 v22, 98304, v16
  v_add_u32 v23, 98304, v17
  v_xor_b32 v20, 0, v24
  ds_read_b128 v[58:61], v20 offset:0
  ds_read_b128 v[62:65], v20 offset:4096
  ds_read_b64_tr_b16 v[74:75], v22 offset:0
  ds_read_b64_tr_b16 v[76:77], v23 offset:0
  ds_read_b64_tr_b16 v[78:79], v22 offset:8192
  ds_read_b64_tr_b16 v[80:81], v23 offset:8192
  v_xor_b32 v21, 32, v24
  ds_read_b128 v[66:69], v21 offset:0
  ds_read_b128 v[70:73], v21 offset:4096
  ds_read_b64_tr_b16 v[82:83], v22 offset:2048
  ds_read_b64_tr_b16 v[84:85], v23 offset:2048
  ds_read_b64_tr_b16 v[86:87], v22 offset:10240
  ds_read_b64_tr_b16 v[88:89], v23 offset:10240
  s_waitcnt lgkmcnt(6)
  v_mfma_f32_32x32x16_bf16 v[90:105], v[74:77], v[58:61], v[90:105]
  v_mfma_f32_32x32x16_bf16 v[106:121], v[74:77], v[62:65], v[106:121]
  v_dot2_f32_bf16 v18, v74, v194, v18
  v_dot2_f32_bf16 v18, v75, v194, v18
  v_dot2_f32_bf16 v18, v76, v194, v18
  v_dot2_f32_bf16 v18, v77, v194, v18
  v_mfma_f32_32x32x16_bf16 v[122:137], v[78:81], v[58:61], v[122:137]
  v_mfma_f32_32x32x16_bf16 v[138:153], v[78:81], v[62:65], v[138:153]
  v_dot2_f32_bf16 v19, v78, v194, v19
  v_dot2_f32_bf16 v19, v79, v194, v19
  v_dot2_f32_bf16 v19, v80, v194, v19
  v_dot2_f32_bf16 v19, v81, v194, v19
  v_xor_b32 v20, 64, v24
  ds_read_b128 v[58:61], v20 offset:0
  ds_read_b128 v[62:65], v20 offset:4096
  ds_read_b64_tr_b16 v[74:75], v22 offset:4096
  ds_read_b64_tr_b16 v[76:77], v23 offset:4096
  ds_read_b64_tr_b16 v[78:79], v22 offset:12288
  ds_read_b64_tr_b16 v[80:81], v23 offset:12288
  s_waitcnt lgkmcnt(6)
  v_mfma_f32_32x32x16_bf16 v[90:105], v[82:85], v[66:69], v[90:105]
  v_mfma_f32_32x32x16_bf16 v[106:121], v[82:85], v[70:73], v[106:121]
  v_dot2_f32_bf16 v18, v82, v194, v18
  v_dot2_f32_bf16 v18, v83, v194, v18
  v_dot2_f32_bf16 v18, v84, v194, v18
  v_dot2_f32_bf16 v18, v85, v194, v18
  v_mfma_f32_32x32x16_bf16 v[122:137], v[86:89], v[66:69], v[122:137]
  v_mfma_f32_32x32x16_bf16 v[138:153], v[86:89], v[70:73], v[138:153]
  v_dot2_f32_bf16 v19, v86, v194, v19
  v_dot2_f32_bf16 v19, v87, v194, v19
  v_dot2_f32_bf16 v19, v88, v194, v19
  v_dot2_f32_bf16 v19, v89, v194, v19
  v_xor_b32 v21, 96, v24
  ds_read_b128 v[66:69], v21 offset:0
  ds_read_b128 v[70:73], v21 offset:4096
  ds_read_b64_tr_b16 v[82:83], v22 offset:6144
  ds_read_b64_tr_b16 v[84:85], v23 offset:6144
  ds_read_b64_tr_b16 v[86:87], v22 offset:14336
  ds_read_b64_tr_b16 v[88:89], v23 offset:14336
  s_waitcnt lgkmcnt(6)
  v_mfma_f32_32x32x16_bf16 v[90:105], v[74:77], v[58:61], v[90:105]
  v_mfma_f32_32x32x16_bf16 v[106:121], v[74:77], v[62:65], v[106:121]
  v_dot2_f32_bf16 v18, v74, v194, v18
  v_dot2_f32_bf16 v18, v75, v194, v18
  v_dot2_f32_bf16 v18, v76, v194, v18
  v_dot2_f32_bf16 v18, v77, v194, v18
  v_mfma_f32_32x32x16_bf16 v[122:137], v[78:81], v[58:61], v[122:137]
  v_mfma_f32_32x32x16_bf16 v[138:153], v[78:81], v[62:65], v[138:153]
  v_dot2_f32_bf16 v19, v78, v194, v19
  v_dot2_f32_bf16 v19, v79, v194, v19
  v_dot2_f32_bf16 v19, v80, v194, v19
  v_dot2_f32_bf16 v19, v81, v194, v19
  s_waitcnt lgkmcnt(0)
  v_mfma_f32_32x32x16_bf16 v[90:105], v[82:85], v[66:69], v[90:105]
  v_mfma_f32_32x32x16_bf16 v[106:121], v[82:85], v[70:73], v[106:121]
  v_dot2_f32_bf16 v18, v82, v194, v18
  v_dot2_f32_bf16 v18, v83, v194, v18
  v_dot2_f32_bf16 v18, v84, v194, v18
  v_dot2_f32_bf16 v18, v85, v194, v18
  v_mfma_f32_32x32x16_bf16 v[122:137], v[86:89], v[66:69], v[122:137]
  v_mfma_f32_32x32x16_bf16 v[138:153], v[86:89], v[70:73], v[138:153]
  v_dot2_f32_bf16 v19, v86, v194, v19
  v_dot2_f32_bf16 v19, v87, v194, v19
  v_dot2_f32_bf16 v19, v88, v194, v19
  v_dot2_f32_bf16 v19, v89, v194, v19
  s_waitcnt vmcnt(0)
  s_barrier
  v_add_u32 v24, 0, v15
  v_add_u32 v22, 0, v16
  v_add_u32 v23, 0, v17
  v_xor_b32 v20, 0, v24
  ds_read_b128 v[58:61], v20 offset:0
  ds_read_b128 v[62:65], v20 offset:4096
  ds_read_b64_tr_b16 v[74:75], v22 offset:0
  ds_read_b64_tr_b16 v[76:77], v23 offset:0
  ds_read_b64_tr_b16 v[78:79], v22 offset:8192
  ds_read_b64_tr_b16 v[80:81], v23 offset:8192
  v_xor_b32 v21, 32, v24
  ds_read_b128 v[66:69], v21 offset:0
  ds_read_b128 v[70:73], v21 offset:4096
  ds_read_b64_tr_b16 v[82:83], v22 offset:2048
  ds_read_b64_tr_b16 v[84:85], v23 offset:2048
  ds_read_b64_tr_b16 v[86:87], v22 offset:10240
  ds_read_b64_tr_b16 v[88:89], v23 offset:10240
  s_waitcnt lgkmcnt(6)
  v_mfma_f32_32x32x16_bf16 v[90:105], v[74:77], v[58:61], v[90:105]
  v_mfma_f32_32x32x16_bf16 v[106:121], v[74:77], v[62:65], v[106:121]
  v_dot2_f32_bf16 v18, v74, v194, v18
  v_dot2_f32_bf16 v18, v75, v194, v18
  v_dot2_f32_bf16 v18, v76, v194, v18
  v_dot2_f32_bf16 v18, v77, v194, v18
  v_mfma_f32_32x32x16_bf16 v[122:137], v[78:81], v[58:61], v[122:137]
  v_mfma_f32_32x32x16_bf16 v[138:153], v[78:81], v[62:65], v[138:153]
  v_dot2_f32_bf16 v19, v78, v194, v19
  v_dot2_f32_bf16 v19, v79, v194, v19
  v_dot2_f32_bf16 v19, v80, v194, v19
  v_dot2_f32_bf16 v19, v81, v194, v19
  v_xor_b32 v20, 64, v24
  ds_read_b128 v[58:61], v20 offset:0
  ds_read_b128 v[62:65], v20 offset:4096
  ds_read_b64_tr_b16 v[74:75], v22 offset:4096
  ds_read_b64_tr_b16 v[76:77], v23 offset:4096
  ds_read_b64_tr_b16 v[78:79], v22 offset:12288
  ds_read_b64_tr_b16 v[80:81], v23 offset:12288
  s_waitcnt lgkmcnt(6)
  v_mfma_f32_32x32x16_bf16 v[90:105], v[82:85], v[66:69], v[90:105]
  v_mfma_f32_32x32x16_bf16 v[106:121], v[82:85], v[70:73], v[106:121]
  v_dot2_f32_bf16 v18, v82, v194, v18
  v_dot2_f32_bf16 v18, v83, v194, v18
  v_dot2_f32_bf16 v18, v84, v194, v18
  v_dot2_f32_bf16 v18, v85, v194, v18
  v_mfma_f32_32x32x16_bf16 v[122:137], v[86:89], v[66:69], v[122:137]
  v_mfma_f32_32x32x16_bf16 v[138:153], v[86:89], v[70:73], v[138:153]
  v_dot2_f32_bf16 v19, v86, v194, v19
  v_dot2_f32_bf16 v19, v87, v194, v19
  v_dot2_f32_bf16 v19, v88, v194, v19
  v_dot2_f32_bf16 v19, v89, v194, v19
  v_xor_b32 v21, 96, v24
  ds_read_b128 v[66:69], v21 offset:0
  ds_read_b128 v[70:73], v21 offset:4096
  ds_read_b64_tr_b16 v[82:83], v22 offset:6144
  ds_read_b64_tr_b16 v[84:85], v23 offset:6144
  ds_read_b64_tr_b16 v[86:87], v22 offset:14336
  ds_read_b64_tr_b16 v[88:89], v23 offset:14336
  s_waitcnt lgkmcnt(6)
  v_mfma_f32_32x32x16_bf16 v[90:105], v[74:77], v[58:61], v[90:105]
  v_mfma_f32_32x32x16_bf16 v[106:121], v[74:77], v[62:65], v[106:121]
  v_dot2_f32_bf16 v18, v74, v194, v18
  v_dot2_f32_bf16 v18, v75, v194, v18
  v_dot2_f32_bf16 v18, v76, v194, v18
  v_dot2_f32_bf16 v18, v77, v194, v18
  v_mfma_f32_32x32x16_bf16 v[122:137], v[78:81], v[58:61], v[122:137]
  v_mfma_f32_32x32x16_bf16 v[138:153], v[78:81], v[62:65], v[138:153]
  v_dot2_f32_bf16 v19, v78, v194, v19
  v_dot2_f32_bf16 v19, v79, v194, v19
  v_dot2_f32_bf16 v19, v80, v194, v19
  v_dot2_f32_bf16 v19, v81, v194, v19
  s_waitcnt lgkmcnt(0)
  v_mfma_f32_32x32x16_bf16 v[90:105], v[82:85], v[66:69], v[90:105]
  v_mfma_f32_32x32x16_bf16 v[106:121], v[82:85], v[70:73], v[106:121]
  v_dot2_f32_bf16 v18, v82, v194, v18
  v_dot2_f32_bf16 v18, v83, v194, v18
  v_dot2_f32_bf16 v18, v84, v194, v18
  v_dot2_f32_bf16 v18, v85, v194, v18
  v_mfma_f32_32x32x16_bf16 v[122:137], v[86:89], v[66:69], v[122:137]
  v_mfma_f32_32x32x16_bf16 v[138:153], v[86:89], v[70:73], v[138:153]
  v_dot2_f32_bf16 v19, v86, v194, v19
  v_dot2_f32_bf16 v19, v87, v194, v19
  v_dot2_f32_bf16 v19, v88, v194, v19
  v_dot2_f32_bf16 v19, v89, v194, v19
  v_add_f32 v26, v26, v28
  v_add_f32 v27, v27, v29
  v_add_f32 v26, v26, v30
  v_add_f32 v27, v27, v31
  v_add_f32 v26, v26, v32
  v_add_f32 v27, v27, v33
  v_add_f32 v26, v26, v34
  v_add_f32 v27, v27, v35
  v_add_f32 v26, v26, v36
  v_add_f32 v27, v27, v37
  v_add_f32 v26, v26, v38
  v_add_f32 v27, v27, v39
  v_add_f32 v26, v26, v40
  v_add_f32 v27, v27, v41
  v_mul_f32 v154, 0x3acccccd, v26
  v_mul_f32 v158, 0x3acccccd, v27
  v_fma_f32 v158, -v154, v154, v158
  v_max_f32 v158, 0, v158
  v_cvt_pk_bf16_f32 v159, v158, v158
  v_lshlrev_b32 v158, 16, v159
  v_add_f32 v158, 0x3727c5ac, v158
  v_cvt_pk_bf16_f32 v159, v158, v158
  v_lshlrev_b32 v158, 16, v159
  v_sqrt_f32 v158, v158
  s_nop 0
  v_cvt_pk_bf16_f32 v159, v158, v158
  v_lshlrev_b32 v158, 16, v159
  v_rcp_f32 v156, v158
  v_cvt_pk_bf16_f32 v159, v154, v154
  v_lshlrev_b32 v154, 16, v159
  v_add_f32 v42, v42, v44
  v_add_f32 v43, v43, v45
  v_add_f32 v42, v42, v46
  v_add_f32 v43, v43, v47
  v_add_f32 v42, v42, v48
  v_add_f32 v43, v43, v49
  v_add_f32 v42, v42, v50
  v_add_f32 v43, v43, v51
  v_add_f32 v42, v42, v52
  v_add_f32 v43, v43, v53
  v_add_f32 v42, v42, v54
  v_add_f32 v43, v43, v55
  v_add_f32 v42, v42, v56
  v_add_f32 v43, v43, v57
  v_mul_f32 v155, 0x3acccccd, v42
  v_mul_f32 v158, 0x3acccccd, v43
  v_fma_f32 v158, -v155, v155, v158
  v_max_f32 v158, 0, v158
  v_cvt_pk_bf16_f32 v159, v158, v158
  v_lshlrev_b32 v158, 16, v159
  v_add_f32 v158, 0x3727c5ac, v158
  v_cvt_pk_bf16_f32 v159, v158, v158
  v_lshlrev_b32 v158, 16, v159
  v_sqrt_f32 v158, v158
  s_nop 0
  v_cvt_pk_bf16_f32 v159, v158, v158
  v_lshlrev_b32 v158, 16, v159
  v_rcp_f32 v157, v158
  v_cvt_pk_bf16_f32 v159, v155, v155
  v_lshlrev_b32 v155, 16, v159
  s_barrier
  v_mov_b32 v158, v18
  s_nop 1
  v_permlane32_swap_b32 v18, v158
  v_add_f32 v18, v18, v158
  v_mov_b32 v158, v19
  s_nop 1
  v_permlane32_swap_b32 v19, v158
  v_add_f32 v19, v19, v158
  s_lshl_b32 s27, s24, 8
  v_lshlrev_b32 v158, 2, v1
  v_add_u32 v158, s27, v158
  ds_write_b32 v158, v18
  ds_write_b32 v158, v19 offset:2048
  v_lshrrev_b32 v159, 5, v1
  v_lshlrev_b32 v159, 4, v159
  v_add_u32 v159, s27, v159
  s_waitcnt lgkmcnt(0)
  ds_read_b128 v[162:165], v159 offset:0
  ds_read_b128 v[178:181], v159 offset:2048
  ds_read_b128 v[166:169], v159 offset:32
  ds_read_b128 v[182:185], v159 offset:2080
  ds_read_b128 v[170:173], v159 offset:64
  ds_read_b128 v[186:189], v159 offset:2112
  ds_read_b128 v[174:177], v159 offset:96
  ds_read_b128 v[190:193], v159 offset:2144
  v_and_b32 v2, 31, v1
  s_lshl_b32 s27, s25, 6
  s_add_u32 s27, s27, s28
  v_add_u32 v2, s27, v2
  s_mov_b32 s27, 3456
  v_mul_lo_u32 v2, v2, s27
  v_lshrrev_b32 v3, 5, v1
  v_lshl_add_u32 v2, v3, 3, v2
  s_lshl_b32 s27, s26, 5
  s_add_u32 s27, s27, s29
  s_lshl_b32 s27, s27, 1
  v_add_u32 v2, s27, v2
  v_add_u32 v3, 110592, v2
  v_mov_b32 v4, 0xc0135761
  v_mov_b32 v5, 0xbdd2d3e8
  s_waitcnt lgkmcnt(0)
  v_fma_f32 v90, -v154, v162, v90
  v_mul_f32 v90, v90, v156
  v_fma_f32 v122, -v154, v178, v122
  v_mul_f32 v122, v122, v156
  v_mul_f32 v6, v90, v90
  v_fma_f32 v6, v6, v5, v4
  v_mul_f32 v6, v6, v90
  v_exp_f32 v6, v6
  s_nop 0
  v_add_f32 v6, 1.0, v6
  v_rcp_f32 v6, v6
  s_nop 0
  v_mul_f32 v90, v90, v6
  v_mul_f32 v90, v90, v122
  v_fma_f32 v91, -v154, v163, v91
  v_mul_f32 v91, v91, v156
  v_fma_f32 v123, -v154, v179, v123
  v_mul_f32 v123, v123, v156
  v_mul_f32 v6, v91, v91
  v_fma_f32 v6, v6, v5, v4
  v_mul_f32 v6, v6, v91
  v_exp_f32 v6, v6
  s_nop 0
  v_add_f32 v6, 1.0, v6
  v_rcp_f32 v6, v6
  s_nop 0
  v_mul_f32 v91, v91, v6
  v_mul_f32 v91, v91, v123
  v_fma_f32 v92, -v154, v164, v92
  v_mul_f32 v92, v92, v156
  v_fma_f32 v124, -v154, v180, v124
  v_mul_f32 v124, v124, v156
  v_mul_f32 v6, v92, v92
  v_fma_f32 v6, v6, v5, v4
  v_mul_f32 v6, v6, v92
  v_exp_f32 v6, v6
  s_nop 0
  v_add_f32 v6, 1.0, v6
  v_rcp_f32 v6, v6
  s_nop 0
  v_mul_f32 v92, v92, v6
  v_mul_f32 v92, v92, v124
  v_fma_f32 v93, -v154, v165, v93
  v_mul_f32 v93, v93, v156
  v_fma_f32 v125, -v154, v181, v125
  v_mul_f32 v125, v125, v156
  v_mul_f32 v6, v93, v93
  v_fma_f32 v6, v6, v5, v4
  v_mul_f32 v6, v6, v93
  v_exp_f32 v6, v6
  s_nop 0
  v_add_f32 v6, 1.0, v6
  v_rcp_f32 v6, v6
  s_nop 0
  v_mul_f32 v93, v93, v6
  v_mul_f32 v93, v93, v125
  v_fma_f32 v94, -v154, v166, v94
  v_mul_f32 v94, v94, v156
  v_fma_f32 v126, -v154, v182, v126
  v_mul_f32 v126, v126, v156
  v_mul_f32 v6, v94, v94
  v_fma_f32 v6, v6, v5, v4
  v_mul_f32 v6, v6, v94
  v_exp_f32 v6, v6
  s_nop 0
  v_add_f32 v6, 1.0, v6
  v_rcp_f32 v6, v6
  s_nop 0
  v_mul_f32 v94, v94, v6
  v_mul_f32 v94, v94, v126
  v_fma_f32 v95, -v154, v167, v95
  v_mul_f32 v95, v95, v156
  v_fma_f32 v127, -v154, v183, v127
  v_mul_f32 v127, v127, v156
  v_mul_f32 v6, v95, v95
  v_fma_f32 v6, v6, v5, v4
  v_mul_f32 v6, v6, v95
  v_exp_f32 v6, v6
  s_nop 0
  v_add_f32 v6, 1.0, v6
  v_rcp_f32 v6, v6
  s_nop 0
  v_mul_f32 v95, v95, v6
  v_mul_f32 v95, v95, v127
  v_fma_f32 v96, -v154, v168, v96
  v_mul_f32 v96, v96, v156
  v_fma_f32 v128, -v154, v184, v128
  v_mul_f32 v128, v128, v156
  v_mul_f32 v6, v96, v96
  v_fma_f32 v6, v6, v5, v4
  v_mul_f32 v6, v6, v96
  v_exp_f32 v6, v6
  s_nop 0
  v_add_f32 v6, 1.0, v6
  v_rcp_f32 v6, v6
  s_nop 0
  v_mul_f32 v96, v96, v6
  v_mul_f32 v96, v96, v128
  v_fma_f32 v97, -v154, v169, v97
  v_mul_f32 v97, v97, v156
  v_fma_f32 v129, -v154, v185, v129
  v_mul_f32 v129, v129, v156
  v_mul_f32 v6, v97, v97
  v_fma_f32 v6, v6, v5, v4
  v_mul_f32 v6, v6, v97
  v_exp_f32 v6, v6
  s_nop 0
  v_add_f32 v6, 1.0, v6
  v_rcp_f32 v6, v6
  s_nop 0
  v_mul_f32 v97, v97, v6
  v_mul_f32 v97, v97, v129
  v_fma_f32 v98, -v154, v170, v98
  v_mul_f32 v98, v98, v156
  v_fma_f32 v130, -v154, v186, v130
  v_mul_f32 v130, v130, v156
  v_mul_f32 v6, v98, v98
  v_fma_f32 v6, v6, v5, v4
  v_mul_f32 v6, v6, v98
  v_exp_f32 v6, v6
  s_nop 0
  v_add_f32 v6, 1.0, v6
  v_rcp_f32 v6, v6
  s_nop 0
  v_mul_f32 v98, v98, v6
  v_mul_f32 v98, v98, v130
  v_fma_f32 v99, -v154, v171, v99
  v_mul_f32 v99, v99, v156
  v_fma_f32 v131, -v154, v187, v131
  v_mul_f32 v131, v131, v156
  v_mul_f32 v6, v99, v99
  v_fma_f32 v6, v6, v5, v4
  v_mul_f32 v6, v6, v99
  v_exp_f32 v6, v6
  s_nop 0
  v_add_f32 v6, 1.0, v6
  v_rcp_f32 v6, v6
  s_nop 0
  v_mul_f32 v99, v99, v6
  v_mul_f32 v99, v99, v131
  v_fma_f32 v100, -v154, v172, v100
  v_mul_f32 v100, v100, v156
  v_fma_f32 v132, -v154, v188, v132
  v_mul_f32 v132, v132, v156
  v_mul_f32 v6, v100, v100
  v_fma_f32 v6, v6, v5, v4
  v_mul_f32 v6, v6, v100
  v_exp_f32 v6, v6
  s_nop 0
  v_add_f32 v6, 1.0, v6
  v_rcp_f32 v6, v6
  s_nop 0
  v_mul_f32 v100, v100, v6
  v_mul_f32 v100, v100, v132
  v_fma_f32 v101, -v154, v173, v101
  v_mul_f32 v101, v101, v156
  v_fma_f32 v133, -v154, v189, v133
  v_mul_f32 v133, v133, v156
  v_mul_f32 v6, v101, v101
  v_fma_f32 v6, v6, v5, v4
  v_mul_f32 v6, v6, v101
  v_exp_f32 v6, v6
  s_nop 0
  v_add_f32 v6, 1.0, v6
  v_rcp_f32 v6, v6
  s_nop 0
  v_mul_f32 v101, v101, v6
  v_mul_f32 v101, v101, v133
  v_fma_f32 v102, -v154, v174, v102
  v_mul_f32 v102, v102, v156
  v_fma_f32 v134, -v154, v190, v134
  v_mul_f32 v134, v134, v156
  v_mul_f32 v6, v102, v102
  v_fma_f32 v6, v6, v5, v4
  v_mul_f32 v6, v6, v102
  v_exp_f32 v6, v6
  s_nop 0
  v_add_f32 v6, 1.0, v6
  v_rcp_f32 v6, v6
  s_nop 0
  v_mul_f32 v102, v102, v6
  v_mul_f32 v102, v102, v134
  v_fma_f32 v103, -v154, v175, v103
  v_mul_f32 v103, v103, v156
  v_fma_f32 v135, -v154, v191, v135
  v_mul_f32 v135, v135, v156
  v_mul_f32 v6, v103, v103
  v_fma_f32 v6, v6, v5, v4
  v_mul_f32 v6, v6, v103
  v_exp_f32 v6, v6
  s_nop 0
  v_add_f32 v6, 1.0, v6
  v_rcp_f32 v6, v6
  s_nop 0
  v_mul_f32 v103, v103, v6
  v_mul_f32 v103, v103, v135
  v_fma_f32 v104, -v154, v176, v104
  v_mul_f32 v104, v104, v156
  v_fma_f32 v136, -v154, v192, v136
  v_mul_f32 v136, v136, v156
  v_mul_f32 v6, v104, v104
  v_fma_f32 v6, v6, v5, v4
  v_mul_f32 v6, v6, v104
  v_exp_f32 v6, v6
  s_nop 0
  v_add_f32 v6, 1.0, v6
  v_rcp_f32 v6, v6
  s_nop 0
  v_mul_f32 v104, v104, v6
  v_mul_f32 v104, v104, v136
  v_fma_f32 v105, -v154, v177, v105
  v_mul_f32 v105, v105, v156
  v_fma_f32 v137, -v154, v193, v137
  v_mul_f32 v137, v137, v156
  v_mul_f32 v6, v105, v105
  v_fma_f32 v6, v6, v5, v4
  v_mul_f32 v6, v6, v105
  v_exp_f32 v6, v6
  s_nop 0
  v_add_f32 v6, 1.0, v6
  v_rcp_f32 v6, v6
  s_nop 0
  v_mul_f32 v105, v105, v6
  v_mul_f32 v105, v105, v137
  v_cvt_pk_bf16_f32 v158, v90, v91
  v_cvt_pk_bf16_f32 v159, v92, v93
  buffer_store_dwordx2 v[158:159], v2, s[16:19], 0 offen offset:0
  v_cvt_pk_bf16_f32 v158, v94, v95
  v_cvt_pk_bf16_f32 v159, v96, v97
  buffer_store_dwordx2 v[158:159], v2, s[16:19], 0 offen offset:16
  v_cvt_pk_bf16_f32 v158, v98, v99
  v_cvt_pk_bf16_f32 v159, v100, v101
  buffer_store_dwordx2 v[158:159], v2, s[16:19], 0 offen offset:32
  v_cvt_pk_bf16_f32 v158, v102, v103
  v_cvt_pk_bf16_f32 v159, v104, v105
  buffer_store_dwordx2 v[158:159], v2, s[16:19], 0 offen offset:48
  v_fma_f32 v106, -v155, v162, v106
  v_mul_f32 v106, v106, v157
  v_fma_f32 v138, -v155, v178, v138
  v_mul_f32 v138, v138, v157
  v_mul_f32 v6, v106, v106
  v_fma_f32 v6, v6, v5, v4
  v_mul_f32 v6, v6, v106
  v_exp_f32 v6, v6
  s_nop 0
  v_add_f32 v6, 1.0, v6
  v_rcp_f32 v6, v6
  s_nop 0
  v_mul_f32 v106, v106, v6
  v_mul_f32 v106, v106, v138
  v_fma_f32 v107, -v155, v163, v107
  v_mul_f32 v107, v107, v157
  v_fma_f32 v139, -v155, v179, v139
  v_mul_f32 v139, v139, v157
  v_mul_f32 v6, v107, v107
  v_fma_f32 v6, v6, v5, v4
  v_mul_f32 v6, v6, v107
  v_exp_f32 v6, v6
  s_nop 0
  v_add_f32 v6, 1.0, v6
  v_rcp_f32 v6, v6
  s_nop 0
  v_mul_f32 v107, v107, v6
  v_mul_f32 v107, v107, v139
  v_fma_f32 v108, -v155, v164, v108
  v_mul_f32 v108, v108, v157
  v_fma_f32 v140, -v155, v180, v140
  v_mul_f32 v140, v140, v157
  v_mul_f32 v6, v108, v108
  v_fma_f32 v6, v6, v5, v4
  v_mul_f32 v6, v6, v108
  v_exp_f32 v6, v6
  s_nop 0
  v_add_f32 v6, 1.0, v6
  v_rcp_f32 v6, v6
  s_nop 0
  v_mul_f32 v108, v108, v6
  v_mul_f32 v108, v108, v140
  v_fma_f32 v109, -v155, v165, v109
  v_mul_f32 v109, v109, v157
  v_fma_f32 v141, -v155, v181, v141
  v_mul_f32 v141, v141, v157
  v_mul_f32 v6, v109, v109
  v_fma_f32 v6, v6, v5, v4
  v_mul_f32 v6, v6, v109
  v_exp_f32 v6, v6
  s_nop 0
  v_add_f32 v6, 1.0, v6
  v_rcp_f32 v6, v6
  s_nop 0
  v_mul_f32 v109, v109, v6
  v_mul_f32 v109, v109, v141
  v_fma_f32 v110, -v155, v166, v110
  v_mul_f32 v110, v110, v157
  v_fma_f32 v142, -v155, v182, v142
  v_mul_f32 v142, v142, v157
  v_mul_f32 v6, v110, v110
  v_fma_f32 v6, v6, v5, v4
  v_mul_f32 v6, v6, v110
  v_exp_f32 v6, v6
  s_nop 0
  v_add_f32 v6, 1.0, v6
  v_rcp_f32 v6, v6
  s_nop 0
  v_mul_f32 v110, v110, v6
  v_mul_f32 v110, v110, v142
  v_fma_f32 v111, -v155, v167, v111
  v_mul_f32 v111, v111, v157
  v_fma_f32 v143, -v155, v183, v143
  v_mul_f32 v143, v143, v157
  v_mul_f32 v6, v111, v111
  v_fma_f32 v6, v6, v5, v4
  v_mul_f32 v6, v6, v111
  v_exp_f32 v6, v6
  s_nop 0
  v_add_f32 v6, 1.0, v6
  v_rcp_f32 v6, v6
  s_nop 0
  v_mul_f32 v111, v111, v6
  v_mul_f32 v111, v111, v143
  v_fma_f32 v112, -v155, v168, v112
  v_mul_f32 v112, v112, v157
  v_fma_f32 v144, -v155, v184, v144
  v_mul_f32 v144, v144, v157
  v_mul_f32 v6, v112, v112
  v_fma_f32 v6, v6, v5, v4
  v_mul_f32 v6, v6, v112
  v_exp_f32 v6, v6
  s_nop 0
  v_add_f32 v6, 1.0, v6
  v_rcp_f32 v6, v6
  s_nop 0
  v_mul_f32 v112, v112, v6
  v_mul_f32 v112, v112, v144
  v_fma_f32 v113, -v155, v169, v113
  v_mul_f32 v113, v113, v157
  v_fma_f32 v145, -v155, v185, v145
  v_mul_f32 v145, v145, v157
  v_mul_f32 v6, v113, v113
  v_fma_f32 v6, v6, v5, v4
  v_mul_f32 v6, v6, v113
  v_exp_f32 v6, v6
  s_nop 0
  v_add_f32 v6, 1.0, v6
  v_rcp_f32 v6, v6
  s_nop 0
  v_mul_f32 v113, v113, v6
  v_mul_f32 v113, v113, v145
  v_fma_f32 v114, -v155, v170, v114
  v_mul_f32 v114, v114, v157
  v_fma_f32 v146, -v155, v186, v146
  v_mul_f32 v146, v146, v157
  v_mul_f32 v6, v114, v114
  v_fma_f32 v6, v6, v5, v4
  v_mul_f32 v6, v6, v114
  v_exp_f32 v6, v6
  s_nop 0
  v_add_f32 v6, 1.0, v6
  v_rcp_f32 v6, v6
  s_nop 0
  v_mul_f32 v114, v114, v6
  v_mul_f32 v114, v114, v146
  v_fma_f32 v115, -v155, v171, v115
  v_mul_f32 v115, v115, v157
  v_fma_f32 v147, -v155, v187, v147
  v_mul_f32 v147, v147, v157
  v_mul_f32 v6, v115, v115
  v_fma_f32 v6, v6, v5, v4
  v_mul_f32 v6, v6, v115
  v_exp_f32 v6, v6
  s_nop 0
  v_add_f32 v6, 1.0, v6
  v_rcp_f32 v6, v6
  s_nop 0
  v_mul_f32 v115, v115, v6
  v_mul_f32 v115, v115, v147
  v_fma_f32 v116, -v155, v172, v116
  v_mul_f32 v116, v116, v157
  v_fma_f32 v148, -v155, v188, v148
  v_mul_f32 v148, v148, v157
  v_mul_f32 v6, v116, v116
  v_fma_f32 v6, v6, v5, v4
  v_mul_f32 v6, v6, v116
  v_exp_f32 v6, v6
  s_nop 0
  v_add_f32 v6, 1.0, v6
  v_rcp_f32 v6, v6
  s_nop 0
  v_mul_f32 v116, v116, v6
  v_mul_f32 v116, v116, v148
  v_fma_f32 v117, -v155, v173, v117
  v_mul_f32 v117, v117, v157
  v_fma_f32 v149, -v155, v189, v149
  v_mul_f32 v149, v149, v157
  v_mul_f32 v6, v117, v117
  v_fma_f32 v6, v6, v5, v4
  v_mul_f32 v6, v6, v117
  v_exp_f32 v6, v6
  s_nop 0
  v_add_f32 v6, 1.0, v6
  v_rcp_f32 v6, v6
  s_nop 0
  v_mul_f32 v117, v117, v6
  v_mul_f32 v117, v117, v149
  v_fma_f32 v118, -v155, v174, v118
  v_mul_f32 v118, v118, v157
  v_fma_f32 v150, -v155, v190, v150
  v_mul_f32 v150, v150, v157
  v_mul_f32 v6, v118, v118
  v_fma_f32 v6, v6, v5, v4
  v_mul_f32 v6, v6, v118
  v_exp_f32 v6, v6
  s_nop 0
  v_add_f32 v6, 1.0, v6
  v_rcp_f32 v6, v6
  s_nop 0
  v_mul_f32 v118, v118, v6
  v_mul_f32 v118, v118, v150
  v_fma_f32 v119, -v155, v175, v119
  v_mul_f32 v119, v119, v157
  v_fma_f32 v151, -v155, v191, v151
  v_mul_f32 v151, v151, v157
  v_mul_f32 v6, v119, v119
  v_fma_f32 v6, v6, v5, v4
  v_mul_f32 v6, v6, v119
  v_exp_f32 v6, v6
  s_nop 0
  v_add_f32 v6, 1.0, v6
  v_rcp_f32 v6, v6
  s_nop 0
  v_mul_f32 v119, v119, v6
  v_mul_f32 v119, v119, v151
  v_fma_f32 v120, -v155, v176, v120
  v_mul_f32 v120, v120, v157
  v_fma_f32 v152, -v155, v192, v152
  v_mul_f32 v152, v152, v157
  v_mul_f32 v6, v120, v120
  v_fma_f32 v6, v6, v5, v4
  v_mul_f32 v6, v6, v120
  v_exp_f32 v6, v6
  s_nop 0
  v_add_f32 v6, 1.0, v6
  v_rcp_f32 v6, v6
  s_nop 0
  v_mul_f32 v120, v120, v6
  v_mul_f32 v120, v120, v152
  v_fma_f32 v121, -v155, v177, v121
  v_mul_f32 v121, v121, v157
  v_fma_f32 v153, -v155, v193, v153
  v_mul_f32 v153, v153, v157
  v_mul_f32 v6, v121, v121
  v_fma_f32 v6, v6, v5, v4
  v_mul_f32 v6, v6, v121
  v_exp_f32 v6, v6
  s_nop 0
  v_add_f32 v6, 1.0, v6
  v_rcp_f32 v6, v6
  s_nop 0
  v_mul_f32 v121, v121, v6
  v_mul_f32 v121, v121, v153
  v_cvt_pk_bf16_f32 v158, v106, v107
  v_cvt_pk_bf16_f32 v159, v108, v109
  buffer_store_dwordx2 v[158:159], v3, s[16:19], 0 offen offset:0
  v_cvt_pk_bf16_f32 v158, v110, v111
  v_cvt_pk_bf16_f32 v159, v112, v113
  buffer_store_dwordx2 v[158:159], v3, s[16:19], 0 offen offset:16
  v_cvt_pk_bf16_f32 v158, v114, v115
  v_cvt_pk_bf16_f32 v159, v116, v117
  buffer_store_dwordx2 v[158:159], v3, s[16:19], 0 offen offset:32
  v_cvt_pk_bf16_f32 v158, v118, v119
  v_cvt_pk_bf16_f32 v159, v120, v121
  buffer_store_dwordx2 v[158:159], v3, s[16:19], 0 offen offset:48
L_end_g3_kernel:
  s_endpgm
.globl g4a_kernel
.p2align 8
.type g4a_kernel,@function
g4a_kernel:
  s_cmp_ge_u32 s2, 256
  s_cbranch_scc1 L_end_g4a_kernel
  s_load_dwordx2 s[32:33], s[0:1], 88
  s_load_dwordx2 s[36:37], s[0:1], 64
  s_load_dwordx2 s[38:39], s[0:1], 72
  v_lshrrev_b32 v15, 6, v0
  v_and_b32 v1, 63, v0
  v_readfirstlane_b32 s20, v15
  s_and_b32 s28, s2, 7
  s_lshr_b32 s30, s2, 3
  s_and_b32 s27, s30, 3
  s_lshr_b32 s30, s30, 2
  s_lshl_b32 s28, s28, 2
  s_add_u32 s28, s28, s27
  s_lshl_b32 s28, s28, 6
  s_mul_i32 s29, s30, 80
  s_waitcnt lgkmcnt(0)
  s_add_u32 s42, s32, 16777216
  s_addc_u32 s43, s33, 0
  s_mov_b32 s4, s42
  s_mov_b32 s5, s43
  s_mov_b32 s6, 7077888
  s_mov_b32 s7, 0x00020000
  s_mov_b32 s8, s36
  s_mov_b32 s9, s37
  s_mov_b32 s10, 2211840
  s_mov_b32 s11, 0x00020000
  s_add_u32 s42, s32, 9437184
  s_addc_u32 s43, s33, 0
  s_mov_b32 s12, s42
  s_mov_b32 s13, s43
  s_mov_b32 s14, 2621440
  s_mov_b32 s15, 0x00020000
  s_add_u32 s42, s32, 6291456
  s_addc_u32 s43, s33, 0
  s_mov_b32 s16, s42
  s_mov_b32 s17, s43
  s_mov_b32 s18, 2621440
  s_mov_b32 s19, 0x00020000
  s_sub_u32 s22, 57, s20
  s_lshr_b32 s22, s22, 2
  s_mul_i32 s27, s20, 13
  s_min_u32 s23, s20, 2
  s_add_u32 s27, s27, s23
  s_lshl_b32 s23, s27, 6
  s_mul_i32 s24, s27, 40960
  s_mul_i32 s21, s20, 36864
  v_lshrrev_b32 v15, 2, v1
  v_lshrrev_b32 v16, 3, v1
  v_xor_b32 v16, v16, v1
  v_and_b32 v16, 3, v16
  v_add_u32 v15, s28, v15
  s_mov_b32 s27, 3456
  v_mul_lo_u32 v15, v15, s27
  v_lshl_add_u32 v2, v16, 4, v15
  v_add_u32 v3, 55296, v2
  v_add_u32 v4, 110592, v2
  v_add_u32 v5, 165888, v2
  v_add_u32 v15, 0, v1
  v_mul_u32_u24 v16, 6554, v15
  v_lshrrev_b32 v16, 16, v16
  v_mul_u32_u24 v17, 10, v16
  v_sub_u32 v17, v15, v17
  v_mul_u32_u24 v16, 1280, v16
  v_lshl_add_u32 v6, v17, 4, v16
  v_add_u32 v15, 64, v1
  v_mul_u32_u24 v16, 6554, v15
  v_lshrrev_b32 v16, 16, v16
  v_mul_u32_u24 v17, 10, v16
  v_sub_u32 v17, v15, v17
  v_mul_u32_u24 v16, 1280, v16
  v_lshl_add_u32 v7, v17, 4, v16
  v_add_u32 v15, 128, v1
  v_mul_u32_u24 v16, 6554, v15
  v_lshrrev_b32 v16, 16, v16
  v_mul_u32_u24 v17, 10, v16
  v_sub_u32 v17, v15, v17
  v_mul_u32_u24 v16, 1280, v16
  v_lshl_add_u32 v8, v17, 4, v16
  v_add_u32 v15, 192, v1
  v_mul_u32_u24 v16, 6554, v15
  v_lshrrev_b32 v16, 16, v16
  v_mul_u32_u24 v17, 10, v16
  v_sub_u32 v17, v15, v17
  v_mul_u32_u24 v16, 1280, v16
  v_lshl_add_u32 v9, v17, 4, v16
  v_add_u32 v15, 256, v1
  v_mul_u32_u24 v16, 6554, v15
  v_lshrrev_b32 v16, 16, v16
  v_mul_u32_u24 v17, 10, v16
  v_sub_u32 v17, v15, v17
  v_mul_u32_u24 v16, 1280, v16
  v_lshl_add_u32 v10, v17, 4, v16
  s_lshl_b32 s27, s29, 1
  v_add_u32 v6, s27, v6
  v_add_u32 v7, s27, v7
  v_add_u32 v8, s27, v8
  v_add_u32 v9, s27, v9
  v_add_u32 v10, s27, v10
  v_and_b32 v15, 15, v1
  v_lshrrev_b32 v16, 4, v1
  v_lshrrev_b32 v17, 1, v15
  v_xor_b32 v17, v17, v16
  v_and_b32 v17, 3, v17
  v_lshlrev_b32 v17, 4, v17
  v_lshl_add_u32 v11, v15, 6, v17
  v_add_u32 v11, s21, v11
  v_lshrrev_b32 v17, 2, v15
  v_lshl_add_u32 v17, v16, 3, v17
  v_mov_b32 v19, v17
  v_mul_u32_u24 v17, 160, v17
  v_and_b32 v18, 3, v1
  v_lshl_add_u32 v12, v18, 3, v17
  v_add_u32 v12, 4096, v12
  v_add_u32 v12, s21, v12
  v_mov_b32 v60, 0
  v_mov_b32 v61, 0
  v_mov_b32 v62, 0
  v_mov_b32 v63, 0
  v_mov_b32 v64, 0
  v_mov_b32 v65, 0
  v_mov_b32 v66, 0
  v_mov_b32 v67, 0
  v_mov_b32 v68, 0
  v_mov_b32 v69, 0
  v_mov_b32 v70, 0
  v_mov_b32 v71, 0
  v_mov_b32 v72, 0
  v_mov_b32 v73, 0
  v_mov_b32 v74, 0
  v_mov_b32 v75, 0
  v_mov_b32 v76, 0
  v_mov_b32 v77, 0
  v_mov_b32 v78, 0
  v_mov_b32 v79, 0
  v_mov_b32 v80, 0
  v_mov_b32 v81, 0
  v_mov_b32 v82, 0
  v_mov_b32 v83, 0
  v_mov_b32 v84, 0
  v_mov_b32 v85, 0
  v_mov_b32 v86, 0
  v_mov_b32 v87, 0
  v_mov_b32 v88, 0
  v_mov_b32 v89, 0
  v_mov_b32 v90, 0
  v_mov_b32 v91, 0
  v_mov_b32 v92, 0
  v_mov_b32 v93, 0
  v_mov_b32 v94, 0
  v_mov_b32 v95, 0
  v_mov_b32 v96, 0
  v_mov_b32 v97, 0
  v_mov_b32 v98, 0
  v_mov_b32 v99, 0
  v_mov_b32 v100, 0
  v_mov_b32 v101, 0
  v_mov_b32 v102, 0
  v_mov_b32 v103, 0
  v_mov_b32 v104, 0
  v_mov_b32 v105, 0
  v_mov_b32 v106, 0
  v_mov_b32 v107, 0
  v_mov_b32 v108, 0
  v_mov_b32 v109, 0
  v_mov_b32 v110, 0
  v_mov_b32 v111, 0
  v_mov_b32 v112, 0
  v_mov_b32 v113, 0
  v_mov_b32 v114, 0
  v_mov_b32 v115, 0
  v_mov_b32 v116, 0
  v_mov_b32 v117, 0
  v_mov_b32 v118, 0
  v_mov_b32 v119, 0
  v_mov_b32 v120, 0
  v_mov_b32 v121, 0
  v_mov_b32 v122, 0
  v_mov_b32 v123, 0
  v_mov_b32 v124, 0
  v_mov_b32 v125, 0
  v_mov_b32 v126, 0
  v_mov_b32 v127, 0
  v_mov_b32 v128, 0
  v_mov_b32 v129, 0
  v_mov_b32 v130, 0
  v_mov_b32 v131, 0
  v_mov_b32 v132, 0
  v_mov_b32 v133, 0
  v_mov_b32 v134, 0
  v_mov_b32 v135, 0
  v_mov_b32 v136, 0
  v_mov_b32 v137, 0
  v_mov_b32 v138, 0
  v_mov_b32 v139, 0
  s_mov_b32 s25, s21
  s_mov_b32 s26, 0
  v_and_b32 v15, 15, v1
  v_lshrrev_b32 v16, 4, v1
  s_lshl_b32 s27, s20, 4
  s_add_u32 s27, s27, s28
  v_add_u32 v15, s27, v15
  v_mul_u32_u24 v15, 1280, v15
  v_lshl_add_u32 v16, v16, 3, v15
  s_lshl_b32 s27, s29, 1
  v_add_u32 v23, s27, v16
  buffer_load_dwordx2 v[154:155], v23, s[16:19], 0 offen offset:0
  buffer_load_dwordx2 v[156:157], v23, s[16:19], 0 offen offset:32
  buffer_load_dwordx2 v[158:159], v23, s[16:19], 0 offen offset:64
  buffer_load_dwordx2 v[160:161], v23, s[16:19], 0 offen offset:96
  buffer_load_dwordx2 v[162:163], v23, s[16:19], 0 offen offset:128
  s_add_u32 m0, s25, 0
  s_nop 0
  buffer_load_dwordx4 v2, s[4:7], s23 offen lds
  s_add_u32 m0, s25, 1024
  s_nop 0
  buffer_load_dwordx4 v3, s[4:7], s23 offen lds
  s_add_u32 m0, s25, 2048
  s_nop 0
  buffer_load_dwordx4 v4, s[4:7], s23 offen lds
  s_add_u32 m0, s25, 3072
  s_nop 0
  buffer_load_dwordx4 v5, s[4:7], s23 offen lds
  s_add_u32 m0, s25, 4096
  s_nop 0
  buffer_load_dwordx4 v6, s[8:11], s24 offen lds
  s_add_u32 m0, s25, 5120
  s_nop 0
  buffer_load_dwordx4 v7, s[8:11], s24 offen lds
  s_add_u32 m0, s25, 6144
  s_nop 0
  buffer_load_dwordx4 v8, s[8:11], s24 offen lds
  s_add_u32 m0, s25, 7168
  s_nop 0
  buffer_load_dwordx4 v9, s[8:11], s24 offen lds
  s_add_u32 m0, s25, 8192
  s_nop 0
  buffer_load_dwordx4 v10, s[8:11], s24 offen lds
  s_add_u32 s24, s24, 40960
  s_add_u32 s23, s23, 64
  s_add_u32 s25, s25, 9216
  s_add_u32 s27, s21, 36864
  s_cmp_ge_u32 s25, s27
  s_cselect_b32 s25, s21, s25
  s_add_u32 m0, s25, 0
  s_nop 0
  buffer_load_dwordx4 v2, s[4:7], s23 offen lds
  s_add_u32 m0, s25, 1024
  s_nop 0
  buffer_load_dwordx4 v3, s[4:7], s23 offen lds
  s_add_u32 m0, s25, 2048
  s_nop 0
  buffer_load_dwordx4 v4, s[4:7], s23 offen lds
  s_add_u32 m0, s25, 3072
  s_nop 0
  buffer_load_dwordx4 v5, s[4:7], s23 offen lds
  s_add_u32 m0, s25, 4096
  s_nop 0
  buffer_load_dwordx4 v6, s[8:11], s24 offen lds
  s_add_u32 m0, s25, 5120
  s_nop 0
  buffer_load_dwordx4 v7, s[8:11], s24 offen lds
  s_add_u32 m0, s25, 6144
  s_nop 0
  buffer_load_dwordx4 v8, s[8:11], s24 offen lds
  s_add_u32 m0, s25, 7168
  s_nop 0
  buffer_load_dwordx4 v9, s[8:11], s24 offen lds
  s_add_u32 m0, s25, 8192
  s_nop 0
  buffer_load_dwordx4 v10, s[8:11], s24 offen lds
  s_add_u32 s24, s24, 40960
  s_add_u32 s23, s23, 64
  s_add_u32 s25, s25, 9216
  s_add_u32 s27, s21, 36864
  s_cmp_ge_u32 s25, s27
  s_cselect_b32 s25, s21, s25
  s_add_u32 m0, s25, 0
  s_nop 0
  buffer_load_dwordx4 v2, s[4:7], s23 offen lds
  s_add_u32 m0, s25, 1024
  s_nop 0
  buffer_load_dwordx4 v3, s[4:7], s23 offen lds
  s_add_u32 m0, s25, 2048
  s_nop 0
  buffer_load_dwordx4 v4, s[4:7], s23 offen lds
  s_add_u32 m0, s25, 3072
  s_nop 0
  buffer_load_dwordx4 v5, s[4:7], s23 offen lds
  s_add_u32 m0, s25, 4096
  s_nop 0
  buffer_load_dwordx4 v6, s[8:11], s24 offen lds
  s_add_u32 m0, s25, 5120
  s_nop 0
  buffer_load_dwordx4 v7, s[8:11], s24 offen lds
  s_add_u32 m0, s25, 6144
  s_nop 0
  buffer_load_dwordx4 v8, s[8:11], s24 offen lds
  s_add_u32 m0, s25, 7168
  s_nop 0
  buffer_load_dwordx4 v9, s[8:11], s24 offen lds
  s_add_u32 m0, s25, 8192
  s_nop 0
  buffer_load_dwordx4 v10, s[8:11], s24 offen lds
  s_add_u32 s24, s24, 40960
  s_add_u32 s23, s23, 64
  s_add_u32 s25, s25, 9216
  s_add_u32 s27, s21, 36864
  s_cmp_ge_u32 s25, s27
  s_cselect_b32 s25, s21, s25
L_loop_g4a_kernel:
  s_add_u32 m0, s25, 0
  s_nop 0
  buffer_load_dwordx4 v2, s[4:7], s23 offen lds
  s_add_u32 m0, s25, 1024
  s_nop 0
  buffer_load_dwordx4 v3, s[4:7], s23 offen lds
  s_add_u32 m0, s25, 2048
  s_nop 0
  buffer_load_dwordx4 v4, s[4:7], s23 offen lds
  s_add_u32 m0, s25, 3072
  s_nop 0
  buffer_load_dwordx4 v5, s[4:7], s23 offen lds
  s_add_u32 m0, s25, 4096
  s_nop 0
  buffer_load_dwordx4 v6, s[8:11], s24 offen lds
  s_add_u32 m0, s25, 5120
  s_nop 0
  buffer_load_dwordx4 v7, s[8:11], s24 offen lds
  s_add_u32 m0, s25, 6144
  s_nop 0
  buffer_load_dwordx4 v8, s[8:11], s24 offen lds
  s_add_u32 m0, s25, 7168
  s_nop 0
  buffer_load_dwordx4 v9, s[8:11], s24 offen lds
  s_add_u32 m0, s25, 8192
  s_nop 0
  buffer_load_dwordx4 v10, s[8:11], s24 offen lds
  s_add_u32 s24, s24, 40960
  s_add_u32 s23, s23, 64
  s_add_u32 s25, s25, 9216
  s_add_u32 s27, s21, 36864
  s_cmp_ge_u32 s25, s27
  s_cselect_b32 s25, s21, s25
  s_waitcnt vmcnt(27)
  v_add_u32 v13, s26, v11
  v_add_u32 v14, s26, v12
  ds_read_b128 v[24:27], v13 offset:0
  ds_read_b128 v[28:31], v13 offset:1024
  ds_read_b128 v[32:35], v13 offset:2048
  ds_read_b128 v[36:39], v13 offset:3072
  ds_read_b64_tr_b16 v[40:41], v14 offset:0
  ds_read_b64_tr_b16 v[42:43], v14 offset:640
  ds_read_b64_tr_b16 v[44:45], v14 offset:32
  ds_read_b64_tr_b16 v[46:47], v14 offset:672
  ds_read_b64_tr_b16 v[48:49], v14 offset:64
  ds_read_b64_tr_b16 v[50:51], v14 offset:704
  ds_read_b64_tr_b16 v[52:53], v14 offset:96
  ds_read_b64_tr_b16 v[54:55], v14 offset:736
  ds_read_b64_tr_b16 v[56:57], v14 offset:128
  ds_read_b64_tr_b16 v[58:59], v14 offset:768
  s_add_u32 s26, s26, 9216
  s_cmp_ge_u32 s26, 36864
  s_cselect_b32 s26, 0, s26
  s_waitcnt lgkmcnt(0)
  v_mfma_f32_16x16x32_bf16 v[60:63], v[40:43], v[24:27], v[60:63]
  v_mfma_f32_16x16x32_bf16 v[64:67], v[44:47], v[24:27], v[64:67]
  v_mfma_f32_16x16x32_bf16 v[68:71], v[48:51], v[24:27], v[68:71]
  v_mfma_f32_16x16x32_bf16 v[72:75], v[52:55], v[24:27], v[72:75]
  v_mfma_f32_16x16x32_bf16 v[76:79], v[56:59], v[24:27], v[76:79]
  v_mfma_f32_16x16x32_bf16 v[80:83], v[40:43], v[28:31], v[80:83]
  v_mfma_f32_16x16x32_bf16 v[84:87], v[44:47], v[28:31], v[84:87]
  v_mfma_f32_16x16x32_bf16 v[88:91], v[48:51], v[28:31], v[88:91]
  v_mfma_f32_16x16x32_bf16 v[92:95], v[52:55], v[28:31], v[92:95]
  v_mfma_f32_16x16x32_bf16 v[96:99], v[56:59], v[28:31], v[96:99]
  v_mfma_f32_16x16x32_bf16 v[100:103], v[40:43], v[32:35], v[100:103]
  v_mfma_f32_16x16x32_bf16 v[104:107], v[44:47], v[32:35], v[104:107]
  v_mfma_f32_16x16x32_bf16 v[108:111], v[48:51], v[32:35], v[108:111]
  v_mfma_f32_16x16x32_bf16 v[112:115], v[52:55], v[32:35], v[112:115]
  v_mfma_f32_16x16x32_bf16 v[116:119], v[56:59], v[32:35], v[116:119]
  v_mfma_f32_16x16x32_bf16 v[120:123], v[40:43], v[36:39], v[120:123]
  v_mfma_f32_16x16x32_bf16 v[124:127], v[44:47], v[36:39], v[124:127]
  v_mfma_f32_16x16x32_bf16 v[128:131], v[48:51], v[36:39], v[128:131]
  v_mfma_f32_16x16x32_bf16 v[132:135], v[52:55], v[36:39], v[132:135]
  v_mfma_f32_16x16x32_bf16 v[136:139], v[56:59], v[36:39], v[136:139]
  s_sub_u32 s22, s22, 1
  s_cmp_lg_u32 s22, 0
  s_cbranch_scc1 L_loop_g4a_kernel
  s_waitcnt vmcnt(0)
  v_lshlrev_b32 v15, 4, v1
  v_add_u32 v15, s21, v15
  ds_write_b128 v15, v[60:63] offset:0
  ds_write_b128 v15, v[64:67] offset:1024
  ds_write_b128 v15, v[68:71] offset:2048
  ds_write_b128 v15, v[72:75] offset:3072
  ds_write_b128 v15, v[76:79] offset:4096
  ds_write_b128 v15, v[80:83] offset:5120
  ds_write_b128 v15, v[84:87] offset:6144
  ds_write_b128 v15, v[88:91] offset:7168
  ds_write_b128 v15, v[92:95] offset:8192
  ds_write_b128 v15, v[96:99] offset:9216
  ds_write_b128 v15, v[100:103] offset:10240
  ds_write_b128 v15, v[104:107] offset:11264
  ds_write_b128 v15, v[108:111] offset:12288
  ds_write_b128 v15, v[112:115] offset:13312
  ds_write_b128 v15, v[116:119] offset:14336
  ds_write_b128 v15, v[120:123] offset:15360
  ds_write_b128 v15, v[124:127] offset:16384
  ds_write_b128 v15, v[128:131] offset:17408
  ds_write_b128 v15, v[132:135] offset:18432
  ds_write_b128 v15, v[136:139] offset:19456
  s_waitcnt lgkmcnt(0)
  s_barrier
  v_lshlrev_b32 v15, 4, v1
  s_mul_i32 s27, s20, 5120
  v_add_u32 v15, s27, v15
  v_add_u32 v16, 36864, v15
  v_add_u32 v17, 73728, v15
  v_add_u32 v18, 110592, v15
  ds_read_b128 v[60:63], v15 offset:0
  ds_read_b128 v[64:67], v15 offset:1024
  ds_read_b128 v[68:71], v15 offset:2048
  ds_read_b128 v[72:75], v15 offset:3072
  ds_read_b128 v[76:79], v15 offset:4096
  ds_read_b128 v[80:83], v16 offset:0
  ds_read_b128 v[84:87], v16 offset:1024
  ds_read_b128 v[88:91], v16 offset:2048
  ds_read_b128 v[92:95], v16 offset:3072
  ds_read_b128 v[96:99], v16 offset:4096
  ds_read_b128 v[100:103], v17 offset:0
  ds_read_b128 v[104:107], v17 offset:1024
  ds_read_b128 v[108:111], v17 offset:2048
  ds_read_b128 v[112:115], v17 offset:3072
  ds_read_b128 v[116:119], v17 offset:4096
  ds_read_b128 v[120:123], v18 offset:0
  ds_read_b128 v[124:127], v18 offset:1024
  ds_read_b128 v[128:131], v18 offset:2048
  ds_read_b128 v[132:135], v18 offset:3072
  ds_read_b128 v[136:139], v18 offset:4096
  s_waitcnt lgkmcnt(0)
  v_add_f32 v60, v60, v80
  v_add_f32 v61, v61, v81
  v_add_f32 v62, v62, v82
  v_add_f32 v63, v63, v83
  v_add_f32 v64, v64, v84
  v_add_f32 v65, v65, v85
  v_add_f32 v66, v66, v86
  v_add_f32 v67, v67, v87
  v_add_f32 v68, v68, v88
  v_add_f32 v69, v69, v89
  v_add_f32 v70, v70, v90
  v_add_f32 v71, v71, v91
  v_add_f32 v72, v72, v92
  v_add_f32 v73, v73, v93
  v_add_f32 v74, v74, v94
  v_add_f32 v75, v75, v95
  v_add_f32 v76, v76, v96
  v_add_f32 v77, v77, v97
  v_add_f32 v78, v78, v98
  v_add_f32 v79, v79, v99
  v_add_f32 v60, v60, v100
  v_add_f32 v61, v61, v101
  v_add_f32 v62, v62, v102
  v_add_f32 v63, v63, v103
  v_add_f32 v64, v64, v104
  v_add_f32 v65, v65, v105
  v_add_f32 v66, v66, v106
  v_add_f32 v67, v67, v107
  v_add_f32 v68, v68, v108
  v_add_f32 v69, v69, v109
  v_add_f32 v70, v70, v110
  v_add_f32 v71, v71, v111
  v_add_f32 v72, v72, v112
  v_add_f32 v73, v73, v113
  v_add_f32 v74, v74, v114
  v_add_f32 v75, v75, v115
  v_add_f32 v76, v76, v116
  v_add_f32 v77, v77, v117
  v_add_f32 v78, v78, v118
  v_add_f32 v79, v79, v119
  v_add_f32 v60, v60, v120
  v_add_f32 v61, v61, v121
  v_add_f32 v62, v62, v122
  v_add_f32 v63, v63, v123
  v_add_f32 v64, v64, v124
  v_add_f32 v65, v65, v125
  v_add_f32 v66, v66, v126
  v_add_f32 v67, v67, v127
  v_add_f32 v68, v68, v128
  v_add_f32 v69, v69, v129
  v_add_f32 v70, v70, v130
  v_add_f32 v71, v71, v131
  v_add_f32 v72, v72, v132
  v_add_f32 v73, v73, v133
  v_add_f32 v74, v74, v134
  v_add_f32 v75, v75, v135
  v_add_f32 v76, v76, v136
  v_add_f32 v77, v77, v137
  v_add_f32 v78, v78, v138
  v_add_f32 v79, v79, v139
  s_waitcnt vmcnt(0)
  v_mov_b32 v100, 0xffff0000
  v_lshlrev_b32 v17, 16, v154
  v_and_b32 v18, v100, v154
  v_add_f32 v60, v60, v17
  v_add_f32 v61, v61, v18
  v_cvt_pk_bf16_f32 v80, v60, v61
  v_lshlrev_b32 v17, 16, v155
  v_and_b32 v18, v100, v155
  v_add_f32 v62, v62, v17
  v_add_f32 v63, v63, v18
  v_cvt_pk_bf16_f32 v81, v62, v63
  buffer_store_dwordx2 v[80:81], v23, s[12:15], 0 offen offset:0
  v_lshlrev_b32 v17, 16, v156
  v_and_b32 v18, v100, v156
  v_add_f32 v64, v64, v17
  v_add_f32 v65, v65, v18
  v_cvt_pk_bf16_f32 v82, v64, v65
  v_lshlrev_b32 v17, 16, v157
  v_and_b32 v18, v100, v157
  v_add_f32 v66, v66, v17
  v_add_f32 v67, v67, v18
  v_cvt_pk_bf16_f32 v83, v66, v67
  buffer_store_dwordx2 v[82:83], v23, s[12:15], 0 offen offset:32
  v_lshlrev_b32 v17, 16, v158
  v_and_b32 v18, v100, v158
  v_add_f32 v68, v68, v17
  v_add_f32 v69, v69, v18
  v_cvt_pk_bf16_f32 v84, v68, v69
  v_lshlrev_b32 v17, 16, v159
  v_and_b32 v18, v100, v159
  v_add_f32 v70, v70, v17
  v_add_f32 v71, v71, v18
  v_cvt_pk_bf16_f32 v85, v70, v71
  buffer_store_dwordx2 v[84:85], v23, s[12:15], 0 offen offset:64
  v_lshlrev_b32 v17, 16, v160
  v_and_b32 v18, v100, v160
  v_add_f32 v72, v72, v17
  v_add_f32 v73, v73, v18
  v_cvt_pk_bf16_f32 v86, v72, v73
  v_lshlrev_b32 v17, 16, v161
  v_and_b32 v18, v100, v161
  v_add_f32 v74, v74, v17
  v_add_f32 v75, v75, v18
  v_cvt_pk_bf16_f32 v87, v74, v75
  buffer_store_dwordx2 v[86:87], v23, s[12:15], 0 offen offset:96
  v_lshlrev_b32 v17, 16, v162
  v_and_b32 v18, v100, v162
  v_add_f32 v76, v76, v17
  v_add_f32 v77, v77, v18
  v_cvt_pk_bf16_f32 v88, v76, v77
  v_lshlrev_b32 v17, 16, v163
  v_and_b32 v18, v100, v163
  v_add_f32 v78, v78, v17
  v_add_f32 v79, v79, v18
  v_cvt_pk_bf16_f32 v89, v78, v79
  buffer_store_dwordx2 v[88:89], v23, s[12:15], 0 offen offset:128
L_end_g4a_kernel:
  s_endpgm
.globl g1b_kernel
.p2align 8
.type g1b_kernel,@function
g1b_kernel:
  s_cmp_ge_u32 s2, 288
  s_cbranch_scc1 L_end_g1b_kernel
  s_load_dwordx2 s[32:33], s[0:1], 88
  s_load_dwordx2 s[34:35], s[0:1], 0
  s_load_dwordx2 s[36:37], s[0:1], 8
  s_load_dwordx2 s[38:39], s[0:1], 16
  s_load_dwordx2 s[40:41], s[0:1], 24
  v_lshrrev_b32 v15, 6, v0
  v_and_b32 v1, 63, v0
  v_readfirstlane_b32 s20, v15
  s_and_b32 s28, s2, 7
  s_lshr_b32 s30, s2, 3
  s_and_b32 s27, s30, 3
  s_lshr_b32 s30, s30, 2
  s_lshl_b32 s28, s28, 2
  s_add_u32 s28, s28, s27
  s_lshl_b32 s28, s28, 6
  s_mul_i32 s29, s30, 80
  s_waitcnt lgkmcnt(0)
  s_add_u32 s42, s32, 9437184
  s_addc_u32 s43, s33, 0
  s_mov_b32 s4, s42
  s_mov_b32 s5, s43
  s_mov_b32 s6, 2621440
  s_mov_b32 s7, 0x00020000
  s_mov_b32 s8, s36
  s_mov_b32 s9, s37
  s_mov_b32 s10, 819200
  s_mov_b32 s11, 0x00020000
  s_add_u32 s42, s32, 0
  s_addc_u32 s43, s33, 0
  s_mov_b32 s12, s42
  s_mov_b32 s13, s43
  s_mov_b32 s14, 2621440
  s_mov_b32 s15, 0x00020000
  s_sub_u32 s22, 23, s20
  s_lshr_b32 s22, s22, 2
  s_mul_i32 s27, s20, 5
  s_min_u32 s23, s20, 0
  s_add_u32 s27, s27, s23
  s_lshl_b32 s23, s27, 6
  s_mul_i32 s24, s27, 40960
  s_mul_i32 s21, s20, 20480
  v_lshrrev_b32 v15, 2, v1
  v_lshrrev_b32 v16, 3, v1
  v_xor_b32 v16, v16, v1
  v_and_b32 v16, 3, v16
  v_add_u32 v15, s28, v15
  s_mov_b32 s27, 1280
  v_mul_lo_u32 v15, v15, s27
  v_lshl_add_u32 v2, v16, 4, v15
  v_add_u32 v3, 20480, v2
  v_add_u32 v4, 40960, v2
  v_add_u32 v5, 61440, v2
  v_add_u32 v15, 0, v1
  v_mul_u32_u24 v16, 6554, v15
  v_lshrrev_b32 v16, 16, v16
  v_mul_u32_u24 v17, 10, v16
  v_sub_u32 v17, v15, v17
  v_mul_u32_u24 v16, 1280, v16
  v_lshl_add_u32 v6, v17, 4, v16
  v_add_u32 v15, 64, v1
  v_mul_u32_u24 v16, 6554, v15
  v_lshrrev_b32 v16, 16, v16
  v_mul_u32_u24 v17, 10, v16
  v_sub_u32 v17, v15, v17
  v_mul_u32_u24 v16, 1280, v16
  v_lshl_add_u32 v7, v17, 4, v16
  v_add_u32 v15, 128, v1
  v_mul_u32_u24 v16, 6554, v15
  v_lshrrev_b32 v16, 16, v16
  v_mul_u32_u24 v17, 10, v16
  v_sub_u32 v17, v15, v17
  v_mul_u32_u24 v16, 1280, v16
  v_lshl_add_u32 v8, v17, 4, v16
  v_add_u32 v15, 192, v1
  v_mul_u32_u24 v16, 6554, v15
  v_lshrrev_b32 v16, 16, v16
  v_mul_u32_u24 v17, 10, v16
  v_sub_u32 v17, v15, v17
  v_mul_u32_u24 v16, 1280, v16
  v_lshl_add_u32 v9, v17, 4, v16
  v_add_u32 v15, 256, v1
  v_mul_u32_u24 v16, 6554, v15
  v_lshrrev_b32 v16, 16, v16
  v_mul_u32_u24 v17, 10, v16
  v_sub_u32 v17, v15, v17
  v_mul_u32_u24 v16, 1280, v16
  v_lshl_add_u32 v10, v17, 4, v16
  s_lshl_b32 s27, s29, 1
  v_add_u32 v6, s27, v6
  v_add_u32 v7, s27, v7
  v_add_u32 v8, s27, v8
  v_add_u32 v9, s27, v9
  v_add_u32 v10, s27, v10
  v_and_b32 v15, 15, v1
  v_lshrrev_b32 v16, 4, v1
  v_lshrrev_b32 v17, 1, v15
  v_xor_b32 v17, v17, v16
  v_and_b32 v17, 3, v17
  v_lshlrev_b32 v17, 4, v17
  v_lshl_add_u32 v11, v15, 6, v17
  v_add_u32 v11, s21, v11
  v_lshrrev_b32 v17, 2, v15
  v_lshl_add_u32 v17, v16, 3, v17
  v_mov_b32 v19, v17
  v_mul_u32_u24 v17, 160, v17
  v_and_b32 v18, 3, v1
  v_lshl_add_u32 v12, v18, 3, v17
  v_add_u32 v12, 4096, v12
  v_add_u32 v12, s21, v12
  v_mov_b32 v60, 0
  v_mov_b32 v61, 0
  v_mov_b32 v62, 0
  v_mov_b32 v63, 0
  v_mov_b32 v64, 0
  v_mov_b32 v65, 0
  v_mov_b32 v66, 0
  v_mov_b32 v67, 0
  v_mov_b32 v68, 0
  v_mov_b32 v69, 0
  v_mov_b32 v70, 0
  v_mov_b32 v71, 0
  v_mov_b32 v72, 0
  v_mov_b32 v73, 0
  v_mov_b32 v74, 0
  v_mov_b32 v75, 0
  v_mov_b32 v76, 0
  v_mov_b32 v77, 0
  v_mov_b32 v78, 0
  v_mov_b32 v79, 0
  v_mov_b32 v80, 0
  v_mov_b32 v81, 0
  v_mov_b32 v82, 0
  v_mov_b32 v83, 0
  v_mov_b32 v84, 0
  v_mov_b32 v85, 0
  v_mov_b32 v86, 0
  v_mov_b32 v87, 0
  v_mov_b32 v88, 0
  v_mov_b32 v89, 0
  v_mov_b32 v90, 0
  v_mov_b32 v91, 0
  v_mov_b32 v92, 0
  v_mov_b32 v93, 0
  v_mov_b32 v94, 0
  v_mov_b32 v95, 0
  v_mov_b32 v96, 0
  v_mov_b32 v97, 0
  v_mov_b32 v98, 0
  v_mov_b32 v99, 0
  v_mov_b32 v100, 0
  v_mov_b32 v101, 0
  v_mov_b32 v102, 0
  v_mov_b32 v103, 0
  v_mov_b32 v104, 0
  v_mov_b32 v105, 0
  v_mov_b32 v106, 0
  v_mov_b32 v107, 0
  v_mov_b32 v108, 0
  v_mov_b32 v109, 0
  v_mov_b32 v110, 0
  v_mov_b32 v111, 0
  v_mov_b32 v112, 0
  v_mov_b32 v113, 0
  v_mov_b32 v114, 0
  v_mov_b32 v115, 0
  v_mov_b32 v116, 0
  v_mov_b32 v117, 0
  v_mov_b32 v118, 0
  v_mov_b32 v119, 0
  v_mov_b32 v120, 0
  v_mov_b32 v121, 0
  v_mov_b32 v122, 0
  v_mov_b32 v123, 0
  v_mov_b32 v124, 0
  v_mov_b32 v125, 0
  v_mov_b32 v126, 0
  v_mov_b32 v127, 0
  v_mov_b32 v128, 0
  v_mov_b32 v129, 0
  v_mov_b32 v130, 0
  v_mov_b32 v131, 0
  v_mov_b32 v132, 0
  v_mov_b32 v133, 0
  v_mov_b32 v134, 0
  v_mov_b32 v135, 0
  v_mov_b32 v136, 0
  v_mov_b32 v137, 0
  v_mov_b32 v138, 0
  v_mov_b32 v139, 0
  v_mov_b32 v140, 0
  v_mov_b32 v141, 0
  v_mov_b32 v142, 0
  v_mov_b32 v143, 0
  v_mov_b32 v144, 0
  v_mov_b32 v145, 0
  v_mov_b32 v146, 0
  v_mov_b32 v147, 0
  v_mov_b32 v148, 0
  v_mov_b32 v149, 0
  v_mov_b32 v150, 0
  v_mov_b32 v151, 0
  v_mov_b32 v152, 0
  v_mov_b32 v153, 0x3f803f80
  s_mov_b32 s25, s21
  s_mov_b32 s26, 0
  s_cmp_eq_u32 s30, 8
  s_cbranch_scc1 L_kv_g1b_kernel
  s_add_u32 m0, s25, 0
  s_nop 0
  buffer_load_dwordx4 v2, s[4:7], s23 offen lds
  s_add_u32 m0, s25, 1024
  s_nop 0
  buffer_load_dwordx4 v3, s[4:7], s23 offen lds
  s_add_u32 m0, s25, 2048
  s_nop 0
  buffer_load_dwordx4 v4, s[4:7], s23 offen lds
  s_add_u32 m0, s25, 3072
  s_nop 0
  buffer_load_dwordx4 v5, s[4:7], s23 offen lds
  s_add_u32 m0, s25, 4096
  s_nop 0
  buffer_load_dwordx4 v6, s[8:11], s24 offen lds
  s_add_u32 m0, s25, 5120
  s_nop 0
  buffer_load_dwordx4 v7, s[8:11], s24 offen lds
  s_add_u32 m0, s25, 6144
  s_nop 0
  buffer_load_dwordx4 v8, s[8:11], s24 offen lds
  s_add_u32 m0, s25, 7168
  s_nop 0
  buffer_load_dwordx4 v9, s[8:11], s24 offen lds
  s_add_u32 m0, s25, 8192
  s_nop 0
  buffer_load_dwordx4 v10, s[8:11], s24 offen lds
  s_add_u32 s24, s24, 40960
  s_add_u32 s23, s23, 64
  s_add_u32 s25, s25, 9216
  s_add_u32 s27, s21, 18432
  s_cmp_ge_u32 s25, s27
  s_cselect_b32 s25, s21, s25
L_loop_g1b_kernel:
  s_add_u32 m0, s25, 0
  s_nop 0
  buffer_load_dwordx4 v2, s[4:7], s23 offen lds
  s_add_u32 m0, s25, 1024
  s_nop 0
  buffer_load_dwordx4 v3, s[4:7], s23 offen lds
  s_add_u32 m0, s25, 2048
  s_nop 0
  buffer_load_dwordx4 v4, s[4:7], s23 offen lds
  s_add_u32 m0, s25, 3072
  s_nop 0
  buffer_load_dwordx4 v5, s[4:7], s23 offen lds
  s_add_u32 m0, s25, 4096
  s_nop 0
  buffer_load_dwordx4 v6, s[8:11], s24 offen lds
  s_add_u32 m0, s25, 5120
  s_nop 0
  buffer_load_dwordx4 v7, s[8:11], s24 offen lds
  s_add_u32 m0, s25, 6144
  s_nop 0
  buffer_load_dwordx4 v8, s[8:11], s24 offen lds
  s_add_u32 m0, s25, 7168
  s_nop 0
  buffer_load_dwordx4 v9, s[8:11], s24 offen lds
  s_add_u32 m0, s25, 8192
  s_nop 0
  buffer_load_dwordx4 v10, s[8:11], s24 offen lds
  s_add_u32 s24, s24, 40960
  s_add_u32 s23, s23, 64
  s_add_u32 s25, s25, 9216
  s_add_u32 s27, s21, 18432
  s_cmp_ge_u32 s25, s27
  s_cselect_b32 s25, s21, s25
  s_waitcnt vmcnt(9)
  v_add_u32 v13, s26, v11
  v_add_u32 v14, s26, v12
  ds_read_b128 v[24:27], v13 offset:0
  ds_read_b128 v[28:31], v13 offset:1024
  ds_read_b128 v[32:35], v13 offset:2048
  ds_read_b128 v[36:39], v13 offset:3072
  ds_read_b64_tr_b16 v[40:41], v14 offset:0
  ds_read_b64_tr_b16 v[42:43], v14 offset:640
  ds_read_b64_tr_b16 v[44:45], v14 offset:32
  ds_read_b64_tr_b16 v[46:47], v14 offset:672
  ds_read_b64_tr_b16 v[48:49], v14 offset:64
  ds_read_b64_tr_b16 v[50:51], v14 offset:704
  ds_read_b64_tr_b16 v[52:53], v14 offset:96
  ds_read_b64_tr_b16 v[54:55], v14 offset:736
  ds_read_b64_tr_b16 v[56:57], v14 offset:128
  ds_read_b64_tr_b16 v[58:59], v14 offset:768
  s_add_u32 s26, s26, 9216
  s_cmp_ge_u32 s26, 18432
  s_cselect_b32 s26, 0, s26
  s_waitcnt lgkmcnt(0)
  v_mfma_f32_16x16x32_bf16 v[60:63], v[40:43], v[24:27], v[60:63]
  v_mfma_f32_16x16x32_bf16 v[64:67], v[44:47], v[24:27], v[64:67]
  v_mfma_f32_16x16x32_bf16 v[68:71], v[48:51], v[24:27], v[68:71]
  v_mfma_f32_16x16x32_bf16 v[72:75], v[52:55], v[24:27], v[72:75]
  v_mfma_f32_16x16x32_bf16 v[76:79], v[56:59], v[24:27], v[76:79]
  v_mfma_f32_16x16x32_bf16 v[80:83], v[40:43], v[28:31], v[80:83]
  v_mfma_f32_16x16x32_bf16 v[84:87], v[44:47], v[28:31], v[84:87]
  v_mfma_f32_16x16x32_bf16 v[88:91], v[48:51], v[28:31], v[88:91]
  v_mfma_f32_16x16x32_bf16 v[92:95], v[52:55], v[28:31], v[92:95]
  v_mfma_f32_16x16x32_bf16 v[96:99], v[56:59], v[28:31], v[96:99]
  v_mfma_f32_16x16x32_bf16 v[100:103], v[40:43], v[32:35], v[100:103]
  v_mfma_f32_16x16x32_bf16 v[104:107], v[44:47], v[32:35], v[104:107]
  v_mfma_f32_16x16x32_bf16 v[108:111], v[48:51], v[32:35], v[108:111]
  v_mfma_f32_16x16x32_bf16 v[112:115], v[52:55], v[32:35], v[112:115]
  v_mfma_f32_16x16x32_bf16 v[116:119], v[56:59], v[32:35], v[116:119]
  v_mfma_f32_16x16x32_bf16 v[120:123], v[40:43], v[36:39], v[120:123]
  v_mfma_f32_16x16x32_bf16 v[124:127], v[44:47], v[36:39], v[124:127]
  v_mfma_f32_16x16x32_bf16 v[128:131], v[48:51], v[36:39], v[128:131]
  v_mfma_f32_16x16x32_bf16 v[132:135], v[52:55], v[36:39], v[132:135]
  v_mfma_f32_16x16x32_bf16 v[136:139], v[56:59], v[36:39], v[136:139]
  v_dot2_f32_bf16 v140, v24, v153, v140
  v_dot2_f32_bf16 v144, v24, v24, v144
  v_dot2_f32_bf16 v140, v25, v153, v140
  v_dot2_f32_bf16 v144, v25, v25, v144
  v_dot2_f32_bf16 v140, v26, v153, v140
  v_dot2_f32_bf16 v144, v26, v26, v144
  v_dot2_f32_bf16 v140, v27, v153, v140
  v_dot2_f32_bf16 v144, v27, v27, v144
  v_dot2_f32_bf16 v141, v28, v153, v141
  v_dot2_f32_bf16 v145, v28, v28, v145
  v_dot2_f32_bf16 v141, v29, v153, v141
  v_dot2_f32_bf16 v145, v29, v29, v145
  v_dot2_f32_bf16 v141, v30, v153, v141
  v_dot2_f32_bf16 v145, v30, v30, v145
  v_dot2_f32_bf16 v141, v31, v153, v141
  v_dot2_f32_bf16 v145, v31, v31, v145
  v_dot2_f32_bf16 v142, v32, v153, v142
  v_dot2_f32_bf16 v146, v32, v32, v146
  v_dot2_f32_bf16 v142, v33, v153, v142
  v_dot2_f32_bf16 v146, v33, v33, v146
  v_dot2_f32_bf16 v142, v34, v153, v142
  v_dot2_f32_bf16 v146, v34, v34, v146
  v_dot2_f32_bf16 v142, v35, v153, v142
  v_dot2_f32_bf16 v146, v35, v35, v146
  v_dot2_f32_bf16 v143, v36, v153, v143
  v_dot2_f32_bf16 v147, v36, v36, v147
  v_dot2_f32_bf16 v143, v37, v153, v143
  v_dot2_f32_bf16 v147, v37, v37, v147
  v_dot2_f32_bf16 v143, v38, v153, v143
  v_dot2_f32_bf16 v147, v38, v38, v147
  v_dot2_f32_bf16 v143, v39, v153, v143
  v_dot2_f32_bf16 v147, v39, v39, v147
  v_dot2_f32_bf16 v148, v40, v153, v148
  v_dot2_f32_bf16 v148, v41, v153, v148
  v_dot2_f32_bf16 v148, v42, v153, v148
  v_dot2_f32_bf16 v148, v43, v153, v148
  v_dot2_f32_bf16 v149, v44, v153, v149
  v_dot2_f32_bf16 v149, v45, v153, v149
  v_dot2_f32_bf16 v149, v46, v153, v149
  v_dot2_f32_bf16 v149, v47, v153, v149
  v_dot2_f32_bf16 v150, v48, v153, v150
  v_dot2_f32_bf16 v150, v49, v153, v150
  v_dot2_f32_bf16 v150, v50, v153, v150
  v_dot2_f32_bf16 v150, v51, v153, v150
  v_dot2_f32_bf16 v151, v52, v153, v151
  v_dot2_f32_bf16 v151, v53, v153, v151
  v_dot2_f32_bf16 v151, v54, v153, v151
  v_dot2_f32_bf16 v151, v55, v153, v151
  v_dot2_f32_bf16 v152, v56, v153, v152
  v_dot2_f32_bf16 v152, v57, v153, v152
  v_dot2_f32_bf16 v152, v58, v153, v152
  v_dot2_f32_bf16 v152, v59, v153, v152
  s_sub_u32 s22, s22, 1
  s_cmp_lg_u32 s22, 0
  s_cbranch_scc1 L_loop_g1b_kernel
  s_branch L_red_g1b_kernel
L_kv_g1b_kernel:
  s_mov_b32 s8, s38
  s_mov_b32 s9, s39
  s_mov_b32 s10, 25600
  s_mov_b32 s11, 0x00020000
  s_mov_b32 s48, s40
  s_mov_b32 s49, s41
  s_mov_b32 s50, 25600
  s_mov_b32 s51, 0x00020000
  v_lshlrev_b32 v6, 4, v1
  v_add_u32 v7, 1024, v6
  s_mul_i32 s27, s20, 5
  s_mul_i32 s24, s27, 1280
  v_mul_u32_u24 v17, 40, v19
  v_lshl_add_u32 v12, v18, 3, v17
  v_add_u32 v12, 4096, v12
  v_add_u32 v12, s21, v12
  s_add_u32 m0, s25, 0
  s_nop 0
  buffer_load_dwordx4 v2, s[4:7], s23 offen lds
  s_add_u32 m0, s25, 1024
  s_nop 0
  buffer_load_dwordx4 v3, s[4:7], s23 offen lds
  s_add_u32 m0, s25, 2048
  s_nop 0
  buffer_load_dwordx4 v4, s[4:7], s23 offen lds
  s_add_u32 m0, s25, 3072
  s_nop 0
  buffer_load_dwordx4 v5, s[4:7], s23 offen lds
  s_add_u32 m0, s25, 4096
  s_nop 0
  buffer_load_dwordx4 v6, s[8:11], s24 offen lds
  s_add_u32 m0, s25, 5120
  s_nop 0
  buffer_load_dwordx4 v7, s[8:11], s24 offen lds
  s_add_u32 m0, s25, 6144
  s_nop 0
  buffer_load_dwordx4 v6, s[48:51], s24 offen lds
  s_add_u32 m0, s25, 7168
  s_nop 0
  buffer_load_dwordx4 v7, s[48:51], s24 offen lds
  s_add_u32 s24, s24, 1280
  s_add_u32 s23, s23, 64
  s_add_u32 s25, s25, 9216
  s_add_u32 s27, s21, 18432
  s_cmp_ge_u32 s25, s27
  s_cselect_b32 s25, s21, s25
L_loopkv_g1b_kernel:
  s_add_u32 m0, s25, 0
  s_nop 0
  buffer_load_dwordx4 v2, s[4:7], s23 offen lds
  s_add_u32 m0, s25, 1024
  s_nop 0
  buffer_load_dwordx4 v3, s[4:7], s23 offen lds
  s_add_u32 m0, s25, 2048
  s_nop 0
  buffer_load_dwordx4 v4, s[4:7], s23 offen lds
  s_add_u32 m0, s25, 3072
  s_nop 0
  buffer_load_dwordx4 v5, s[4:7], s23 offen lds
  s_add_u32 m0, s25, 4096
  s_nop 0
  buffer_load_dwordx4 v6, s[8:11], s24 offen lds
  s_add_u32 m0, s25, 5120
  s_nop 0
  buffer_load_dwordx4 v7, s[8:11], s24 offen lds
  s_add_u32 m0, s25, 6144
  s_nop 0
  buffer_load_dwordx4 v6, s[48:51], s24 offen lds
  s_add_u32 m0, s25, 7168
  s_nop 0
  buffer_load_dwordx4 v7, s[48:51], s24 offen lds
  s_add_u32 s24, s24, 1280
  s_add_u32 s23, s23, 64
  s_add_u32 s25, s25, 9216
  s_add_u32 s27, s21, 18432
  s_cmp_ge_u32 s25, s27
  s_cselect_b32 s25, s21, s25
  s_waitcnt vmcnt(8)
  v_add_u32 v13, s26, v11
  v_add_u32 v14, s26, v12
  ds_read_b128 v[24:27], v13 offset:0
  ds_read_b128 v[28:31], v13 offset:1024
  ds_read_b128 v[32:35], v13 offset:2048
  ds_read_b128 v[36:39], v13 offset:3072
  ds_read_b64_tr_b16 v[40:41], v14 offset:0
  ds_read_b64_tr_b16 v[42:43], v14 offset:160
  ds_read_b64_tr_b16 v[44:45], v14 offset:32
  ds_read_b64_tr_b16 v[46:47], v14 offset:192
  ds_read_b64_tr_b16 v[48:49], v14 offset:2048
  ds_read_b64_tr_b16 v[50:51], v14 offset:2208
  ds_read_b64_tr_b16 v[52:53], v14 offset:2080
  ds_read_b64_tr_b16 v[54:55], v14 offset:2240
  s_add_u32 s26, s26, 9216
  s_cmp_ge_u32 s26, 18432
  s_cselect_b32 s26, 0, s26
  s_waitcnt lgkmcnt(0)
  v_mfma_f32_16x16x32_bf16 v[60:63], v[40:43], v[24:27], v[60:63]
  v_mfma_f32_16x16x32_bf16 v[64:67], v[44:47], v[24:27], v[64:67]
  v_mfma_f32_16x16x32_bf16 v[68:71], v[48:51], v[24:27], v[68:71]
  v_mfma_f32_16x16x32_bf16 v[72:75], v[52:55], v[24:27], v[72:75]
  v_mfma_f32_16x16x32_bf16 v[80:83], v[40:43], v[28:31], v[80:83]
  v_mfma_f32_16x16x32_bf16 v[84:87], v[44:47], v[28:31], v[84:87]
  v_mfma_f32_16x16x32_bf16 v[88:91], v[48:51], v[28:31], v[88:91]
  v_mfma_f32_16x16x32_bf16 v[92:95], v[52:55], v[28:31], v[92:95]
  v_mfma_f32_16x16x32_bf16 v[100:103], v[40:43], v[32:35], v[100:103]
  v_mfma_f32_16x16x32_bf16 v[104:107], v[44:47], v[32:35], v[104:107]
  v_mfma_f32_16x16x32_bf16 v[108:111], v[48:51], v[32:35], v[108:111]
  v_mfma_f32_16x16x32_bf16 v[112:115], v[52:55], v[32:35], v[112:115]
  v_mfma_f32_16x16x32_bf16 v[120:123], v[40:43], v[36:39], v[120:123]
  v_mfma_f32_16x16x32_bf16 v[124:127], v[44:47], v[36:39], v[124:127]
  v_mfma_f32_16x16x32_bf16 v[128:131], v[48:51], v[36:39], v[128:131]
  v_mfma_f32_16x16x32_bf16 v[132:135], v[52:55], v[36:39], v[132:135]
  v_dot2_f32_bf16 v140, v24, v153, v140
  v_dot2_f32_bf16 v144, v24, v24, v144
  v_dot2_f32_bf16 v140, v25, v153, v140
  v_dot2_f32_bf16 v144, v25, v25, v144
  v_dot2_f32_bf16 v140, v26, v153, v140
  v_dot2_f32_bf16 v144, v26, v26, v144
  v_dot2_f32_bf16 v140, v27, v153, v140
  v_dot2_f32_bf16 v144, v27, v27, v144
  v_dot2_f32_bf16 v141, v28, v153, v141
  v_dot2_f32_bf16 v145, v28, v28, v145
  v_dot2_f32_bf16 v141, v29, v153, v141
  v_dot2_f32_bf16 v145, v29, v29, v145
  v_dot2_f32_bf16 v141, v30, v153, v141
  v_dot2_f32_bf16 v145, v30, v30, v145
  v_dot2_f32_bf16 v141, v31, v153, v141
  v_dot2_f32_bf16 v145, v31, v31, v145
  v_dot2_f32_bf16 v142, v32, v153, v142
  v_dot2_f32_bf16 v146, v32, v32, v146
  v_dot2_f32_bf16 v142, v33, v153, v142
  v_dot2_f32_bf16 v146, v33, v33, v146
  v_dot2_f32_bf16 v142, v34, v153, v142
  v_dot2_f32_bf16 v146, v34, v34, v146
  v_dot2_f32_bf16 v142, v35, v153, v142
  v_dot2_f32_bf16 v146, v35, v35, v146
  v_dot2_f32_bf16 v143, v36, v153, v143
  v_dot2_f32_bf16 v147, v36, v36, v147
  v_dot2_f32_bf16 v143, v37, v153, v143
  v_dot2_f32_bf16 v147, v37, v37, v147
  v_dot2_f32_bf16 v143, v38, v153, v143
  v_dot2_f32_bf16 v147, v38, v38, v147
  v_dot2_f32_bf16 v143, v39, v153, v143
  v_dot2_f32_bf16 v147, v39, v39, v147
  v_dot2_f32_bf16 v148, v40, v153, v148
  v_dot2_f32_bf16 v148, v41, v153, v148
  v_dot2_f32_bf16 v148, v42, v153, v148
  v_dot2_f32_bf16 v148, v43, v153, v148
  v_dot2_f32_bf16 v149, v44, v153, v149
  v_dot2_f32_bf16 v149, v45, v153, v149
  v_dot2_f32_bf16 v149, v46, v153, v149
  v_dot2_f32_bf16 v149, v47, v153, v149
  v_dot2_f32_bf16 v150, v48, v153, v150
  v_dot2_f32_bf16 v150, v49, v153, v150
  v_dot2_f32_bf16 v150, v50, v153, v150
  v_dot2_f32_bf16 v150, v51, v153, v150
  v_dot2_f32_bf16 v151, v52, v153, v151
  v_dot2_f32_bf16 v151, v53, v153, v151
  v_dot2_f32_bf16 v151, v54, v153, v151
  v_dot2_f32_bf16 v151, v55, v153, v151
  s_sub_u32 s22, s22, 1
  s_cmp_lg_u32 s22, 0
  s_cbranch_scc1 L_loopkv_g1b_kernel
L_red_g1b_kernel:
  s_waitcnt vmcnt(0)
  v_lshlrev_b32 v15, 4, v1
  v_add_u32 v15, s21, v15
  ds_write_b128 v15, v[60:63] offset:0
  ds_write_b128 v15, v[64:67] offset:1024
  ds_write_b128 v15, v[68:71] offset:2048
  ds_write_b128 v15, v[72:75] offset:3072
  ds_write_b128 v15, v[76:79] offset:4096
  ds_write_b128 v15, v[80:83] offset:5120
  ds_write_b128 v15, v[84:87] offset:6144
  ds_write_b128 v15, v[88:91] offset:7168
  ds_write_b128 v15, v[92:95] offset:8192
  ds_write_b128 v15, v[96:99] offset:9216
  ds_write_b128 v15, v[100:103] offset:10240
  ds_write_b128 v15, v[104:107] offset:11264
  ds_write_b128 v15, v[108:111] offset:12288
  ds_write_b128 v15, v[112:115] offset:13312
  ds_write_b128 v15, v[116:119] offset:14336
  ds_write_b128 v15, v[120:123] offset:15360
  ds_write_b128 v15, v[124:127] offset:16384
  ds_write_b128 v15, v[128:131] offset:17408
  ds_write_b128 v15, v[132:135] offset:18432
  ds_write_b128 v15, v[136:139] offset:19456
  s_mul_i32 s27, s20, 5120
  s_add_u32 s27, s27, s21
  v_lshlrev_b32 v16, 2, v1
  v_add_u32 v16, s27, v16
  ds_write_b32 v16, v140 offset:0
  ds_write_b32 v16, v141 offset:256
  ds_write_b32 v16, v142 offset:512
  ds_write_b32 v16, v143 offset:768
  ds_write_b32 v16, v144 offset:1024
  ds_write_b32 v16, v145 offset:1280
  ds_write_b32 v16, v146 offset:1536
  ds_write_b32 v16, v147 offset:1792
  ds_write_b32 v16, v148 offset:2048
  ds_write_b32 v16, v149 offset:2304
  ds_write_b32 v16, v150 offset:2560
  ds_write_b32 v16, v151 offset:2816
  ds_write_b32 v16, v152 offset:3072
  s_cmp_lg_u32 s20, 1
  s_cbranch_scc1 L_own1_g1b_kernel
  v_mov_b32 v60, v80
  v_mov_b32 v61, v81
  v_mov_b32 v62, v82
  v_mov_b32 v63, v83
  v_mov_b32 v64, v84
  v_mov_b32 v65, v85
  v_mov_b32 v66, v86
  v_mov_b32 v67, v87
  v_mov_b32 v68, v88
  v_mov_b32 v69, v89
  v_mov_b32 v70, v90
  v_mov_b32 v71, v91
  v_mov_b32 v72, v92
  v_mov_b32 v73, v93
  v_mov_b32 v74, v94
  v_mov_b32 v75, v95
  v_mov_b32 v76, v96
  v_mov_b32 v77, v97
  v_mov_b32 v78, v98
  v_mov_b32 v79, v99
L_own1_g1b_kernel:
  s_cmp_lg_u32 s20, 2
  s_cbranch_scc1 L_own2_g1b_kernel
  v_mov_b32 v60, v100
  v_mov_b32 v61, v101
  v_mov_b32 v62, v102
  v_mov_b32 v63, v103
  v_mov_b32 v64, v104
  v_mov_b32 v65, v105
  v_mov_b32 v66, v106
  v_mov_b32 v67, v107
  v_mov_b32 v68, v108
  v_mov_b32 v69, v109
  v_mov_b32 v70, v110
  v_mov_b32 v71, v111
  v_mov_b32 v72, v112
  v_mov_b32 v73, v113
  v_mov_b32 v74, v114
  v_mov_b32 v75, v115
  v_mov_b32 v76, v116
  v_mov_b32 v77, v117
  v_mov_b32 v78, v118
  v_mov_b32 v79, v119
L_own2_g1b_kernel:
  s_cmp_lg_u32 s20, 3
  s_cbranch_scc1 L_own3_g1b_kernel
  v_mov_b32 v60, v120
  v_mov_b32 v61, v121
  v_mov_b32 v62, v122
  v_mov_b32 v63, v123
  v_mov_b32 v64, v124
  v_mov_b32 v65, v125
  v_mov_b32 v66, v126
  v_mov_b32 v67, v127
  v_mov_b32 v68, v128
  v_mov_b32 v69, v129
  v_mov_b32 v70, v130
  v_mov_b32 v71, v131
  v_mov_b32 v72, v132
  v_mov_b32 v73, v133
  v_mov_b32 v74, v134
  v_mov_b32 v75, v135
  v_mov_b32 v76, v136
  v_mov_b32 v77, v137
  v_mov_b32 v78, v138
  v_mov_b32 v79, v139
L_own3_g1b_kernel:
  s_waitcnt lgkmcnt(0)
  s_barrier
  v_lshlrev_b32 v15, 4, v1
  s_mul_i32 s27, s20, 5120
  v_add_u32 v15, s27, v15
  v_add_u32 v16, 20480, v15
  v_add_u32 v17, 40960, v15
  v_add_u32 v18, 61440, v15
  s_add_u32 s27, s20, 1
  s_and_b32 s27, s27, 3
  s_mul_i32 s27, s27, 20480
  v_add_u32 v16, s27, v15
  s_add_u32 s27, s20, 2
  s_and_b32 s27, s27, 3
  s_mul_i32 s27, s27, 20480
  v_add_u32 v17, s27, v15
  s_add_u32 s27, s20, 3
  s_and_b32 s27, s27, 3
  s_mul_i32 s27, s27, 20480
  v_add_u32 v18, s27, v15
  ds_read_b128 v[80:83], v16 offset:0
  ds_read_b128 v[84:87], v16 offset:1024
  ds_read_b128 v[88:91], v16 offset:2048
  ds_read_b128 v[92:95], v16 offset:3072
  ds_read_b128 v[96:99], v16 offset:4096
  ds_read_b128 v[100:103], v17 offset:0
  ds_read_b128 v[104:107], v17 offset:1024
  ds_read_b128 v[108:111], v17 offset:2048
  ds_read_b128 v[112:115], v17 offset:3072
  ds_read_b128 v[116:119], v17 offset:4096
  ds_read_b128 v[120:123], v18 offset:0
  ds_read_b128 v[124:127], v18 offset:1024
  ds_read_b128 v[128:131], v18 offset:2048
  ds_read_b128 v[132:135], v18 offset:3072
  ds_read_b128 v[136:139], v18 offset:4096
  v_lshlrev_b32 v19, 2, v1
  s_lshl_b32 s27, s20, 8
  v_add_u32 v19, s27, v19
  v_add_u32 v20, 0, v19
  ds_read_b32 v140, v20
  ds_read_b32 v144, v20 offset:1024
  v_add_u32 v20, 25600, v19
  ds_read_b32 v141, v20
  ds_read_b32 v145, v20 offset:1024
  v_add_u32 v20, 51200, v19
  ds_read_b32 v142, v20
  ds_read_b32 v146, v20 offset:1024
  v_add_u32 v20, 76800, v19
  ds_read_b32 v143, v20
  ds_read_b32 v147, v20 offset:1024
  v_lshlrev_b32 v19, 2, v1
  v_add_u32 v20, 2048, v19
  ds_read_b32 v40, v20 offset:0
  ds_read_b32 v41, v20 offset:256
  ds_read_b32 v42, v20 offset:512
  ds_read_b32 v43, v20 offset:768
  ds_read_b32 v44, v20 offset:1024
  v_add_u32 v20, 27648, v19
  ds_read_b32 v45, v20 offset:0
  ds_read_b32 v46, v20 offset:256
  ds_read_b32 v47, v20 offset:512
  ds_read_b32 v48, v20 offset:768
  ds_read_b32 v49, v20 offset:1024
  v_add_u32 v20, 53248, v19
  ds_read_b32 v50, v20 offset:0
  ds_read_b32 v51, v20 offset:256
  ds_read_b32 v52, v20 offset:512
  ds_read_b32 v53, v20 offset:768
  ds_read_b32 v54, v20 offset:1024
  v_add_u32 v20, 78848, v19
  ds_read_b32 v55, v20 offset:0
  ds_read_b32 v56, v20 offset:256
  ds_read_b32 v57, v20 offset:512
  ds_read_b32 v58, v20 offset:768
  ds_read_b32 v59, v20 offset:1024
  s_waitcnt lgkmcnt(0)
  v_add_f32 v60, v60, v80
  v_add_f32 v61, v61, v81
  v_add_f32 v62, v62, v82
  v_add_f32 v63, v63, v83
  v_add_f32 v64, v64, v84
  v_add_f32 v65, v65, v85
  v_add_f32 v66, v66, v86
  v_add_f32 v67, v67, v87
  v_add_f32 v68, v68, v88
  v_add_f32 v69, v69, v89
  v_add_f32 v70, v70, v90
  v_add_f32 v71, v71, v91
  v_add_f32 v72, v72, v92
  v_add_f32 v73, v73, v93
  v_add_f32 v74, v74, v94
  v_add_f32 v75, v75, v95
  v_add_f32 v76, v76, v96
  v_add_f32 v77, v77, v97
  v_add_f32 v78, v78, v98
  v_add_f32 v79, v79, v99
  v_add_f32 v60, v60, v100
  v_add_f32 v61, v61, v101
  v_add_f32 v62, v62, v102
  v_add_f32 v63, v63, v103
  v_add_f32 v64, v64, v104
  v_add_f32 v65, v65, v105
  v_add_f32 v66, v66, v106
  v_add_f32 v67, v67, v107
  v_add_f32 v68, v68, v108
  v_add_f32 v69, v69, v109
  v_add_f32 v70, v70, v110
  v_add_f32 v71, v71, v111
  v_add_f32 v72, v72, v112
  v_add_f32 v73, v73, v113
  v_add_f32 v74, v74, v114
  v_add_f32 v75, v75, v115
  v_add_f32 v76, v76, v116
  v_add_f32 v77, v77, v117
  v_add_f32 v78, v78, v118
  v_add_f32 v79, v79, v119
  v_add_f32 v60, v60, v120
  v_add_f32 v61, v61, v121
  v_add_f32 v62, v62, v122
  v_add_f32 v63, v63, v123
  v_add_f32 v64, v64, v124
  v_add_f32 v65, v65, v125
  v_add_f32 v66, v66, v126
  v_add_f32 v67, v67, v127
  v_add_f32 v68, v68, v128
  v_add_f32 v69, v69, v129
  v_add_f32 v70, v70, v130
  v_add_f32 v71, v71, v131
  v_add_f32 v72, v72, v132
  v_add_f32 v73, v73, v133
  v_add_f32 v74, v74, v134
  v_add_f32 v75, v75, v135
  v_add_f32 v76, v76, v136
  v_add_f32 v77, v77, v137
  v_add_f32 v78, v78, v138
  v_add_f32 v79, v79, v139
  v_add_f32 v140, v140, v141
  v_add_f32 v142, v142, v143
  v_add_f32 v140, v140, v142
  v_add_f32 v144, v144, v145
  v_add_f32 v146, v146, v147
  v_add_f32 v144, v144, v146
  v_mov_b32 v104, v140
  s_nop 1
  v_permlane16_swap_b32 v140, v104
  v_add_f32 v140, v140, v104
  v_mov_b32 v104, v140
  s_nop 1
  v_permlane32_swap_b32 v140, v104
  v_add_f32 v140, v140, v104
  v_mov_b32 v104, v144
  s_nop 1
  v_permlane16_swap_b32 v144, v104
  v_add_f32 v144, v144, v104
  v_mov_b32 v104, v144
  s_nop 1
  v_permlane32_swap_b32 v144, v104
  v_add_f32 v144, v144, v104
  v_add_f32 v40, v40, v45
  v_add_f32 v50, v50, v55
  v_add_f32 v40, v40, v50
  v_mov_b32 v104, v40
  s_nop 1
  v_permlane16_swap_b32 v40, v104
  v_add_f32 v40, v40, v104
  v_mov_b32 v104, v40
  s_nop 1
  v_permlane32_swap_b32 v40, v104
  v_add_f32 v40, v40, v104
  v_add_f32 v41, v41, v46
  v_add_f32 v51, v51, v56
  v_add_f32 v41, v41, v51
  v_mov_b32 v104, v41
  s_nop 1
  v_permlane16_swap_b32 v41, v104
  v_add_f32 v41, v41, v104
  v_mov_b32 v104, v41
  s_nop 1
  v_permlane32_swap_b32 v41, v104
  v_add_f32 v41, v41, v104
  v_add_f32 v42, v42, v47
  v_add_f32 v52, v52, v57
  v_add_f32 v42, v42, v52
  v_mov_b32 v104, v42
  s_nop 1
  v_permlane16_swap_b32 v42, v104
  v_add_f32 v42, v42, v104
  v_mov_b32 v104, v42
  s_nop 1
  v_permlane32_swap_b32 v42, v104
  v_add_f32 v42, v42, v104
  v_add_f32 v43, v43, v48
  v_add_f32 v53, v53, v58
  v_add_f32 v43, v43, v53
  v_mov_b32 v104, v43
  s_nop 1
  v_permlane16_swap_b32 v43, v104
  v_add_f32 v43, v43, v104
  v_mov_b32 v104, v43
  s_nop 1
  v_permlane32_swap_b32 v43, v104
  v_add_f32 v43, v43, v104
  v_add_f32 v44, v44, v49
  v_add_f32 v54, v54, v59
  v_add_f32 v44, v44, v54
  v_mov_b32 v104, v44
  s_nop 1
  v_permlane16_swap_b32 v44, v104
  v_add_f32 v44, v44, v104
  v_mov_b32 v104, v44
  s_nop 1
  v_permlane32_swap_b32 v44, v104
  v_add_f32 v44, v44, v104
  v_lshrrev_b32 v104, 4, v1
  v_lshlrev_b32 v104, 4, v104
  v_add_u32 v105, 0, v104
  ds_bpermute_b32 v84, v105, v40
  v_add_u32 v105, 4, v104
  ds_bpermute_b32 v85, v105, v40
  v_add_u32 v105, 8, v104
  ds_bpermute_b32 v86, v105, v40
  v_add_u32 v105, 12, v104
  ds_bpermute_b32 v87, v105, v40
  v_add_u32 v105, 0, v104
  ds_bpermute_b32 v88, v105, v41
  v_add_u32 v105, 4, v104
  ds_bpermute_b32 v89, v105, v41
  v_add_u32 v105, 8, v104
  ds_bpermute_b32 v90, v105, v41
  v_add_u32 v105, 12, v104
  ds_bpermute_b32 v91, v105, v41
  v_add_u32 v105, 0, v104
  ds_bpermute_b32 v92, v105, v42
  v_add_u32 v105, 4, v104
  ds_bpermute_b32 v93, v105, v42
  v_add_u32 v105, 8, v104
  ds_bpermute_b32 v94, v105, v42
  v_add_u32 v105, 12, v104
  ds_bpermute_b32 v95, v105, v42
  v_add_u32 v105, 0, v104
  ds_bpermute_b32 v96, v105, v43
  v_add_u32 v105, 4, v104
  ds_bpermute_b32 v97, v105, v43
  v_add_u32 v105, 8, v104
  ds_bpermute_b32 v98, v105, v43
  v_add_u32 v105, 12, v104
  ds_bpermute_b32 v99, v105, v43
  v_add_u32 v105, 0, v104
  ds_bpermute_b32 v100, v105, v44
  v_add_u32 v105, 4, v104
  ds_bpermute_b32 v101, v105, v44
  v_add_u32 v105, 8, v104
  ds_bpermute_b32 v102, v105, v44
  v_add_u32 v105, 12, v104
  ds_bpermute_b32 v103, v105, v44
  v_mul_f32 v80, 0x3acccccd, v140
  v_mul_f32 v106, 0x3acccccd, v144
  v_fma_f32 v106, -v80, v80, v106
  v_max_f32 v106, 0, v106
  v_cvt_pk_bf16_f32 v107, v106, v106
  v_lshlrev_b32 v106, 16, v107
  v_add_f32 v106, 0x3727c5ac, v106
  v_cvt_pk_bf16_f32 v107, v106, v106
  v_lshlrev_b32 v106, 16, v107
  v_sqrt_f32 v106, v106
  s_nop 0
  v_cvt_pk_bf16_f32 v107, v106, v106
  v_lshlrev_b32 v106, 16, v107
  v_rcp_f32 v81, v106
  v_cvt_pk_bf16_f32 v107, v80, v80
  v_lshlrev_b32 v80, 16, v107
  s_waitcnt lgkmcnt(0)
  v_fma_f32 v60, -v80, v84, v60
  v_mul_f32 v60, v60, v81
  v_fma_f32 v61, -v80, v85, v61
  v_mul_f32 v61, v61, v81
  v_fma_f32 v62, -v80, v86, v62
  v_mul_f32 v62, v62, v81
  v_fma_f32 v63, -v80, v87, v63
  v_mul_f32 v63, v63, v81
  v_fma_f32 v64, -v80, v88, v64
  v_mul_f32 v64, v64, v81
  v_fma_f32 v65, -v80, v89, v65
  v_mul_f32 v65, v65, v81
  v_fma_f32 v66, -v80, v90, v66
  v_mul_f32 v66, v66, v81
  v_fma_f32 v67, -v80, v91, v67
  v_mul_f32 v67, v67, v81
  v_fma_f32 v68, -v80, v92, v68
  v_mul_f32 v68, v68, v81
  v_fma_f32 v69, -v80, v93, v69
  v_mul_f32 v69, v69, v81
  v_fma_f32 v70, -v80, v94, v70
  v_mul_f32 v70, v70, v81
  v_fma_f32 v71, -v80, v95, v71
  v_mul_f32 v71, v71, v81
  v_fma_f32 v72, -v80, v96, v72
  v_mul_f32 v72, v72, v81
  v_fma_f32 v73, -v80, v97, v73
  v_mul_f32 v73, v73, v81
  v_fma_f32 v74, -v80, v98, v74
  v_mul_f32 v74, v74, v81
  v_fma_f32 v75, -v80, v99, v75
  v_mul_f32 v75, v75, v81
  v_fma_f32 v76, -v80, v100, v76
  v_mul_f32 v76, v76, v81
  v_fma_f32 v77, -v80, v101, v77
  v_mul_f32 v77, v77, v81
  v_fma_f32 v78, -v80, v102, v78
  v_mul_f32 v78, v78, v81
  v_fma_f32 v79, -v80, v103, v79
  v_mul_f32 v79, v79, v81
  v_and_b32 v15, 15, v1
  s_lshl_b32 s27, s20, 4
  s_add_u32 s27, s27, s28
  v_add_u32 v15, s27, v15
  v_lshrrev_b32 v16, 4, v1
  s_cmp_eq_u32 s30, 8
  s_cbranch_scc1 L_epikv_g1b_kernel
  v_mov_b32 v104, 0x3ea52b5c
  v_mul_f32 v60, v60, v104
  v_mul_f32 v61, v61, v104
  v_mul_f32 v62, v62, v104
  v_mul_f32 v63, v63, v104
  v_mul_f32 v64, v64, v104
  v_mul_f32 v65, v65, v104
  v_mul_f32 v66, v66, v104
  v_mul_f32 v67, v67, v104
  v_mul_f32 v68, v68, v104
  v_mul_f32 v69, v69, v104
  v_mul_f32 v70, v70, v104
  v_mul_f32 v71, v71, v104
  v_mul_f32 v72, v72, v104
  v_mul_f32 v73, v73, v104
  v_mul_f32 v74, v74, v104
  v_mul_f32 v75, v75, v104
  v_mul_f32 v76, v76, v104
  v_mul_f32 v77, v77, v104
  v_mul_f32 v78, v78, v104
  v_mul_f32 v79, v79, v104
  v_mul_u32_u24 v17, 1280, v15
  v_lshl_add_u32 v17, v16, 3, v17
  s_lshl_b32 s27, s29, 1
  v_add_u32 v17, s27, v17
  v_cvt_pk_bf16_f32 v124, v60, v61
  v_cvt_pk_bf16_f32 v125, v62, v63
  buffer_store_dwordx2 v[124:125], v17, s[12:15], 0 offen offset:0
  v_cvt_pk_bf16_f32 v126, v64, v65
  v_cvt_pk_bf16_f32 v127, v66, v67
  buffer_store_dwordx2 v[126:127], v17, s[12:15], 0 offen offset:32
  v_cvt_pk_bf16_f32 v128, v68, v69
  v_cvt_pk_bf16_f32 v129, v70, v71
  buffer_store_dwordx2 v[128:129], v17, s[12:15], 0 offen offset:64
  v_cvt_pk_bf16_f32 v130, v72, v73
  v_cvt_pk_bf16_f32 v131, v74, v75
  buffer_store_dwordx2 v[130:131], v17, s[12:15], 0 offen offset:96
  v_cvt_pk_bf16_f32 v132, v76, v77
  v_cvt_pk_bf16_f32 v133, v78, v79
  buffer_store_dwordx2 v[132:133], v17, s[12:15], 0 offen offset:128
  s_branch L_end_g1b_kernel
L_epikv_g1b_kernel:
  s_add_u32 s42, s32, 12582912
  s_addc_u32 s43, s33, 0
  s_mov_b32 s12, s42
  s_mov_b32 s13, s43
  s_mov_b32 s14, 262144
  s_mov_b32 s15, 0x00020000
  v_cmp_eq_u32 vcc, 1, v16
  s_nop 1
  v_cndmask_b32 v104, 0, 1.0, vcc
  v_cmp_eq_u32 vcc, 0, v16
  s_nop 1
  v_cndmask_b32 v64, v104, v64, vcc
  v_cndmask_b32 v65, 0, v65, vcc
  v_cndmask_b32 v66, 0, v66, vcc
  v_cndmask_b32 v67, 0, v67, vcc
  v_cndmask_b32 v72, v104, v72, vcc
  v_cndmask_b32 v73, 0, v73, vcc
  v_cndmask_b32 v74, 0, v74, vcc
  v_cndmask_b32 v75, 0, v75, vcc
  v_lshrrev_b32 v17, 5, v15
  v_lshlrev_b32 v17, 12, v17
  v_and_b32 v18, 31, v15
  v_lshrrev_b32 v19, 1, v16
  v_lshl_add_u32 v19, v19, 5, v18
  v_lshl_add_u32 v19, v19, 4, v17
  v_and_b32 v20, 1, v16
  v_lshl_add_u32 v19, v20, 3, v19
  v_cvt_pk_bf16_f32 v124, v60, v61
  v_cvt_pk_bf16_f32 v125, v62, v63
  buffer_store_dwordx2 v[124:125], v19, s[12:15], 0 offen offset:0
  v_cvt_pk_bf16_f32 v126, v64, v65
  v_cvt_pk_bf16_f32 v127, v66, v67
  buffer_store_dwordx2 v[126:127], v19, s[12:15], 0 offen offset:1024
  v_lshrrev_b32 v19, 4, v18
  v_lshl_add_u32 v19, v19, 10, v17
  v_add_u32 v19, 2048, v19
  v_lshrrev_b32 v20, 2, v18
  v_and_b32 v20, 1, v20
  v_lshl_add_u32 v19, v20, 9, v19
  v_lshrrev_b32 v20, 3, v18
  v_and_b32 v20, 1, v20
  v_and_b32 v21, 3, v18
  v_lshl_add_u32 v20, v20, 2, v21
  v_lshl_add_u32 v19, v20, 1, v19
  v_lshl_add_u32 v19, v16, 6, v19
  v_cvt_pk_bf16_f32 v106, v68, v68
  buffer_store_short v106, v19, s[12:15], 0 offen offset:0
  v_cvt_pk_bf16_f32 v106, v69, v69
  buffer_store_short v106, v19, s[12:15], 0 offen offset:16
  v_cvt_pk_bf16_f32 v106, v70, v70
  buffer_store_short v106, v19, s[12:15], 0 offen offset:32
  v_cvt_pk_bf16_f32 v106, v71, v71
  buffer_store_short v106, v19, s[12:15], 0 offen offset:48
  v_cvt_pk_bf16_f32 v106, v72, v72
  buffer_store_short v106, v19, s[12:15], 0 offen offset:256
  v_cvt_pk_bf16_f32 v106, v73, v73
  buffer_store_short v106, v19, s[12:15], 0 offen offset:272
  v_cvt_pk_bf16_f32 v106, v74, v74
  buffer_store_short v106, v19, s[12:15], 0 offen offset:288
  v_cvt_pk_bf16_f32 v106, v75, v75
  buffer_store_short v106, v19, s[12:15], 0 offen offset:304
L_end_g1b_kernel:
  s_endpgm
.globl g2b_kernel
.p2align 8
.type g2b_kernel,@function
g2b_kernel:
  s_cmp_ge_u32 s2, 256
  s_cbranch_scc1 L_end_g2b_kernel
  s_load_dwordx2 s[32:33], s[0:1], 88
  s_load_dwordx2 s[34:35], s[0:1], 0
  s_load_dwordx2 s[36:37], s[0:1], 32
  v_lshrrev_b32 v15, 6, v0
  v_and_b32 v1, 63, v0
  v_readfirstlane_b32 s20, v15
  s_and_b32 s28, s2, 7
  s_lshr_b32 s30, s2, 3
  s_and_b32 s27, s30, 3
  s_lshr_b32 s30, s30, 2
  s_lshl_b32 s28, s28, 2
  s_add_u32 s28, s28, s27
  s_lshl_b32 s28, s28, 6
  s_mul_i32 s29, s30, 80
  s_waitcnt lgkmcnt(0)
  s_add_u32 s42, s32, 3145728
  s_addc_u32 s43, s33, 0
  s_mov_b32 s4, s42
  s_mov_b32 s5, s43
  s_mov_b32 s6, 2621440
  s_mov_b32 s7, 0x00020000
  s_mov_b32 s8, s36
  s_mov_b32 s9, s37
  s_mov_b32 s10, 819200
  s_mov_b32 s11, 0x00020000
  s_add_u32 s42, s32, 6291456
  s_addc_u32 s43, s33, 0
  s_mov_b32 s12, s42
  s_mov_b32 s13, s43
  s_mov_b32 s14, 2621440
  s_mov_b32 s15, 0x00020000
  s_add_u32 s42, s32, 9437184
  s_addc_u32 s43, s33, 0
  s_mov_b32 s16, s42
  s_mov_b32 s17, s43
  s_mov_b32 s18, 2621440
  s_mov_b32 s19, 0x00020000
  s_sub_u32 s22, 23, s20
  s_lshr_b32 s22, s22, 2
  s_mul_i32 s27, s20, 5
  s_min_u32 s23, s20, 0
  s_add_u32 s27, s27, s23
  s_lshl_b32 s23, s27, 6
  s_mul_i32 s24, s27, 40960
  s_mul_i32 s21, s20, 36864
  v_lshrrev_b32 v15, 2, v1
  v_lshrrev_b32 v16, 3, v1
  v_xor_b32 v16, v16, v1
  v_and_b32 v16, 3, v16
  v_add_u32 v15, s28, v15
  s_mov_b32 s27, 1280
  v_mul_lo_u32 v15, v15, s27
  v_lshl_add_u32 v2, v16, 4, v15
  v_add_u32 v3, 20480, v2
  v_add_u32 v4, 40960, v2
  v_add_u32 v5, 61440, v2
  v_add_u32 v15, 0, v1
  v_mul_u32_u24 v16, 6554, v15
  v_lshrrev_b32 v16, 16, v16
  v_mul_u32_u24 v17, 10, v16
  v_sub_u32 v17, v15, v17
  v_mul_u32_u24 v16, 1280, v16
  v_lshl_add_u32 v6, v17, 4, v16
  v_add_u32 v15, 64, v1
  v_mul_u32_u24 v16, 6554, v15
  v_lshrrev_b32 v16, 16, v16
  v_mul_u32_u24 v17, 10, v16
  v_sub_u32 v17, v15, v17
  v_mul_u32_u24 v16, 1280, v16
  v_lshl_add_u32 v7, v17, 4, v16
  v_add_u32 v15, 128, v1
  v_mul_u32_u24 v16, 6554, v15
  v_lshrrev_b32 v16, 16, v16
  v_mul_u32_u24 v17, 10, v16
  v_sub_u32 v17, v15, v17
  v_mul_u32_u24 v16, 1280, v16
  v_lshl_add_u32 v8, v17, 4, v16
  v_add_u32 v15, 192, v1
  v_mul_u32_u24 v16, 6554, v15
  v_lshrrev_b32 v16, 16, v16
  v_mul_u32_u24 v17, 10, v16
  v_sub_u32 v17, v15, v17
  v_mul_u32_u24 v16, 1280, v16
  v_lshl_add_u32 v9, v17, 4, v16
  v_add_u32 v15, 256, v1
  v_mul_u32_u24 v16, 6554, v15
  v_lshrrev_b32 v16, 16, v16
  v_mul_u32_u24 v17, 10, v16
  v_sub_u32 v17, v15, v17
  v_mul_u32_u24 v16, 1280, v16
  v_lshl_add_u32 v10, v17, 4, v16
  s_lshl_b32 s27, s29, 1
  v_add_u32 v6, s27, v6
  v_add_u32 v7, s27, v7
  v_add_u32 v8, s27, v8
  v_add_u32 v9, s27, v9
  v_add_u32 v10, s27, v10
  v_and_b32 v15, 15, v1
  v_lshrrev_b32 v16, 4, v1
  v_lshrrev_b32 v17, 1, v15
  v_xor_b32 v17, v17, v16
  v_and_b32 v17, 3, v17
  v_lshlrev_b32 v17, 4, v17
  v_lshl_add_u32 v11, v15, 6, v17
  v_add_u32 v11, s21, v11
  v_lshrrev_b32 v17, 2, v15
  v_lshl_add_u32 v17, v16, 3, v17
  v_mov_b32 v19, v17
  v_mul_u32_u24 v17, 160, v17
  v_and_b32 v18, 3, v1
  v_lshl_add_u32 v12, v18, 3, v17
  v_add_u32 v12, 4096, v12
  v_add_u32 v12, s21, v12
  v_mov_b32 v60, 0
  v_mov_b32 v61, 0
  v_mov_b32 v62, 0
  v_mov_b32 v63, 0
  v_mov_b32 v64, 0
  v_mov_b32 v65, 0
  v_mov_b32 v66, 0
  v_mov_b32 v67, 0
  v_mov_b32 v68, 0
  v_mov_b32 v69, 0
  v_mov_b32 v70, 0
  v_mov_b32 v71, 0
  v_mov_b32 v72, 0
  v_mov_b32 v73, 0
  v_mov_b32 v74, 0
  v_mov_b32 v75, 0
  v_mov_b32 v76, 0
  v_mov_b32 v77, 0
  v_mov_b32 v78, 0
  v_mov_b32 v79, 0
  v_mov_b32 v80, 0
  v_mov_b32 v81, 0
  v_mov_b32 v82, 0
  v_mov_b32 v83, 0
  v_mov_b32 v84, 0
  v_mov_b32 v85, 0
  v_mov_b32 v86, 0
  v_mov_b32 v87, 0
  v_mov_b32 v88, 0
  v_mov_b32 v89, 0
  v_mov_b32 v90, 0
  v_mov_b32 v91, 0
  v_mov_b32 v92, 0
  v_mov_b32 v93, 0
  v_mov_b32 v94, 0
  v_mov_b32 v95, 0
  v_mov_b32 v96, 0
  v_mov_b32 v97, 0
  v_mov_b32 v98, 0
  v_mov_b32 v99, 0
  v_mov_b32 v100, 0
  v_mov_b32 v101, 0
  v_mov_b32 v102, 0
  v_mov_b32 v103, 0
  v_mov_b32 v104, 0
  v_mov_b32 v105, 0
  v_mov_b32 v106, 0
  v_mov_b32 v107, 0
  v_mov_b32 v108, 0
  v_mov_b32 v109, 0
  v_mov_b32 v110, 0
  v_mov_b32 v111, 0
  v_mov_b32 v112, 0
  v_mov_b32 v113, 0
  v_mov_b32 v114, 0
  v_mov_b32 v115, 0
  v_mov_b32 v116, 0
  v_mov_b32 v117, 0
  v_mov_b32 v118, 0
  v_mov_b32 v119, 0
  v_mov_b32 v120, 0
  v_mov_b32 v121, 0
  v_mov_b32 v122, 0
  v_mov_b32 v123, 0
  v_mov_b32 v124, 0
  v_mov_b32 v125, 0
  v_mov_b32 v126, 0
  v_mov_b32 v127, 0
  v_mov_b32 v128, 0
  v_mov_b32 v129, 0
  v_mov_b32 v130, 0
  v_mov_b32 v131, 0
  v_mov_b32 v132, 0
  v_mov_b32 v133, 0
  v_mov_b32 v134, 0
  v_mov_b32 v135, 0
  v_mov_b32 v136, 0
  v_mov_b32 v137, 0
  v_mov_b32 v138, 0
  v_mov_b32 v139, 0
  s_mov_b32 s25, s21
  s_mov_b32 s26, 0
  v_and_b32 v15, 15, v1
  v_lshrrev_b32 v16, 4, v1
  s_lshl_b32 s27, s20, 4
  s_add_u32 s27, s27, s28
  v_add_u32 v15, s27, v15
  v_mul_u32_u24 v15, 1280, v15
  v_lshl_add_u32 v16, v16, 3, v15
  s_lshl_b32 s27, s29, 1
  v_add_u32 v23, s27, v16
  buffer_load_dwordx2 v[154:155], v23, s[16:19], 0 offen offset:0
  buffer_load_dwordx2 v[156:157], v23, s[16:19], 0 offen offset:32
  buffer_load_dwordx2 v[158:159], v23, s[16:19], 0 offen offset:64
  buffer_load_dwordx2 v[160:161], v23, s[16:19], 0 offen offset:96
  buffer_load_dwordx2 v[162:163], v23, s[16:19], 0 offen offset:128
  s_add_u32 m0, s25, 0
  s_nop 0
  buffer_load_dwordx4 v2, s[4:7], s23 offen lds
  s_add_u32 m0, s25, 1024
  s_nop 0
  buffer_load_dwordx4 v3, s[4:7], s23 offen lds
  s_add_u32 m0, s25, 2048
  s_nop 0
  buffer_load_dwordx4 v4, s[4:7], s23 offen lds
  s_add_u32 m0, s25, 3072
  s_nop 0
  buffer_load_dwordx4 v5, s[4:7], s23 offen lds
  s_add_u32 m0, s25, 4096
  s_nop 0
  buffer_load_dwordx4 v6, s[8:11], s24 offen lds
  s_add_u32 m0, s25, 5120
  s_nop 0
  buffer_load_dwordx4 v7, s[8:11], s24 offen lds
  s_add_u32 m0, s25, 6144
  s_nop 0
  buffer_load_dwordx4 v8, s[8:11], s24 offen lds
  s_add_u32 m0, s25, 7168
  s_nop 0
  buffer_load_dwordx4 v9, s[8:11], s24 offen lds
  s_add_u32 m0, s25, 8192
  s_nop 0
  buffer_load_dwordx4 v10, s[8:11], s24 offen lds
  s_add_u32 s24, s24, 40960
  s_add_u32 s23, s23, 64
  s_add_u32 s25, s25, 9216
  s_add_u32 s27, s21, 36864
  s_cmp_ge_u32 s25, s27
  s_cselect_b32 s25, s21, s25
  s_add_u32 m0, s25, 0
  s_nop 0
  buffer_load_dwordx4 v2, s[4:7], s23 offen lds
  s_add_u32 m0, s25, 1024
  s_nop 0
  buffer_load_dwordx4 v3, s[4:7], s23 offen lds
  s_add_u32 m0, s25, 2048
  s_nop 0
  buffer_load_dwordx4 v4, s[4:7], s23 offen lds
  s_add_u32 m0, s25, 3072
  s_nop 0
  buffer_load_dwordx4 v5, s[4:7], s23 offen lds
  s_add_u32 m0, s25, 4096
  s_nop 0
  buffer_load_dwordx4 v6, s[8:11], s24 offen lds
  s_add_u32 m0, s25, 5120
  s_nop 0
  buffer_load_dwordx4 v7, s[8:11], s24 offen lds
  s_add_u32 m0, s25, 6144
  s_nop 0
  buffer_load_dwordx4 v8, s[8:11], s24 offen lds
  s_add_u32 m0, s25, 7168
  s_nop 0
  buffer_load_dwordx4 v9, s[8:11], s24 offen lds
  s_add_u32 m0, s25, 8192
  s_nop 0
  buffer_load_dwordx4 v10, s[8:11], s24 offen lds
  s_add_u32 s24, s24, 40960
  s_add_u32 s23, s23, 64
  s_add_u32 s25, s25, 9216
  s_add_u32 s27, s21, 36864
  s_cmp_ge_u32 s25, s27
  s_cselect_b32 s25, s21, s25
  s_add_u32 m0, s25, 0
  s_nop 0
  buffer_load_dwordx4 v2, s[4:7], s23 offen lds
  s_add_u32 m0, s25, 1024
  s_nop 0
  buffer_load_dwordx4 v3, s[4:7], s23 offen lds
  s_add_u32 m0, s25, 2048
  s_nop 0
  buffer_load_dwordx4 v4, s[4:7], s23 offen lds
  s_add_u32 m0, s25, 3072
  s_nop 0
  buffer_load_dwordx4 v5, s[4:7], s23 offen lds
  s_add_u32 m0, s25, 4096
  s_nop 0
  buffer_load_dwordx4 v6, s[8:11], s24 offen lds
  s_add_u32 m0, s25, 5120
  s_nop 0
  buffer_load_dwordx4 v7, s[8:11], s24 offen lds
  s_add_u32 m0, s25, 6144
  s_nop 0
  buffer_load_dwordx4 v8, s[8:11], s24 offen lds
  s_add_u32 m0, s25, 7168
  s_nop 0
  buffer_load_dwordx4 v9, s[8:11], s24 offen lds
  s_add_u32 m0, s25, 8192
  s_nop 0
  buffer_load_dwordx4 v10, s[8:11], s24 offen lds
  s_add_u32 s24, s24, 40960
  s_add_u32 s23, s23, 64
  s_add_u32 s25, s25, 9216
  s_add_u32 s27, s21, 36864
  s_cmp_ge_u32 s25, s27
  s_cselect_b32 s25, s21, s25
L_loop_g2b_kernel:
  s_add_u32 m0, s25, 0
  s_nop 0
  buffer_load_dwordx4 v2, s[4:7], s23 offen lds
  s_add_u32 m0, s25, 1024
  s_nop 0
  buffer_load_dwordx4 v3, s[4:7], s23 offen lds
  s_add_u32 m0, s25, 2048
  s_nop 0
  buffer_load_dwordx4 v4, s[4:7], s23 offen lds
  s_add_u32 m0, s25, 3072
  s_nop 0
  buffer_load_dwordx4 v5, s[4:7], s23 offen lds
  s_add_u32 m0, s25, 4096
  s_nop 0
  buffer_load_dwordx4 v6, s[8:11], s24 offen lds
  s_add_u32 m0, s25, 5120
  s_nop 0
  buffer_load_dwordx4 v7, s[8:11], s24 offen lds
  s_add_u32 m0, s25, 6144
  s_nop 0
  buffer_load_dwordx4 v8, s[8:11], s24 offen lds
  s_add_u32 m0, s25, 7168
  s_nop 0
  buffer_load_dwordx4 v9, s[8:11], s24 offen lds
  s_add_u32 m0, s25, 8192
  s_nop 0
  buffer_load_dwordx4 v10, s[8:11], s24 offen lds
  s_add_u32 s24, s24, 40960
  s_add_u32 s23, s23, 64
  s_add_u32 s25, s25, 9216
  s_add_u32 s27, s21, 36864
  s_cmp_ge_u32 s25, s27
  s_cselect_b32 s25, s21, s25
  s_waitcnt vmcnt(27)
  v_add_u32 v13, s26, v11
  v_add_u32 v14, s26, v12
  ds_read_b128 v[24:27], v13 offset:0
  ds_read_b128 v[28:31], v13 offset:1024
  ds_read_b128 v[32:35], v13 offset:2048
  ds_read_b128 v[36:39], v13 offset:3072
  ds_read_b64_tr_b16 v[40:41], v14 offset:0
  ds_read_b64_tr_b16 v[42:43], v14 offset:640
  ds_read_b64_tr_b16 v[44:45], v14 offset:32
  ds_read_b64_tr_b16 v[46:47], v14 offset:672
  ds_read_b64_tr_b16 v[48:49], v14 offset:64
  ds_read_b64_tr_b16 v[50:51], v14 offset:704
  ds_read_b64_tr_b16 v[52:53], v14 offset:96
  ds_read_b64_tr_b16 v[54:55], v14 offset:736
  ds_read_b64_tr_b16 v[56:57], v14 offset:128
  ds_read_b64_tr_b16 v[58:59], v14 offset:768
  s_add_u32 s26, s26, 9216
  s_cmp_ge_u32 s26, 36864
  s_cselect_b32 s26, 0, s26
  s_waitcnt lgkmcnt(0)
  v_mfma_f32_16x16x32_bf16 v[60:63], v[40:43], v[24:27], v[60:63]
  v_mfma_f32_16x16x32_bf16 v[64:67], v[44:47], v[24:27], v[64:67]
  v_mfma_f32_16x16x32_bf16 v[68:71], v[48:51], v[24:27], v[68:71]
  v_mfma_f32_16x16x32_bf16 v[72:75], v[52:55], v[24:27], v[72:75]
  v_mfma_f32_16x16x32_bf16 v[76:79], v[56:59], v[24:27], v[76:79]
  v_mfma_f32_16x16x32_bf16 v[80:83], v[40:43], v[28:31], v[80:83]
  v_mfma_f32_16x16x32_bf16 v[84:87], v[44:47], v[28:31], v[84:87]
  v_mfma_f32_16x16x32_bf16 v[88:91], v[48:51], v[28:31], v[88:91]
  v_mfma_f32_16x16x32_bf16 v[92:95], v[52:55], v[28:31], v[92:95]
  v_mfma_f32_16x16x32_bf16 v[96:99], v[56:59], v[28:31], v[96:99]
  v_mfma_f32_16x16x32_bf16 v[100:103], v[40:43], v[32:35], v[100:103]
  v_mfma_f32_16x16x32_bf16 v[104:107], v[44:47], v[32:35], v[104:107]
  v_mfma_f32_16x16x32_bf16 v[108:111], v[48:51], v[32:35], v[108:111]
  v_mfma_f32_16x16x32_bf16 v[112:115], v[52:55], v[32:35], v[112:115]
  v_mfma_f32_16x16x32_bf16 v[116:119], v[56:59], v[32:35], v[116:119]
  v_mfma_f32_16x16x32_bf16 v[120:123], v[40:43], v[36:39], v[120:123]
  v_mfma_f32_16x16x32_bf16 v[124:127], v[44:47], v[36:39], v[124:127]
  v_mfma_f32_16x16x32_bf16 v[128:131], v[48:51], v[36:39], v[128:131]
  v_mfma_f32_16x16x32_bf16 v[132:135], v[52:55], v[36:39], v[132:135]
  v_mfma_f32_16x16x32_bf16 v[136:139], v[56:59], v[36:39], v[136:139]
  s_sub_u32 s22, s22, 1
  s_cmp_lg_u32 s22, 0
  s_cbranch_scc1 L_loop_g2b_kernel
  s_waitcnt vmcnt(0)
  v_lshlrev_b32 v15, 4, v1
  v_add_u32 v15, s21, v15
  ds_write_b128 v15, v[60:63] offset:0
  ds_write_b128 v15, v[64:67] offset:1024
  ds_write_b128 v15, v[68:71] offset:2048
  ds_write_b128 v15, v[72:75] offset:3072
  ds_write_b128 v15, v[76:79] offset:4096
  ds_write_b128 v15, v[80:83] offset:5120
  ds_write_b128 v15, v[84:87] offset:6144
  ds_write_b128 v15, v[88:91] offset:7168
  ds_write_b128 v15, v[92:95] offset:8192
  ds_write_b128 v15, v[96:99] offset:9216
  ds_write_b128 v15, v[100:103] offset:10240
  ds_write_b128 v15, v[104:107] offset:11264
  ds_write_b128 v15, v[108:111] offset:12288
  ds_write_b128 v15, v[112:115] offset:13312
  ds_write_b128 v15, v[116:119] offset:14336
  ds_write_b128 v15, v[120:123] offset:15360
  ds_write_b128 v15, v[124:127] offset:16384
  ds_write_b128 v15, v[128:131] offset:17408
  ds_write_b128 v15, v[132:135] offset:18432
  ds_write_b128 v15, v[136:139] offset:19456
  s_waitcnt lgkmcnt(0)
  s_barrier
  v_lshlrev_b32 v15, 4, v1
  s_mul_i32 s27, s20, 5120
  v_add_u32 v15, s27, v15
  v_add_u32 v16, 36864, v15
  v_add_u32 v17, 73728, v15
  v_add_u32 v18, 110592, v15
  ds_read_b128 v[60:63], v15 offset:0
  ds_read_b128 v[64:67], v15 offset:1024
  ds_read_b128 v[68:71], v15 offset:2048
  ds_read_b128 v[72:75], v15 offset:3072
  ds_read_b128 v[76:79], v15 offset:4096
  ds_read_b128 v[80:83], v16 offset:0
  ds_read_b128 v[84:87], v16 offset:1024
  ds_read_b128 v[88:91], v16 offset:2048
  ds_read_b128 v[92:95], v16 offset:3072
  ds_read_b128 v[96:99], v16 offset:4096
  ds_read_b128 v[100:103], v17 offset:0
  ds_read_b128 v[104:107], v17 offset:1024
  ds_read_b128 v[108:111], v17 offset:2048
  ds_read_b128 v[112:115], v17 offset:3072
  ds_read_b128 v[116:119], v17 offset:4096
  ds_read_b128 v[120:123], v18 offset:0
  ds_read_b128 v[124:127], v18 offset:1024
  ds_read_b128 v[128:131], v18 offset:2048
  ds_read_b128 v[132:135], v18 offset:3072
  ds_read_b128 v[136:139], v18 offset:4096
  s_waitcnt lgkmcnt(0)
  v_add_f32 v60, v60, v80
  v_add_f32 v61, v61, v81
  v_add_f32 v62, v62, v82
  v_add_f32 v63, v63, v83
  v_add_f32 v64, v64, v84
  v_add_f32 v65, v65, v85
  v_add_f32 v66, v66, v86
  v_add_f32 v67, v67, v87
  v_add_f32 v68, v68, v88
  v_add_f32 v69, v69, v89
  v_add_f32 v70, v70, v90
  v_add_f32 v71, v71, v91
  v_add_f32 v72, v72, v92
  v_add_f32 v73, v73, v93
  v_add_f32 v74, v74, v94
  v_add_f32 v75, v75, v95
  v_add_f32 v76, v76, v96
  v_add_f32 v77, v77, v97
  v_add_f32 v78, v78, v98
  v_add_f32 v79, v79, v99
  v_add_f32 v60, v60, v100
  v_add_f32 v61, v61, v101
  v_add_f32 v62, v62, v102
  v_add_f32 v63, v63, v103
  v_add_f32 v64, v64, v104
  v_add_f32 v65, v65, v105
  v_add_f32 v66, v66, v106
  v_add_f32 v67, v67, v107
  v_add_f32 v68, v68, v108
  v_add_f32 v69, v69, v109
  v_add_f32 v70, v70, v110
  v_add_f32 v71, v71, v111
  v_add_f32 v72, v72, v112
  v_add_f32 v73, v73, v113
  v_add_f32 v74, v74, v114
  v_add_f32 v75, v75, v115
  v_add_f32 v76, v76, v116
  v_add_f32 v77, v77, v117
  v_add_f32 v78, v78, v118
  v_add_f32 v79, v79, v119
  v_add_f32 v60, v60, v120
  v_add_f32 v61, v61, v121
  v_add_f32 v62, v62, v122
  v_add_f32 v63, v63, v123
  v_add_f32 v64, v64, v124
  v_add_f32 v65, v65, v125
  v_add_f32 v66, v66, v126
  v_add_f32 v67, v67, v127
  v_add_f32 v68, v68, v128
  v_add_f32 v69, v69, v129
  v_add_f32 v70, v70, v130
  v_add_f32 v71, v71, v131
  v_add_f32 v72, v72, v132
  v_add_f32 v73, v73, v133
  v_add_f32 v74, v74, v134
  v_add_f32 v75, v75, v135
  v_add_f32 v76, v76, v136
  v_add_f32 v77, v77, v137
  v_add_f32 v78, v78, v138
  v_add_f32 v79, v79, v139
  s_waitcnt vmcnt(0)
  v_mov_b32 v100, 0xffff0000
  v_mov_b32 v140, 0
  v_mov_b32 v141, 0
  v_lshlrev_b32 v17, 16, v154
  v_and_b32 v18, v100, v154
  v_add_f32 v60, v60, v17
  v_add_f32 v61, v61, v18
  v_cvt_pk_bf16_f32 v80, v60, v61
  v_lshlrev_b32 v17, 16, v80
  v_and_b32 v18, v100, v80
  v_add_f32 v140, v140, v17
  v_fmac_f32 v141, v17, v17
  v_add_f32 v140, v140, v18
  v_fmac_f32 v141, v18, v18
  v_lshlrev_b32 v17, 16, v155
  v_and_b32 v18, v100, v155
  v_add_f32 v62, v62, v17
  v_add_f32 v63, v63, v18
  v_cvt_pk_bf16_f32 v81, v62, v63
  v_lshlrev_b32 v17, 16, v81
  v_and_b32 v18, v100, v81
  v_add_f32 v140, v140, v17
  v_fmac_f32 v141, v17, v17
  v_add_f32 v140, v140, v18
  v_fmac_f32 v141, v18, v18
  buffer_store_dwordx2 v[80:81], v23, s[12:15], 0 offen offset:0
  v_lshlrev_b32 v17, 16, v156
  v_and_b32 v18, v100, v156
  v_add_f32 v64, v64, v17
  v_add_f32 v65, v65, v18
  v_cvt_pk_bf16_f32 v82, v64, v65
  v_lshlrev_b32 v17, 16, v82
  v_and_b32 v18, v100, v82
  v_add_f32 v140, v140, v17
  v_fmac_f32 v141, v17, v17
  v_add_f32 v140, v140, v18
  v_fmac_f32 v141, v18, v18
  v_lshlrev_b32 v17, 16, v157
  v_and_b32 v18, v100, v157
  v_add_f32 v66, v66, v17
  v_add_f32 v67, v67, v18
  v_cvt_pk_bf16_f32 v83, v66, v67
  v_lshlrev_b32 v17, 16, v83
  v_and_b32 v18, v100, v83
  v_add_f32 v140, v140, v17
  v_fmac_f32 v141, v17, v17
  v_add_f32 v140, v140, v18
  v_fmac_f32 v141, v18, v18
  buffer_store_dwordx2 v[82:83], v23, s[12:15], 0 offen offset:32
  v_lshlrev_b32 v17, 16, v158
  v_and_b32 v18, v100, v158
  v_add_f32 v68, v68, v17
  v_add_f32 v69, v69, v18
  v_cvt_pk_bf16_f32 v84, v68, v69
  v_lshlrev_b32 v17, 16, v84
  v_and_b32 v18, v100, v84
  v_add_f32 v140, v140, v17
  v_fmac_f32 v141, v17, v17
  v_add_f32 v140, v140, v18
  v_fmac_f32 v141, v18, v18
  v_lshlrev_b32 v17, 16, v159
  v_and_b32 v18, v100, v159
  v_add_f32 v70, v70, v17
  v_add_f32 v71, v71, v18
  v_cvt_pk_bf16_f32 v85, v70, v71
  v_lshlrev_b32 v17, 16, v85
  v_and_b32 v18, v100, v85
  v_add_f32 v140, v140, v17
  v_fmac_f32 v141, v17, v17
  v_add_f32 v140, v140, v18
  v_fmac_f32 v141, v18, v18
  buffer_store_dwordx2 v[84:85], v23, s[12:15], 0 offen offset:64
  v_lshlrev_b32 v17, 16, v160
  v_and_b32 v18, v100, v160
  v_add_f32 v72, v72, v17
  v_add_f32 v73, v73, v18
  v_cvt_pk_bf16_f32 v86, v72, v73
  v_lshlrev_b32 v17, 16, v86
  v_and_b32 v18, v100, v86
  v_add_f32 v140, v140, v17
  v_fmac_f32 v141, v17, v17
  v_add_f32 v140, v140, v18
  v_fmac_f32 v141, v18, v18
  v_lshlrev_b32 v17, 16, v161
  v_and_b32 v18, v100, v161
  v_add_f32 v74, v74, v17
  v_add_f32 v75, v75, v18
  v_cvt_pk_bf16_f32 v87, v74, v75
  v_lshlrev_b32 v17, 16, v87
  v_and_b32 v18, v100, v87
  v_add_f32 v140, v140, v17
  v_fmac_f32 v141, v17, v17
  v_add_f32 v140, v140, v18
  v_fmac_f32 v141, v18, v18
  buffer_store_dwordx2 v[86:87], v23, s[12:15], 0 offen offset:96
  v_lshlrev_b32 v17, 16, v162
  v_and_b32 v18, v100, v162
  v_add_f32 v76, v76, v17
  v_add_f32 v77, v77, v18
  v_cvt_pk_bf16_f32 v88, v76, v77
  v_lshlrev_b32 v17, 16, v88
  v_and_b32 v18, v100, v88
  v_add_f32 v140, v140, v17
  v_fmac_f32 v141, v17, v17
  v_add_f32 v140, v140, v18
  v_fmac_f32 v141, v18, v18
  v_lshlrev_b32 v17, 16, v163
  v_and_b32 v18, v100, v163
  v_add_f32 v78, v78, v17
  v_add_f32 v79, v79, v18
  v_cvt_pk_bf16_f32 v89, v78, v79
  v_lshlrev_b32 v17, 16, v89
  v_and_b32 v18, v100, v89
  v_add_f32 v140, v140, v17
  v_fmac_f32 v141, v17, v17
  v_add_f32 v140, v140, v18
  v_fmac_f32 v141, v18, v18
  buffer_store_dwordx2 v[88:89], v23, s[12:15], 0 offen offset:128
  v_mov_b32 v17, v140
  s_nop 1
  v_permlane16_swap_b32 v140, v17
  v_add_f32 v140, v140, v17
  v_mov_b32 v17, v140
  s_nop 1
  v_permlane32_swap_b32 v140, v17
  v_add_f32 v140, v140, v17
  v_mov_b32 v17, v141
  s_nop 1
  v_permlane16_swap_b32 v141, v17
  v_add_f32 v141, v141, v17
  v_mov_b32 v17, v141
  s_nop 1
  v_permlane32_swap_b32 v141, v17
  v_add_f32 v141, v141, v17
  s_add_u32 s42, s32, 13631488
  s_addc_u32 s43, s33, 0
  s_mov_b32 s12, s42
  s_mov_b32 s13, s43
  s_mov_b32 s14, 131072
  s_mov_b32 s15, 0x00020000
  v_and_b32 v15, 15, v1
  s_lshl_b32 s27, s20, 4
  s_add_u32 s27, s27, s28
  v_add_u32 v15, s27, v15
  v_lshl_add_u32 v15, v15, 3, s30
  v_lshlrev_b32 v15, 3, v15
  v_cmp_gt_u32 vcc, 16, v1
  s_nop 0
  s_and_saveexec_b64 s[44:45], vcc
  buffer_store_dwordx2 v[140:141], v15, s[12:15], 0 offen
  s_mov_b64 exec, -1
L_end_g2b_kernel:
  s_endpgm
.globl g4b_kernel
.p2align 8
.type g4b_kernel,@function
g4b_kernel:
  s_cmp_ge_u32 s2, 256
  s_cbranch_scc1 L_end_g4b_kernel
  s_load_dwordx2 s[32:33], s[0:1], 88
  s_load_dwordx2 s[36:37], s[0:1], 64
  s_load_dwordx2 s[38:39], s[0:1], 72
  v_lshrrev_b32 v15, 6, v0
  v_and_b32 v1, 63, v0
  v_readfirstlane_b32 s20, v15
  s_and_b32 s28, s2, 7
  s_lshr_b32 s30, s2, 3
  s_and_b32 s27, s30, 3
  s_lshr_b32 s30, s30, 2
  s_lshl_b32 s28, s28, 2
  s_add_u32 s28, s28, s27
  s_lshl_b32 s28, s28, 6
  s_mul_i32 s29, s30, 80
  s_waitcnt lgkmcnt(0)
  s_add_u32 s42, s32, 16777216
  s_addc_u32 s43, s33, 0
  s_mov_b32 s4, s42
  s_mov_b32 s5, s43
  s_mov_b32 s6, 7077888
  s_mov_b32 s7, 0x00020000
  s_mov_b32 s8, s36
  s_mov_b32 s9, s37
  s_mov_b32 s10, 2211840
  s_mov_b32 s11, 0x00020000
  s_mov_b32 s12, s38
  s_mov_b32 s13, s39
  s_mov_b32 s14, 2621440
  s_mov_b32 s15, 0x00020000
  s_add_u32 s42, s32, 6291456
  s_addc_u32 s43, s33, 0
  s_mov_b32 s16, s42
  s_mov_b32 s17, s43
  s_mov_b32 s18, 2621440
  s_mov_b32 s19, 0x00020000
  s_sub_u32 s22, 57, s20
  s_lshr_b32 s22, s22, 2
  s_mul_i32 s27, s20, 13
  s_min_u32 s23, s20, 2
  s_add_u32 s27, s27, s23
  s_lshl_b32 s23, s27, 6
  s_mul_i32 s24, s27, 40960
  s_mul_i32 s21, s20, 36864
  v_lshrrev_b32 v15, 2, v1
  v_lshrrev_b32 v16, 3, v1
  v_xor_b32 v16, v16, v1
  v_and_b32 v16, 3, v16
  v_add_u32 v15, s28, v15
  s_mov_b32 s27, 3456
  v_mul_lo_u32 v15, v15, s27
  v_lshl_add_u32 v2, v16, 4, v15
  v_add_u32 v3, 55296, v2
  v_add_u32 v4, 110592, v2
  v_add_u32 v5, 165888, v2
  v_add_u32 v15, 0, v1
  v_mul_u32_u24 v16, 6554, v15
  v_lshrrev_b32 v16, 16, v16
  v_mul_u32_u24 v17, 10, v16
  v_sub_u32 v17, v15, v17
  v_mul_u32_u24 v16, 1280, v16
  v_lshl_add_u32 v6, v17, 4, v16
  v_add_u32 v15, 64, v1
  v_mul_u32_u24 v16, 6554, v15
  v_lshrrev_b32 v16, 16, v16
  v_mul_u32_u24 v17, 10, v16
  v_sub_u32 v17, v15, v17
  v_mul_u32_u24 v16, 1280, v16
  v_lshl_add_u32 v7, v17, 4, v16
  v_add_u32 v15, 128, v1
  v_mul_u32_u24 v16, 6554, v15
  v_lshrrev_b32 v16, 16, v16
  v_mul_u32_u24 v17, 10, v16
  v_sub_u32 v17, v15, v17
  v_mul_u32_u24 v16, 1280, v16
  v_lshl_add_u32 v8, v17, 4, v16
  v_add_u32 v15, 192, v1
  v_mul_u32_u24 v16, 6554, v15
  v_lshrrev_b32 v16, 16, v16
  v_mul_u32_u24 v17, 10, v16
  v_sub_u32 v17, v15, v17
  v_mul_u32_u24 v16, 1280, v16
  v_lshl_add_u32 v9, v17, 4, v16
  v_add_u32 v15, 256, v1
  v_mul_u32_u24 v16, 6554, v15
  v_lshrrev_b32 v16, 16, v16
  v_mul_u32_u24 v17, 10, v16
  v_sub_u32 v17, v15, v17
  v_mul_u32_u24 v16, 1280, v16
  v_lshl_add_u32 v10, v17, 4, v16
  s_lshl_b32 s27, s29, 1
  v_add_u32 v6, s27, v6
  v_add_u32 v7, s27, v7
  v_add_u32 v8, s27, v8
  v_add_u32 v9, s27, v9
  v_add_u32 v10, s27, v10
  v_and_b32 v15, 15, v1
  v_lshrrev_b32 v16, 4, v1
  v_lshrrev_b32 v17, 1, v15
  v_xor_b32 v17, v17, v16
  v_and_b32 v17, 3, v17
  v_lshlrev_b32 v17, 4, v17
  v_lshl_add_u32 v11, v15, 6, v17
  v_add_u32 v11, s21, v11
  v_lshrrev_b32 v17, 2, v15
  v_lshl_add_u32 v17, v16, 3, v17
  v_mov_b32 v19, v17
  v_mul_u32_u24 v17, 160, v17
  v_and_b32 v18, 3, v1
  v_lshl_add_u32 v12, v18, 3, v17
  v_add_u32 v12, 4096, v12
  v_add_u32 v12, s21, v12
  v_mov_b32 v60, 0
  v_mov_b32 v61, 0
  v_mov_b32 v62, 0
  v_mov_b32 v63, 0
  v_mov_b32 v64, 0
  v_mov_b32 v65, 0
  v_mov_b32 v66, 0
  v_mov_b32 v67, 0
  v_mov_b32 v68, 0
  v_mov_b32 v69, 0
  v_mov_b32 v70, 0
  v_mov_b32 v71, 0
  v_mov_b32 v72, 0
  v_mov_b32 v73, 0
  v_mov_b32 v74, 0
  v_mov_b32 v75, 0
  v_mov_b32 v76, 0
  v_mov_b32 v77, 0
  v_mov_b32 v78, 0
  v_mov_b32 v79, 0
  v_mov_b32 v80, 0
  v_mov_b32 v81, 0
  v_mov_b32 v82, 0
  v_mov_b32 v83, 0
  v_mov_b32 v84, 0
  v_mov_b32 v85, 0
  v_mov_b32 v86, 0
  v_mov_b32 v87, 0
  v_mov_b32 v88, 0
  v_mov_b32 v89, 0
  v_mov_b32 v90, 0
  v_mov_b32 v91, 0
  v_mov_b32 v92, 0
  v_mov_b32 v93, 0
  v_mov_b32 v94, 0
  v_mov_b32 v95, 0
  v_mov_b32 v96, 0
  v_mov_b32 v97, 0
  v_mov_b32 v98, 0
  v_mov_b32 v99, 0
  v_mov_b32 v100, 0
  v_mov_b32 v101, 0
  v_mov_b32 v102, 0
  v_mov_b32 v103, 0
  v_mov_b32 v104, 0
  v_mov_b32 v105, 0
  v_mov_b32 v106, 0
  v_mov_b32 v107, 0
  v_mov_b32 v108, 0
  v_mov_b32 v109, 0
  v_mov_b32 v110, 0
  v_mov_b32 v111, 0
  v_mov_b32 v112, 0
  v_mov_b32 v113, 0
  v_mov_b32 v114, 0
  v_mov_b32 v115, 0
  v_mov_b32 v116, 0
  v_mov_b32 v117, 0
  v_mov_b32 v118, 0
  v_mov_b32 v119, 0
  v_mov_b32 v120, 0
  v_mov_b32 v121, 0
  v_mov_b32 v122, 0
  v_mov_b32 v123, 0
  v_mov_b32 v124, 0
  v_mov_b32 v125, 0
  v_mov_b32 v126, 0
  v_mov_b32 v127, 0
  v_mov_b32 v128, 0
  v_mov_b32 v129, 0
  v_mov_b32 v130, 0
  v_mov_b32 v131, 0
  v_mov_b32 v132, 0
  v_mov_b32 v133, 0
  v_mov_b32 v134, 0
  v_mov_b32 v135, 0
  v_mov_b32 v136, 0
  v_mov_b32 v137, 0
  v_mov_b32 v138, 0
  v_mov_b32 v139, 0
  s_mov_b32 s25, s21
  s_mov_b32 s26, 0
  v_and_b32 v15, 15, v1
  v_lshrrev_b32 v16, 4, v1
  s_lshl_b32 s27, s20, 4
  s_add_u32 s27, s27, s28
  v_add_u32 v15, s27, v15
  v_mul_u32_u24 v15, 1280, v15
  v_lshl_add_u32 v16, v16, 3, v15
  s_lshl_b32 s27, s29, 1
  v_add_u32 v23, s27, v16
  buffer_load_dwordx2 v[154:155], v23, s[16:19], 0 offen offset:0
  buffer_load_dwordx2 v[156:157], v23, s[16:19], 0 offen offset:32
  buffer_load_dwordx2 v[158:159], v23, s[16:19], 0 offen offset:64
  buffer_load_dwordx2 v[160:161], v23, s[16:19], 0 offen offset:96
  buffer_load_dwordx2 v[162:163], v23, s[16:19], 0 offen offset:128
  s_add_u32 m0, s25, 0
  s_nop 0
  buffer_load_dwordx4 v2, s[4:7], s23 offen lds
  s_add_u32 m0, s25, 1024
  s_nop 0
  buffer_load_dwordx4 v3, s[4:7], s23 offen lds
  s_add_u32 m0, s25, 2048
  s_nop 0
  buffer_load_dwordx4 v4, s[4:7], s23 offen lds
  s_add_u32 m0, s25, 3072
  s_nop 0
  buffer_load_dwordx4 v5, s[4:7], s23 offen lds
  s_add_u32 m0, s25, 4096
  s_nop 0
  buffer_load_dwordx4 v6, s[8:11], s24 offen lds
  s_add_u32 m0, s25, 5120
  s_nop 0
  buffer_load_dwordx4 v7, s[8:11], s24 offen lds
  s_add_u32 m0, s25, 6144
  s_nop 0
  buffer_load_dwordx4 v8, s[8:11], s24 offen lds
  s_add_u32 m0, s25, 7168
  s_nop 0
  buffer_load_dwordx4 v9, s[8:11], s24 offen lds
  s_add_u32 m0, s25, 8192
  s_nop 0
  buffer_load_dwordx4 v10, s[8:11], s24 offen lds
  s_add_u32 s24, s24, 40960
  s_add_u32 s23, s23, 64
  s_add_u32 s25, s25, 9216
  s_add_u32 s27, s21, 36864
  s_cmp_ge_u32 s25, s27
  s_cselect_b32 s25, s21, s25
  s_add_u32 m0, s25, 0
  s_nop 0
  buffer_load_dwordx4 v2, s[4:7], s23 offen lds
  s_add_u32 m0, s25, 1024
  s_nop 0
  buffer_load_dwordx4 v3, s[4:7], s23 offen lds
  s_add_u32 m0, s25, 2048
  s_nop 0
  buffer_load_dwordx4 v4, s[4:7], s23 offen lds
  s_add_u32 m0, s25, 3072
  s_nop 0
  buffer_load_dwordx4 v5, s[4:7], s23 offen lds
  s_add_u32 m0, s25, 4096
  s_nop 0
  buffer_load_dwordx4 v6, s[8:11], s24 offen lds
  s_add_u32 m0, s25, 5120
  s_nop 0
  buffer_load_dwordx4 v7, s[8:11], s24 offen lds
  s_add_u32 m0, s25, 6144
  s_nop 0
  buffer_load_dwordx4 v8, s[8:11], s24 offen lds
  s_add_u32 m0, s25, 7168
  s_nop 0
  buffer_load_dwordx4 v9, s[8:11], s24 offen lds
  s_add_u32 m0, s25, 8192
  s_nop 0
  buffer_load_dwordx4 v10, s[8:11], s24 offen lds
  s_add_u32 s24, s24, 40960
  s_add_u32 s23, s23, 64
  s_add_u32 s25, s25, 9216
  s_add_u32 s27, s21, 36864
  s_cmp_ge_u32 s25, s27
  s_cselect_b32 s25, s21, s25
  s_add_u32 m0, s25, 0
  s_nop 0
  buffer_load_dwordx4 v2, s[4:7], s23 offen lds
  s_add_u32 m0, s25, 1024
  s_nop 0
  buffer_load_dwordx4 v3, s[4:7], s23 offen lds
  s_add_u32 m0, s25, 2048
  s_nop 0
  buffer_load_dwordx4 v4, s[4:7], s23 offen lds
  s_add_u32 m0, s25, 3072
  s_nop 0
  buffer_load_dwordx4 v5, s[4:7], s23 offen lds
  s_add_u32 m0, s25, 4096
  s_nop 0
  buffer_load_dwordx4 v6, s[8:11], s24 offen lds
  s_add_u32 m0, s25, 5120
  s_nop 0
  buffer_load_dwordx4 v7, s[8:11], s24 offen lds
  s_add_u32 m0, s25, 6144
  s_nop 0
  buffer_load_dwordx4 v8, s[8:11], s24 offen lds
  s_add_u32 m0, s25, 7168
  s_nop 0
  buffer_load_dwordx4 v9, s[8:11], s24 offen lds
  s_add_u32 m0, s25, 8192
  s_nop 0
  buffer_load_dwordx4 v10, s[8:11], s24 offen lds
  s_add_u32 s24, s24, 40960
  s_add_u32 s23, s23, 64
  s_add_u32 s25, s25, 9216
  s_add_u32 s27, s21, 36864
  s_cmp_ge_u32 s25, s27
  s_cselect_b32 s25, s21, s25
L_loop_g4b_kernel:
  s_add_u32 m0, s25, 0
  s_nop 0
  buffer_load_dwordx4 v2, s[4:7], s23 offen lds
  s_add_u32 m0, s25, 1024
  s_nop 0
  buffer_load_dwordx4 v3, s[4:7], s23 offen lds
  s_add_u32 m0, s25, 2048
  s_nop 0
  buffer_load_dwordx4 v4, s[4:7], s23 offen lds
  s_add_u32 m0, s25, 3072
  s_nop 0
  buffer_load_dwordx4 v5, s[4:7], s23 offen lds
  s_add_u32 m0, s25, 4096
  s_nop 0
  buffer_load_dwordx4 v6, s[8:11], s24 offen lds
  s_add_u32 m0, s25, 5120
  s_nop 0
  buffer_load_dwordx4 v7, s[8:11], s24 offen lds
  s_add_u32 m0, s25, 6144
  s_nop 0
  buffer_load_dwordx4 v8, s[8:11], s24 offen lds
  s_add_u32 m0, s25, 7168
  s_nop 0
  buffer_load_dwordx4 v9, s[8:11], s24 offen lds
  s_add_u32 m0, s25, 8192
  s_nop 0
  buffer_load_dwordx4 v10, s[8:11], s24 offen lds
  s_add_u32 s24, s24, 40960
  s_add_u32 s23, s23, 64
  s_add_u32 s25, s25, 9216
  s_add_u32 s27, s21, 36864
  s_cmp_ge_u32 s25, s27
  s_cselect_b32 s25, s21, s25
  s_waitcnt vmcnt(27)
  v_add_u32 v13, s26, v11
  v_add_u32 v14, s26, v12
  ds_read_b128 v[24:27], v13 offset:0
  ds_read_b128 v[28:31], v13 offset:1024
  ds_read_b128 v[32:35], v13 offset:2048
  ds_read_b128 v[36:39], v13 offset:3072
  ds_read_b64_tr_b16 v[40:41], v14 offset:0
  ds_read_b64_tr_b16 v[42:43], v14 offset:640
  ds_read_b64_tr_b16 v[44:45], v14 offset:32
  ds_read_b64_tr_b16 v[46:47], v14 offset:672
  ds_read_b64_tr_b16 v[48:49], v14 offset:64
  ds_read_b64_tr_b16 v[50:51], v14 offset:704
  ds_read_b64_tr_b16 v[52:53], v14 offset:96
  ds_read_b64_tr_b16 v[54:55], v14 offset:736
  ds_read_b64_tr_b16 v[56:57], v14 offset:128
  ds_read_b64_tr_b16 v[58:59], v14 offset:768
  s_add_u32 s26, s26, 9216
  s_cmp_ge_u32 s26, 36864
  s_cselect_b32 s26, 0, s26
  s_waitcnt lgkmcnt(0)
  v_mfma_f32_16x16x32_bf16 v[60:63], v[40:43], v[24:27], v[60:63]
  v_mfma_f32_16x16x32_bf16 v[64:67], v[44:47], v[24:27], v[64:67]
  v_mfma_f32_16x16x32_bf16 v[68:71], v[48:51], v[24:27], v[68:71]
  v_mfma_f32_16x16x32_bf16 v[72:75], v[52:55], v[24:27], v[72:75]
  v_mfma_f32_16x16x32_bf16 v[76:79], v[56:59], v[24:27], v[76:79]
  v_mfma_f32_16x16x32_bf16 v[80:83], v[40:43], v[28:31], v[80:83]
  v_mfma_f32_16x16x32_bf16 v[84:87], v[44:47], v[28:31], v[84:87]
  v_mfma_f32_16x16x32_bf16 v[88:91], v[48:51], v[28:31], v[88:91]
  v_mfma_f32_16x16x32_bf16 v[92:95], v[52:55], v[28:31], v[92:95]
  v_mfma_f32_16x16x32_bf16 v[96:99], v[56:59], v[28:31], v[96:99]
  v_mfma_f32_16x16x32_bf16 v[100:103], v[40:43], v[32:35], v[100:103]
  v_mfma_f32_16x16x32_bf16 v[104:107], v[44:47], v[32:35], v[104:107]
  v_mfma_f32_16x16x32_bf16 v[108:111], v[48:51], v[32:35], v[108:111]
  v_mfma_f32_16x16x32_bf16 v[112:115], v[52:55], v[32:35], v[112:115]
  v_mfma_f32_16x16x32_bf16 v[116:119], v[56:59], v[32:35], v[116:119]
  v_mfma_f32_16x16x32_bf16 v[120:123], v[40:43], v[36:39], v[120:123]
  v_mfma_f32_16x16x32_bf16 v[124:127], v[44:47], v[36:39], v[124:127]
  v_mfma_f32_16x16x32_bf16 v[128:131], v[48:51], v[36:39], v[128:131]
  v_mfma_f32_16x16x32_bf16 v[132:135], v[52:55], v[36:39], v[132:135]
  v_mfma_f32_16x16x32_bf16 v[136:139], v[56:59], v[36:39], v[136:139]
  s_sub_u32 s22, s22, 1
  s_cmp_lg_u32 s22, 0
  s_cbranch_scc1 L_loop_g4b_kernel
  s_waitcnt vmcnt(0)
  v_lshlrev_b32 v15, 4, v1
  v_add_u32 v15, s21, v15
  ds_write_b128 v15, v[60:63] offset:0
  ds_write_b128 v15, v[64:67] offset:1024
  ds_write_b128 v15, v[68:71] offset:2048
  ds_write_b128 v15, v[72:75] offset:3072
  ds_write_b128 v15, v[76:79] offset:4096
  ds_write_b128 v15, v[80:83] offset:5120
  ds_write_b128 v15, v[84:87] offset:6144
  ds_write_b128 v15, v[88:91] offset:7168
  ds_write_b128 v15, v[92:95] offset:8192
  ds_write_b128 v15, v[96:99] offset:9216
  ds_write_b128 v15, v[100:103] offset:10240
  ds_write_b128 v15, v[104:107] offset:11264
  ds_write_b128 v15, v[108:111] offset:12288
  ds_write_b128 v15, v[112:115] offset:13312
  ds_write_b128 v15, v[116:119] offset:14336
  ds_write_b128 v15, v[120:123] offset:15360
  ds_write_b128 v15, v[124:127] offset:16384
  ds_write_b128 v15, v[128:131] offset:17408
  ds_write_b128 v15, v[132:135] offset:18432
  ds_write_b128 v15, v[136:139] offset:19456
  s_waitcnt lgkmcnt(0)
  s_barrier
  v_lshlrev_b32 v15, 4, v1
  s_mul_i32 s27, s20, 5120
  v_add_u32 v15, s27, v15
  v_add_u32 v16, 36864, v15
  v_add_u32 v17, 73728, v15
  v_add_u32 v18, 110592, v15
  ds_read_b128 v[60:63], v15 offset:0
  ds_read_b128 v[64:67], v15 offset:1024
  ds_read_b128 v[68:71], v15 offset:2048
  ds_read_b128 v[72:75], v15 offset:3072
  ds_read_b128 v[76:79], v15 offset:4096
  ds_read_b128 v[80:83], v16 offset:0
  ds_read_b128 v[84:87], v16 offset:1024
  ds_read_b128 v[88:91], v16 offset:2048
  ds_read_b128 v[92:95], v16 offset:3072
  ds_read_b128 v[96:99], v16 offset:4096
  ds_read_b128 v[100:103], v17 offset:0
  ds_read_b128 v[104:107], v17 offset:1024
  ds_read_b128 v[108:111], v17 offset:2048
  ds_read_b128 v[112:115], v17 offset:3072
  ds_read_b128 v[116:119], v17 offset:4096
  ds_read_b128 v[120:123], v18 offset:0
  ds_read_b128 v[124:127], v18 offset:1024
  ds_read_b128 v[128:131], v18 offset:2048
  ds_read_b128 v[132:135], v18 offset:3072
  ds_read_b128 v[136:139], v18 offset:4096
  s_waitcnt lgkmcnt(0)
  v_add_f32 v60, v60, v80
  v_add_f32 v61, v61, v81
  v_add_f32 v62, v62, v82
  v_add_f32 v63, v63, v83
  v_add_f32 v64, v64, v84
  v_add_f32 v65, v65, v85
  v_add_f32 v66, v66, v86
  v_add_f32 v67, v67, v87
  v_add_f32 v68, v68, v88
  v_add_f32 v69, v69, v89
  v_add_f32 v70, v70, v90
  v_add_f32 v71, v71, v91
  v_add_f32 v72, v72, v92
  v_add_f32 v73, v73, v93
  v_add_f32 v74, v74, v94
  v_add_f32 v75, v75, v95
  v_add_f32 v76, v76, v96
  v_add_f32 v77, v77, v97
  v_add_f32 v78, v78, v98
  v_add_f32 v79, v79, v99
  v_add_f32 v60, v60, v100
  v_add_f32 v61, v61, v101
  v_add_f32 v62, v62, v102
  v_add_f32 v63, v63, v103
  v_add_f32 v64, v64, v104
  v_add_f32 v65, v65, v105
  v_add_f32 v66, v66, v106
  v_add_f32 v67, v67, v107
  v_add_f32 v68, v68, v108
  v_add_f32 v69, v69, v109
  v_add_f32 v70, v70, v110
  v_add_f32 v71, v71, v111
  v_add_f32 v72, v72, v112
  v_add_f32 v73, v73, v113
  v_add_f32 v74, v74, v114
  v_add_f32 v75, v75, v115
  v_add_f32 v76, v76, v116
  v_add_f32 v77, v77, v117
  v_add_f32 v78, v78, v118
  v_add_f32 v79, v79, v119
  v_add_f32 v60, v60, v120
  v_add_f32 v61, v61, v121
  v_add_f32 v62, v62, v122
  v_add_f32 v63, v63, v123
  v_add_f32 v64, v64, v124
  v_add_f32 v65, v65, v125
  v_add_f32 v66, v66, v126
  v_add_f32 v67, v67, v127
  v_add_f32 v68, v68, v128
  v_add_f32 v69, v69, v129
  v_add_f32 v70, v70, v130
  v_add_f32 v71, v71, v131
  v_add_f32 v72, v72, v132
  v_add_f32 v73, v73, v133
  v_add_f32 v74, v74, v134
  v_add_f32 v75, v75, v135
  v_add_f32 v76, v76, v136
  v_add_f32 v77, v77, v137
  v_add_f32 v78, v78, v138
  v_add_f32 v79, v79, v139
  s_waitcnt vmcnt(0)
  v_mov_b32 v100, 0xffff0000
  v_lshlrev_b32 v17, 16, v154
  v_and_b32 v18, v100, v154
  v_add_f32 v60, v60, v17
  v_add_f32 v61, v61, v18
  v_cvt_pk_bf16_f32 v80, v60, v61
  v_lshlrev_b32 v17, 16, v155
  v_and_b32 v18, v100, v155
  v_add_f32 v62, v62, v17
  v_add_f32 v63, v63, v18
  v_cvt_pk_bf16_f32 v81, v62, v63
  buffer_store_dwordx2 v[80:81], v23, s[12:15], 0 offen offset:0
  v_lshlrev_b32 v17, 16, v156
  v_and_b32 v18, v100, v156
  v_add_f32 v64, v64, v17
  v_add_f32 v65, v65, v18
  v_cvt_pk_bf16_f32 v82, v64, v65
  v_lshlrev_b32 v17, 16, v157
  v_and_b32 v18, v100, v157
  v_add_f32 v66, v66, v17
  v_add_f32 v67, v67, v18
  v_cvt_pk_bf16_f32 v83, v66, v67
  buffer_store_dwordx2 v[82:83], v23, s[12:15], 0 offen offset:32
  v_lshlrev_b32 v17, 16, v158
  v_and_b32 v18, v100, v158
  v_add_f32 v68, v68, v17
  v_add_f32 v69, v69, v18
  v_cvt_pk_bf16_f32 v84, v68, v69
  v_lshlrev_b32 v17, 16, v159
  v_and_b32 v18, v100, v159
  v_add_f32 v70, v70, v17
  v_add_f32 v71, v71, v18
  v_cvt_pk_bf16_f32 v85, v70, v71
  buffer_store_dwordx2 v[84:85], v23, s[12:15], 0 offen offset:64
  v_lshlrev_b32 v17, 16, v160
  v_and_b32 v18, v100, v160
  v_add_f32 v72, v72, v17
  v_add_f32 v73, v73, v18
  v_cvt_pk_bf16_f32 v86, v72, v73
  v_lshlrev_b32 v17, 16, v161
  v_and_b32 v18, v100, v161
  v_add_f32 v74, v74, v17
  v_add_f32 v75, v75, v18
  v_cvt_pk_bf16_f32 v87, v74, v75
  buffer_store_dwordx2 v[86:87], v23, s[12:15], 0 offen offset:96
  v_lshlrev_b32 v17, 16, v162
  v_and_b32 v18, v100, v162
  v_add_f32 v76, v76, v17
  v_add_f32 v77, v77, v18
  v_cvt_pk_bf16_f32 v88, v76, v77
  v_lshlrev_b32 v17, 16, v163
  v_and_b32 v18, v100, v163
  v_add_f32 v78, v78, v17
  v_add_f32 v79, v79, v18
  v_cvt_pk_bf16_f32 v89, v78, v79
  buffer_store_dwordx2 v[88:89], v23, s[12:15], 0 offen offset:128
L_end_g4b_kernel:
  s_endpgm
.section .rodata,"a"
.p2align 6
.amdhsa_kernel g1a_kernel
  .amdhsa_next_free_vgpr 154
  .amdhsa_next_free_sgpr 52
  .amdhsa_accum_offset 156
  .amdhsa_group_segment_fixed_size 0
  .amdhsa_kernarg_size 96
  .amdhsa_user_sgpr_count 2
  .amdhsa_user_sgpr_kernarg_segment_ptr 1
  .amdhsa_system_sgpr_workgroup_id_x 1
.end_amdhsa_kernel
.p2align 6
.amdhsa_kernel att_kernel
  .amdhsa_next_free_vgpr 192
  .amdhsa_next_free_sgpr 46
  .amdhsa_accum_offset 192
  .amdhsa_group_segment_fixed_size 0
  .amdhsa_kernarg_size 96
  .amdhsa_user_sgpr_count 2
  .amdhsa_user_sgpr_kernarg_segment_ptr 1
  .amdhsa_system_sgpr_workgroup_id_x 1
.end_amdhsa_kernel
.p2align 6
.amdhsa_kernel g2a_kernel
  .amdhsa_next_free_vgpr 164
  .amdhsa_next_free_sgpr 46
  .amdhsa_accum_offset 164
  .amdhsa_group_segment_fixed_size 0
  .amdhsa_kernarg_size 96
  .amdhsa_user_sgpr_count 2
  .amdhsa_user_sgpr_kernarg_segment_ptr 1
  .amdhsa_system_sgpr_workgroup_id_x 1
.end_amdhsa_kernel
.p2align 6
.amdhsa_kernel g3_kernel
  .amdhsa_next_free_vgpr 195
  .amdhsa_next_free_sgpr 40
  .amdhsa_accum_offset 196
  .amdhsa_group_segment_fixed_size 0
  .amdhsa_kernarg_size 96
  .amdhsa_user_sgpr_count 2
  .amdhsa_user_sgpr_kernarg_segment_ptr 1
  .amdhsa_system_sgpr_workgroup_id_x 1
.end_amdhsa_kernel
.p2align 6
.amdhsa_kernel g4a_kernel
  .amdhsa_next_free_vgpr 164
  .amdhsa_next_free_sgpr 44
  .amdhsa_accum_offset 164
  .amdhsa_group_segment_fixed_size 0
  .amdhsa_kernarg_size 96
  .amdhsa_user_sgpr_count 2
  .amdhsa_user_sgpr_kernarg_segment_ptr 1
  .amdhsa_system_sgpr_workgroup_id_x 1
.end_amdhsa_kernel
.p2align 6
.amdhsa_kernel g1b_kernel
  .amdhsa_next_free_vgpr 154
  .amdhsa_next_free_sgpr 52
  .amdhsa_accum_offset 156
  .amdhsa_group_segment_fixed_size 0
  .amdhsa_kernarg_size 96
  .amdhsa_user_sgpr_count 2
  .amdhsa_user_sgpr_kernarg_segment_ptr 1
  .amdhsa_system_sgpr_workgroup_id_x 1
.end_amdhsa_kernel
.p2align 6
.amdhsa_kernel g2b_kernel
  .amdhsa_next_free_vgpr 164
  .amdhsa_next_free_sgpr 46
  .amdhsa_accum_offset 164
  .amdhsa_group_segment_fixed_size 0
  .amdhsa_kernarg_size 96
  .amdhsa_user_sgpr_count 2
  .amdhsa_user_sgpr_kernarg_segment_ptr 1
  .amdhsa_system_sgpr_workgroup_id_x 1
.end_amdhsa_kernel
.p2align 6
.amdhsa_kernel g4b_kernel
  .amdhsa_next_free_vgpr 164
  .amdhsa_next_free_sgpr 44
  .amdhsa_accum_offset 164
  .amdhsa_group_segment_fixed_size 0
  .amdhsa_kernarg_size 96
  .amdhsa_user_sgpr_count 2
  .amdhsa_user_sgpr_kernarg_segment_ptr 1
  .amdhsa_system_sgpr_workgroup_id_x 1
.end_amdhsa_kernel
```
